```python
import torch

def _softmax(x, axis=-1):
    return torch.softmax(x, dim=axis)

def _gelu(x):
    return torch.nn.functional.gelu(x, approximate='tanh')

def _silu(x):
    return torch.nn.functional.silu(x)

def _sigmoid(x):
    return torch.sigmoid(x)

def _layernorm(x, axis=-1, eps=1e-05):
    m = x.mean(dim=axis, keepdim=True)
    v = x.var(dim=axis, keepdim=True, unbiased=False)
    return (x - m) / torch.sqrt(v + eps)

def _scatter_add(tgt, idx, src, axis=0):
    return tgt.clone().index_add_(axis, idx, src)

def _segment_sum(src, seg, n):
    out = torch.zeros((n,) + src.shape[1:], dtype=src.dtype)
    return out.index_add_(0, seg, src)

def _pad(x, pw):
    flat = tuple((v for pair in reversed(pw) for v in pair))
    return torch.nn.functional.pad(x, flat)
kernel_name = 'sequential_preLN__memory_aug_recurrent_mem_tr__geglu_ffn__prompt'

def setup_inputs():

    _w = lambda a: (lambda t: t.to(torch.bfloat16) if t.is_floating_point() else t)(torch.as_tensor(a))

    def _A_setup():
        B, S, Dm = (1, 2048, 576)
        H, Dh = (32, 128)
        M, seg = (8, 32)
        seg = min(seg, S)
        S = S // seg * seg
        return {'x': _w((lambda *s: torch.randn(*s, dtype=torch.bfloat16) * 0.05)(B, S, Dm)), 'mem0': _w((lambda *s: torch.randn(*s, dtype=torch.bfloat16) * 0.2)(B, M, Dm)), 'Wq': _w((lambda *s: torch.randn(*s, dtype=torch.bfloat16) * 1.6)(Dm, H, Dh) * Dm ** (-0.5)), 'Wk': _w((lambda *s: torch.randn(*s, dtype=torch.bfloat16) * 1.6)(Dm, H, Dh) * Dm ** (-0.5)), 'Wv': _w((lambda *s: torch.randn(*s, dtype=torch.bfloat16) * 0.2)(Dm, H, Dh) * Dm ** (-0.5)), 'Wo': _w((lambda *s: torch.randn(*s, dtype=torch.bfloat16) * 0.2)(H, Dh, Dm) * (H * Dh) ** (-0.5)), 'seg_len': seg}
    _A_in = _A_setup()

    def _B_setup():
        B, S, D, F = (1, 2048, 576, 4608)
        return {'x': _w((lambda *s: torch.randn(*s, dtype=torch.bfloat16) * 0.05)(B, S, D)), 'w_gate': _w((lambda *s: torch.randn(*s, dtype=torch.bfloat16) * 0.05)(D, F)), 'w_up': _w((lambda *s: torch.randn(*s, dtype=torch.bfloat16) * 0.05)(D, F)), 'w_down': _w((lambda *s: torch.randn(*s, dtype=torch.bfloat16) * 0.05)(F, D))}
    _B_in = _B_setup()
    return {'A_x': _A_in['x'], 'A_mem0': _A_in['mem0'], 'A_Wq': _A_in['Wq'], 'A_Wk': _A_in['Wk'], 'A_Wv': _A_in['Wv'], 'A_Wo': _A_in['Wo'], 'A_seg_len': _A_in['seg_len'], 'B_x': _B_in['x'], 'B_w_gate': _B_in['w_gate'], 'B_w_up': _B_in['w_up'], 'B_w_down': _B_in['w_down']}

def reference(A_x, A_mem0, A_Wq, A_Wk, A_Wv, A_Wo, A_seg_len, B_x, B_w_gate, B_w_up, B_w_down):

    def _A_ref(x, mem0, Wq, Wk, Wv, Wo, seg_len):
        B, S, Dm = x.shape
        H, Dh = (Wq.shape[1], Wq.shape[2])
        M = mem0.shape[1]
        scale = Dh ** (-0.5)
        n_seg = S // seg_len
        L = M + seg_len
        idx = torch.arange(L)
        mask = (idx[:, None] < M) | (idx[:, None] >= idx[None, :])
        mem = mem0
        outs = []
        for s in range(n_seg):
            xs = x[:, s * seg_len:(s + 1) * seg_len, :].clone()
            h = torch.concatenate([mem, xs], axis=1)
            q = torch.einsum('btd,dhe->bhte', h, Wq)
            k = torch.einsum('btd,dhe->bhte', h, Wk)
            v = torch.einsum('btd,dhe->bhte', h, Wv)
            scores = torch.einsum('bhqe,bhke->bhqk', q, k) * scale
            scores = torch.where(mask[None, None], scores, -1000000000.0)
            p = _softmax(scores, axis=-1)
            o = torch.einsum('bhqk,bhke->bhqe', p, v)
            o = torch.einsum('bhte,hed->btd', o, Wo)
            mem = o[:, :M, :].clone()
            outs.append(o[:, M:, :])
        return torch.concatenate(outs, axis=1)

    def _B_ref(x, w_gate, w_up, w_down):
        return _gelu(x @ w_gate) * (x @ w_up) @ w_down
    x = A_x
    h = x + _A_ref(_layernorm(x, axis=-1), A_mem0, A_Wq, A_Wk, A_Wv, A_Wo, A_seg_len)
    h2 = h + _B_ref(_layernorm(h, axis=-1), B_w_gate, B_w_up, B_w_down)
    return h2
```

```asm
; @launch grid=(256,1,1) block=(256,1,1) lds=163840
.amdgcn_target "amdgcn-amd-amdhsa--gfx950"
.text
.globl sequential_preLN__memory_aug_recurrent_mem_tr__geglu_ffn__prompt_kernel
.p2align 8
.type sequential_preLN__memory_aug_recurrent_mem_tr__geglu_ffn__prompt_kernel,@function
sequential_preLN__memory_aug_recurrent_mem_tr__geglu_ffn__prompt_kernel:
    s_cmp_ge_u32 s2, 256
    s_cbranch_scc1 END
    s_load_dwordx2 s[4:5], s[0:1], 104
    s_load_dwordx2 s[84:85], s[0:1], 96
    s_load_dwordx2 s[8:9], s[0:1], 16
    s_mov_b32 s6, 268435456
    s_mov_b32 s7, 0x20000
    s_mov_b32 s86, 256
    s_mov_b32 s87, 0x20000
    v_lshrrev_b32 v1, 6, v0
    s_nop 0
    v_readfirstlane_b32 s13, v1
    s_getreg_b32 s94, hwreg(HW_REG_XCC_ID)
    s_and_b32 s94, s94, 7
    s_lshl_b32 s16, s94, 4
    s_mov_b32 s93, 0
    v_mov_b32 v2, 0
    v_mov_b32 v1, 1
    s_waitcnt lgkmcnt(0)
    s_cmp_lg_u32 s13, 0
    s_cbranch_scc1 L_noticket
    s_mov_b64 exec, 1
    buffer_atomic_add v1, off, s[84:87], s16 sc0 sc1
    s_waitcnt vmcnt(0)
    ds_write_b32 v2, v1
    s_mov_b64 exec, -1
    s_waitcnt lgkmcnt(0)
L_noticket:
    s_cmp_lg_u32 s13, 1
    s_cbranch_scc1 L_nozero
    s_cmp_ge_u32 s2, 11
    s_cbranch_scc1 L_nozero
    v_and_b32 v3, 63, v0
    v_lshlrev_b32 v3, 7, v3
    s_lshl_b32 s16, s2, 13
    buffer_store_dword v2, v3, s[4:7], s16 offen sc1
    s_waitcnt vmcnt(0)
    s_mov_b64 exec, 1
    buffer_atomic_add v1, off, s[84:87], 0 offset:4 sc1
    s_mov_b64 exec, -1
L_nozero:
    s_barrier
    ds_read_b32 v1, v2
    s_waitcnt lgkmcnt(0)
    v_readfirstlane_b32 s92, v1
    s_barrier
    s_mov_b32 s12, s92
    s_cmp_ge_u32 s92, 32
    s_cbranch_scc1 OVERFLOW
    s_cmp_eq_u32 s94, 0
    s_cbranch_scc1 CHAIN
    s_sub_u32 s16, s94, 1
    s_lshl_b32 s16, s16, 5
    s_add_u32 s16, s16, s92
DISPATCH:
    s_getpc_b64 s[18:19]
L_pc:
    s_add_u32 s18, s18, ROLETAB - L_pc
    s_addc_u32 s19, s19, 0
    s_min_u32 s16, s16, 223
    s_lshl_b32 s16, s16, 2
    s_load_dword s95, s[18:19], s16
    s_waitcnt lgkmcnt(0)
    s_bfe_u32 s96, s95, 0x80010
    s_cmp_ge_u32 s96, 128
    s_cbranch_scc1 L_noln1
    v_mbcnt_lo_u32_b32 v1, -1, 0
    v_mbcnt_hi_u32_b32 v1, -1, v1
    s_load_dwordx2 s[8:9], s[0:1], 0
    s_mov_b32 s10, 2359296
    s_mov_b32 s11, 0x20000
    s_waitcnt lgkmcnt(0)
    v_lshrrev_b32 v2, 4, v1
    v_mul_u32_u24 v2, 1152, v2
    v_and_b32 v3, 15, v1
    v_lshl_add_u32 v2, v3, 3, v2
    s_lshl_b32 s16, s96, 2
    s_add_u32 s16, s16, s13
    s_mul_i32 s16, s16, 4608
    buffer_load_dwordx2 v[4:5], v2, s[8:11], s16 offen offset:0
    buffer_load_dwordx2 v[6:7], v2, s[8:11], s16 offen offset:128
    buffer_load_dwordx2 v[8:9], v2, s[8:11], s16 offen offset:256
    buffer_load_dwordx2 v[10:11], v2, s[8:11], s16 offen offset:384
    buffer_load_dwordx2 v[12:13], v2, s[8:11], s16 offen offset:512
    buffer_load_dwordx2 v[14:15], v2, s[8:11], s16 offen offset:640
    buffer_load_dwordx2 v[16:17], v2, s[8:11], s16 offen offset:768
    buffer_load_dwordx2 v[18:19], v2, s[8:11], s16 offen offset:896
    buffer_load_dwordx2 v[20:21], v2, s[8:11], s16 offen offset:1024
    s_add_u32 s16, s16, 2097152
    s_waitcnt vmcnt(0)
    v_lshlrev_b32 v24, 16, v4
    v_and_b32 v25, 0xffff0000, v4
    v_lshlrev_b32 v26, 16, v5
    v_and_b32 v27, 0xffff0000, v5
    v_lshlrev_b32 v28, 16, v6
    v_and_b32 v29, 0xffff0000, v6
    v_lshlrev_b32 v30, 16, v7
    v_and_b32 v31, 0xffff0000, v7
    v_lshlrev_b32 v32, 16, v8
    v_and_b32 v33, 0xffff0000, v8
    v_lshlrev_b32 v34, 16, v9
    v_and_b32 v35, 0xffff0000, v9
    v_lshlrev_b32 v36, 16, v10
    v_and_b32 v37, 0xffff0000, v10
    v_lshlrev_b32 v38, 16, v11
    v_and_b32 v39, 0xffff0000, v11
    v_lshlrev_b32 v40, 16, v12
    v_and_b32 v41, 0xffff0000, v12
    v_lshlrev_b32 v42, 16, v13
    v_and_b32 v43, 0xffff0000, v13
    v_lshlrev_b32 v44, 16, v14
    v_and_b32 v45, 0xffff0000, v14
    v_lshlrev_b32 v46, 16, v15
    v_and_b32 v47, 0xffff0000, v15
    v_lshlrev_b32 v48, 16, v16
    v_and_b32 v49, 0xffff0000, v16
    v_lshlrev_b32 v50, 16, v17
    v_and_b32 v51, 0xffff0000, v17
    v_lshlrev_b32 v52, 16, v18
    v_and_b32 v53, 0xffff0000, v18
    v_lshlrev_b32 v54, 16, v19
    v_and_b32 v55, 0xffff0000, v19
    v_lshlrev_b32 v56, 16, v20
    v_and_b32 v57, 0xffff0000, v20
    v_lshlrev_b32 v58, 16, v21
    v_and_b32 v59, 0xffff0000, v21
    v_pk_add_f32 v[60:61], v[24:25], v[26:27]
    v_pk_add_f32 v[60:61], v[60:61], v[28:29]
    v_pk_add_f32 v[60:61], v[60:61], v[30:31]
    v_pk_add_f32 v[60:61], v[60:61], v[32:33]
    v_pk_add_f32 v[60:61], v[60:61], v[34:35]
    v_pk_add_f32 v[60:61], v[60:61], v[36:37]
    v_pk_add_f32 v[60:61], v[60:61], v[38:39]
    v_pk_add_f32 v[60:61], v[60:61], v[40:41]
    v_pk_add_f32 v[60:61], v[60:61], v[42:43]
    v_pk_add_f32 v[60:61], v[60:61], v[44:45]
    v_pk_add_f32 v[60:61], v[60:61], v[46:47]
    v_pk_add_f32 v[60:61], v[60:61], v[48:49]
    v_pk_add_f32 v[60:61], v[60:61], v[50:51]
    v_pk_add_f32 v[60:61], v[60:61], v[52:53]
    v_pk_add_f32 v[60:61], v[60:61], v[54:55]
    v_pk_add_f32 v[60:61], v[60:61], v[56:57]
    v_pk_add_f32 v[60:61], v[60:61], v[58:59]
    v_add_f32 v60, v60, v61
    s_nop 1
    v_add_f32_dpp v60, v60, v60 row_ror:8 row_mask:0xf bank_mask:0xf
    s_nop 1
    v_add_f32_dpp v60, v60, v60 row_ror:4 row_mask:0xf bank_mask:0xf
    s_nop 1
    v_add_f32_dpp v60, v60, v60 row_ror:2 row_mask:0xf bank_mask:0xf
    s_nop 1
    v_add_f32_dpp v60, v60, v60 row_ror:1 row_mask:0xf bank_mask:0xf
    v_mul_f32 v60, 0xbae38e39, v60
    v_pk_add_f32 v[24:25], v[24:25], v[60:61] op_sel_hi:[1,0]
    v_pk_add_f32 v[26:27], v[26:27], v[60:61] op_sel_hi:[1,0]
    v_pk_add_f32 v[28:29], v[28:29], v[60:61] op_sel_hi:[1,0]
    v_pk_add_f32 v[30:31], v[30:31], v[60:61] op_sel_hi:[1,0]
    v_pk_add_f32 v[32:33], v[32:33], v[60:61] op_sel_hi:[1,0]
    v_pk_add_f32 v[34:35], v[34:35], v[60:61] op_sel_hi:[1,0]
    v_pk_add_f32 v[36:37], v[36:37], v[60:61] op_sel_hi:[1,0]
    v_pk_add_f32 v[38:39], v[38:39], v[60:61] op_sel_hi:[1,0]
    v_pk_add_f32 v[40:41], v[40:41], v[60:61] op_sel_hi:[1,0]
    v_pk_add_f32 v[42:43], v[42:43], v[60:61] op_sel_hi:[1,0]
    v_pk_add_f32 v[44:45], v[44:45], v[60:61] op_sel_hi:[1,0]
    v_pk_add_f32 v[46:47], v[46:47], v[60:61] op_sel_hi:[1,0]
    v_pk_add_f32 v[48:49], v[48:49], v[60:61] op_sel_hi:[1,0]
    v_pk_add_f32 v[50:51], v[50:51], v[60:61] op_sel_hi:[1,0]
    v_pk_add_f32 v[52:53], v[52:53], v[60:61] op_sel_hi:[1,0]
    v_pk_add_f32 v[54:55], v[54:55], v[60:61] op_sel_hi:[1,0]
    v_pk_add_f32 v[56:57], v[56:57], v[60:61] op_sel_hi:[1,0]
    v_pk_add_f32 v[58:59], v[58:59], v[60:61] op_sel_hi:[1,0]
    v_pk_mul_f32 v[62:63], v[24:25], v[24:25]
    v_pk_fma_f32 v[62:63], v[26:27], v[26:27], v[62:63]
    v_pk_fma_f32 v[62:63], v[28:29], v[28:29], v[62:63]
    v_pk_fma_f32 v[62:63], v[30:31], v[30:31], v[62:63]
    v_pk_fma_f32 v[62:63], v[32:33], v[32:33], v[62:63]
    v_pk_fma_f32 v[62:63], v[34:35], v[34:35], v[62:63]
    v_pk_fma_f32 v[62:63], v[36:37], v[36:37], v[62:63]
    v_pk_fma_f32 v[62:63], v[38:39], v[38:39], v[62:63]
    v_pk_fma_f32 v[62:63], v[40:41], v[40:41], v[62:63]
    v_pk_fma_f32 v[62:63], v[42:43], v[42:43], v[62:63]
    v_pk_fma_f32 v[62:63], v[44:45], v[44:45], v[62:63]
    v_pk_fma_f32 v[62:63], v[46:47], v[46:47], v[62:63]
    v_pk_fma_f32 v[62:63], v[48:49], v[48:49], v[62:63]
    v_pk_fma_f32 v[62:63], v[50:51], v[50:51], v[62:63]
    v_pk_fma_f32 v[62:63], v[52:53], v[52:53], v[62:63]
    v_pk_fma_f32 v[62:63], v[54:55], v[54:55], v[62:63]
    v_pk_fma_f32 v[62:63], v[56:57], v[56:57], v[62:63]
    v_pk_fma_f32 v[62:63], v[58:59], v[58:59], v[62:63]
    v_add_f32 v60, v62, v63
    s_nop 1
    v_add_f32_dpp v60, v60, v60 row_ror:8 row_mask:0xf bank_mask:0xf
    s_nop 1
    v_add_f32_dpp v60, v60, v60 row_ror:4 row_mask:0xf bank_mask:0xf
    s_nop 1
    v_add_f32_dpp v60, v60, v60 row_ror:2 row_mask:0xf bank_mask:0xf
    s_nop 1
    v_add_f32_dpp v60, v60, v60 row_ror:1 row_mask:0xf bank_mask:0xf
    v_mov_b32 v61, 0x3727c5ac
    v_fmac_f32 v61, 0x3ae38e39, v60
    v_rsq_f32 v60, v61
    s_nop 0
    v_pk_mul_f32 v[24:25], v[24:25], v[60:61] op_sel_hi:[1,0]
    v_pk_mul_f32 v[26:27], v[26:27], v[60:61] op_sel_hi:[1,0]
    v_pk_mul_f32 v[28:29], v[28:29], v[60:61] op_sel_hi:[1,0]
    v_pk_mul_f32 v[30:31], v[30:31], v[60:61] op_sel_hi:[1,0]
    v_pk_mul_f32 v[32:33], v[32:33], v[60:61] op_sel_hi:[1,0]
    v_pk_mul_f32 v[34:35], v[34:35], v[60:61] op_sel_hi:[1,0]
    v_pk_mul_f32 v[36:37], v[36:37], v[60:61] op_sel_hi:[1,0]
    v_pk_mul_f32 v[38:39], v[38:39], v[60:61] op_sel_hi:[1,0]
    v_pk_mul_f32 v[40:41], v[40:41], v[60:61] op_sel_hi:[1,0]
    v_pk_mul_f32 v[42:43], v[42:43], v[60:61] op_sel_hi:[1,0]
    v_pk_mul_f32 v[44:45], v[44:45], v[60:61] op_sel_hi:[1,0]
    v_pk_mul_f32 v[46:47], v[46:47], v[60:61] op_sel_hi:[1,0]
    v_pk_mul_f32 v[48:49], v[48:49], v[60:61] op_sel_hi:[1,0]
    v_pk_mul_f32 v[50:51], v[50:51], v[60:61] op_sel_hi:[1,0]
    v_pk_mul_f32 v[52:53], v[52:53], v[60:61] op_sel_hi:[1,0]
    v_pk_mul_f32 v[54:55], v[54:55], v[60:61] op_sel_hi:[1,0]
    v_pk_mul_f32 v[56:57], v[56:57], v[60:61] op_sel_hi:[1,0]
    v_pk_mul_f32 v[58:59], v[58:59], v[60:61] op_sel_hi:[1,0]
    v_cvt_pk_bf16_f32 v4, v24, v25
    v_cvt_pk_bf16_f32 v5, v26, v27
    v_cvt_pk_bf16_f32 v6, v28, v29
    v_cvt_pk_bf16_f32 v7, v30, v31
    v_cvt_pk_bf16_f32 v8, v32, v33
    v_cvt_pk_bf16_f32 v9, v34, v35
    v_cvt_pk_bf16_f32 v10, v36, v37
    v_cvt_pk_bf16_f32 v11, v38, v39
    v_cvt_pk_bf16_f32 v12, v40, v41
    v_cvt_pk_bf16_f32 v13, v42, v43
    v_cvt_pk_bf16_f32 v14, v44, v45
    v_cvt_pk_bf16_f32 v15, v46, v47
    v_cvt_pk_bf16_f32 v16, v48, v49
    v_cvt_pk_bf16_f32 v17, v50, v51
    v_cvt_pk_bf16_f32 v18, v52, v53
    v_cvt_pk_bf16_f32 v19, v54, v55
    v_cvt_pk_bf16_f32 v20, v56, v57
    v_cvt_pk_bf16_f32 v21, v58, v59
    buffer_store_dwordx2 v[4:5], v2, s[4:7], s16 offen offset:0 sc1
    buffer_store_dwordx2 v[6:7], v2, s[4:7], s16 offen offset:128 sc1
    buffer_store_dwordx2 v[8:9], v2, s[4:7], s16 offen offset:256 sc1
    buffer_store_dwordx2 v[10:11], v2, s[4:7], s16 offen offset:384 sc1
    buffer_store_dwordx2 v[12:13], v2, s[4:7], s16 offen offset:512 sc1
    buffer_store_dwordx2 v[14:15], v2, s[4:7], s16 offen offset:640 sc1
    buffer_store_dwordx2 v[16:17], v2, s[4:7], s16 offen offset:768 sc1
    buffer_store_dwordx2 v[18:19], v2, s[4:7], s16 offen offset:896 sc1
    buffer_store_dwordx2 v[20:21], v2, s[4:7], s16 offen offset:1024 sc1
    s_waitcnt vmcnt(0)
    s_barrier
    s_cmp_lg_u32 s13, 0
    s_cbranch_scc1 L_ln1e_1
    v_mov_b32 v3, 1
    s_mov_b64 exec, 1
    buffer_store_byte v3, off, s[84:87], s96 offset:128 sc1
    s_mov_b64 exec, -1
L_ln1e_1:
L_noln1:
    s_bfe_u32 s12, s95, 0x80008
    s_and_b32 s95, s95, 0xff
    s_cmp_eq_u32 s95, 0
    s_cbranch_scc1 ROLE_KV
    s_cmp_eq_u32 s95, 1
    s_cbranch_scc1 ROLE_QA
    s_cmp_eq_u32 s95, 2
    s_cbranch_scc1 ROLE_OP
    s_cmp_eq_u32 s95, 3
    s_cbranch_scc1 ROLE_DN
    s_cmp_eq_u32 s95, 4
    s_cbranch_scc1 ROLE_GU
    s_cmp_eq_u32 s95, 5
    s_cbranch_scc1 ROLE_LN
    s_cmp_eq_u32 s95, 6
    s_cbranch_scc1 ROLE_FIN
    s_endpgm
OVERFLOW:
    v_mbcnt_lo_u32_b32 v2, -1, 0
    v_mbcnt_hi_u32_b32 v2, -1, v2
    v_and_b32 v2, 31, v2
    v_lshlrev_b32 v2, 2, v2
    s_mov_b32 s45, 131072
L_ver_2:
    buffer_load_dword v3, v2, s[84:87], 0 offen sc1
    s_sub_u32 s45, s45, 1
    s_cbranch_scc1 ABORT
    s_waitcnt vmcnt(0)
L_verchk_4:
    v_readlane_b32 s66, v3, 0
    v_readlane_b32 s67, v3, 4
    v_readlane_b32 s68, v3, 8
    v_readlane_b32 s69, v3, 12
    v_readlane_b32 s70, v3, 16
    v_readlane_b32 s71, v3, 20
    v_readlane_b32 s72, v3, 24
    v_readlane_b32 s73, v3, 28
    v_readlane_b32 s74, v3, 1
    s_add_u32 s75, s66, s67
    s_add_u32 s75, s75, s68
    s_add_u32 s75, s75, s69
    s_add_u32 s75, s75, s70
    s_add_u32 s75, s75, s71
    s_add_u32 s75, s75, s72
    s_add_u32 s75, s75, s73
    s_add_u32 s75, s75, s74
    s_cmp_ge_u32 s75, 267
    s_cbranch_scc1 L_ver_2_d
    s_sleep 16
    s_branch L_ver_2
L_ver_2_d:
    s_cmp_eq_u32 s93, 1
    s_cbranch_scc1 L_verok_3
    s_or_b32 s75, s66, s67
    s_or_b32 s75, s75, s68
    s_or_b32 s75, s75, s69
    s_or_b32 s75, s75, s70
    s_or_b32 s75, s75, s71
    s_or_b32 s75, s75, s72
    s_or_b32 s75, s75, s73
    s_cmp_lg_u32 s75, 32
    s_cbranch_scc1 REROLE
L_verok_3:
REROLE:
    s_mov_b32 s93, 1
    s_mov_b32 s74, 7
    s_mov_b32 s16, s92
    s_cmp_ge_u32 s72, 32
    s_cselect_b32 s74, 6, s74
    s_cmp_ge_u32 s71, 32
    s_cselect_b32 s74, 5, s74
    s_cmp_ge_u32 s70, 32
    s_cselect_b32 s74, 4, s74
    s_cmp_ge_u32 s69, 32
    s_cselect_b32 s74, 3, s74
    s_cmp_ge_u32 s68, 32
    s_cselect_b32 s74, 2, s74
    s_cmp_ge_u32 s67, 32
    s_cselect_b32 s74, 1, s74
    s_cmp_ge_u32 s66, 32
    s_cselect_b32 s74, 0, s74
    s_cmp_gt_u32 s94, 0
    s_cselect_b32 s75, s66, 0
    s_add_u32 s16, s16, s75
    s_cmp_gt_u32 s94, 1
    s_cselect_b32 s75, s67, 0
    s_add_u32 s16, s16, s75
    s_cmp_gt_u32 s94, 2
    s_cselect_b32 s75, s68, 0
    s_add_u32 s16, s16, s75
    s_cmp_gt_u32 s94, 3
    s_cselect_b32 s75, s69, 0
    s_add_u32 s16, s16, s75
    s_cmp_gt_u32 s94, 4
    s_cselect_b32 s75, s70, 0
    s_add_u32 s16, s16, s75
    s_cmp_gt_u32 s94, 5
    s_cselect_b32 s75, s71, 0
    s_add_u32 s16, s16, s75
    s_cmp_gt_u32 s94, 6
    s_cselect_b32 s75, s72, 0
    s_add_u32 s16, s16, s75
    s_waitcnt vmcnt(0) lgkmcnt(0)
    s_barrier
    s_mov_b32 s12, s92
    s_cmp_lt_u32 s94, s74
    s_cbranch_scc1 DISPATCH
    s_sub_u32 s16, s16, 32
    s_cmp_gt_u32 s94, s74
    s_cbranch_scc1 DISPATCH
    s_cmp_ge_u32 s92, 32
    s_cbranch_scc1 DISPATCH
    s_branch CHAIN
CHAIN:
    v_mbcnt_lo_u32_b32 v20, -1, 0
    v_mbcnt_hi_u32_b32 v20, -1, v20
    v_and_b32 v21, 15, v20
    v_lshrrev_b32 v22, 4, v20
    s_mul_i32 s81, s13, 38912
    s_cmp_eq_u32 s13, 3
    s_cselect_b32 s81, 108544, s81
    s_xor_b32 s20, s13, 0
    s_lshl_b32 s20, s20, 9
    s_xor_b32 s21, s13, 1
    s_lshl_b32 s21, s21, 9
    s_xor_b32 s22, s13, 2
    s_lshl_b32 s22, s22, 9
    s_xor_b32 s23, s13, 3
    s_lshl_b32 s23, s23, 9
    s_load_dwordx2 s[52:53], s[0:1], 16
    s_mov_b32 s54, 4718592
    s_mov_b32 s55, 0x20000
    s_load_dwordx2 s[56:57], s[0:1], 24
    s_mov_b32 s58, 4718592
    s_mov_b32 s59, 0x20000
    s_load_dwordx2 s[60:61], s[0:1], 32
    s_mov_b32 s62, 4718592
    s_mov_b32 s63, 0x20000
    s_load_dwordx2 s[76:77], s[0:1], 40
    s_mov_b32 s78, 4718592
    s_mov_b32 s79, 0x20000
    v_lshlrev_b32 v26, 13, v22
    v_lshl_add_u32 v26, v21, 4, v26
    v_bfe_u32 v23, v20, 3, 2
    v_lshrrev_b32 v24, 5, v20
    v_lshl_add_u32 v23, v23, 2, v24
    v_mul_u32_u24 v27, 1152, v23
    v_and_b32 v23, 7, v20
    v_lshl_add_u32 v27, v23, 4, v27
    v_bfe_u32 v23, v20, 2, 2
    v_lshl_add_u32 v23, v23, 2, v22
    v_mul_u32_u24 v28, 1152, v23
    v_and_b32 v23, 3, v20
    v_lshl_add_u32 v28, v23, 4, v28
    s_lshl_b32 s17, s13, 6
    s_sub_u32 s16, 1024, s17
    v_add_u32 v28, s16, v28
    s_mul_i32 s82, s13, 6144
    s_add_u32 s82, s82, 139264
    s_lshl_b32 s16, s13, 16
    s_lshl_b32 s80, s12, 8
    s_add_u32 s80, s80, s16
    s_mul_i32 s16, s12, 147456
    s_lshl_b32 s18, s13, 7
    s_add_u32 s16, s16, s18
    s_mul_i32 s88, s20, 72
    s_add_u32 s88, s88, s16
    s_mul_i32 s89, s21, 72
    s_add_u32 s89, s89, s16
    s_mul_i32 s90, s22, 72
    s_add_u32 s90, s90, s16
    s_mul_i32 s91, s23, 72
    s_add_u32 s91, s91, s16
    s_load_dwordx2 s[8:9], s[0:1], 8
    s_mov_b32 s10, 9216
    s_mov_b32 s11, 0x20000
    v_and_b32 v23, 7, v20
    v_lshlrev_b32 v25, 4, v23
    v_mul_u32_u24 v23, 1152, v23
    v_lshrrev_b32 v24, 3, v20
    v_lshl_add_u32 v23, v24, 5, v23
    v_lshl_add_u32 v35, v24, 8, v25
    s_mul_i32 s16, s13, 2304
    s_add_u32 s16, s16, 145664
    v_add_u32 v35, s16, v35
    s_mul_i32 s16, s13, 288
    s_waitcnt lgkmcnt(0)
    buffer_load_dwordx4 v[36:39], v23, s[8:11], s16 offen
    buffer_load_dwordx4 v[40:43], v23, s[8:11], s16 offen offset:16
    buffer_load_dwordx4 v[44:47], v23, s[8:11], s16 offen offset:256
    buffer_load_dwordx4 v[48:51], v23, s[8:11], s16 offen offset:272
    s_cmp_ge_u32 s13, 2
    s_cbranch_scc1 L_no5_5
    s_add_u32 m0, s81, 30720
    s_add_u32 s18, s88, 0
    buffer_load_dwordx4 v28, s[76:79], s18 offen lds
    s_add_u32 m0, s81, 31744
    s_add_u32 s18, s88, 18432
    buffer_load_dwordx4 v28, s[76:79], s18 offen lds
    s_add_u32 m0, s81, 32768
    s_add_u32 s18, s89, 0
    buffer_load_dwordx4 v28, s[76:79], s18 offen lds
    s_add_u32 m0, s81, 33792
    s_add_u32 s18, s89, 18432
    buffer_load_dwordx4 v28, s[76:79], s18 offen lds
    s_add_u32 m0, s81, 34816
    s_add_u32 s18, s90, 0
    buffer_load_dwordx4 v28, s[76:79], s18 offen lds
    s_add_u32 m0, s81, 35840
    s_add_u32 s18, s90, 18432
    buffer_load_dwordx4 v28, s[76:79], s18 offen lds
    s_add_u32 m0, s81, 36864
    s_add_u32 s18, s91, 0
    buffer_load_dwordx4 v28, s[76:79], s18 offen lds
    s_add_u32 m0, s81, 37888
    s_add_u32 s18, s91, 18432
    buffer_load_dwordx4 v28, s[76:79], s18 offen lds
L_no5_5:
    s_add_u32 m0, s81, 0
    s_add_u32 s18, s80, 0
    buffer_load_dwordx4 v26, s[52:55], s18 offen lds
    s_add_u32 m0, s81, 1024
    s_add_u32 s18, s80, 32768
    buffer_load_dwordx4 v26, s[52:55], s18 offen lds
    s_add_u32 m0, s81, 2048
    s_add_u32 s18, s80, 262144
    buffer_load_dwordx4 v26, s[52:55], s18 offen lds
    s_add_u32 m0, s81, 3072
    s_add_u32 s18, s80, 294912
    buffer_load_dwordx4 v26, s[52:55], s18 offen lds
    s_add_u32 m0, s81, 4096
    s_add_u32 s18, s80, 524288
    buffer_load_dwordx4 v26, s[52:55], s18 offen lds
    s_add_u32 m0, s81, 5120
    s_add_u32 s18, s80, 557056
    buffer_load_dwordx4 v26, s[52:55], s18 offen lds
    s_add_u32 m0, s81, 6144
    s_add_u32 s18, s80, 786432
    buffer_load_dwordx4 v26, s[52:55], s18 offen lds
    s_add_u32 m0, s81, 7168
    s_add_u32 s18, s80, 819200
    buffer_load_dwordx4 v26, s[52:55], s18 offen lds
    s_add_u32 m0, s81, 8192
    s_add_u32 s18, s80, 1048576
    buffer_load_dwordx4 v26, s[52:55], s18 offen lds
    s_add_u32 m0, s81, 9216
    s_add_u32 s18, s80, 1081344
    buffer_load_dwordx4 v26, s[52:55], s18 offen lds
    s_add_u32 m0, s81, 10240
    s_add_u32 s18, s80, 1310720
    buffer_load_dwordx4 v26, s[52:55], s18 offen lds
    s_add_u32 m0, s81, 11264
    s_add_u32 s18, s80, 1343488
    buffer_load_dwordx4 v26, s[52:55], s18 offen lds
    s_add_u32 m0, s81, 12288
    s_add_u32 s18, s80, 1572864
    buffer_load_dwordx4 v26, s[52:55], s18 offen lds
    s_add_u32 m0, s81, 13312
    s_add_u32 s18, s80, 1605632
    buffer_load_dwordx4 v26, s[52:55], s18 offen lds
    s_add_u32 m0, s81, 14336
    s_add_u32 s18, s80, 1835008
    buffer_load_dwordx4 v26, s[52:55], s18 offen lds
    s_add_u32 m0, s81, 15360
    s_add_u32 s18, s80, 1867776
    buffer_load_dwordx4 v26, s[52:55], s18 offen lds
    s_add_u32 m0, s81, 16384
    s_add_u32 s18, s80, 2097152
    buffer_load_dwordx4 v26, s[52:55], s18 offen lds
    s_add_u32 m0, s81, 17408
    s_add_u32 s18, s80, 2129920
    buffer_load_dwordx4 v26, s[52:55], s18 offen lds
    s_add_u32 m0, s81, 18432
    s_add_u32 s18, s80, 2359296
    buffer_load_dwordx4 v26, s[52:55], s18 offen lds
    s_add_u32 m0, s81, 19456
    s_add_u32 s18, s80, 2392064
    buffer_load_dwordx4 v26, s[52:55], s18 offen lds
    v_lshrrev_b32 v23, 1, v22
    v_lshlrev_b32 v23, 8, v23
    v_lshl_add_u32 v23, v21, 2, v23
    v_add_u32 v23, s17, v23
    v_and_b32 v24, 1, v22
    v_mul_u32_u24 v25, 38912, v24
    v_add_u32 v10, v25, v23
    v_mul_u32_u24 v25, 30720, v24
    v_add_u32 v11, v25, v23
    v_add_u32 v11, 77824, v11
    v_lshlrev_b32 v23, 7, v22
    v_lshl_add_u32 v23, v21, 2, v23
    v_add_u32 v30, s81, v23
    v_add_u32 v31, 64, v30
    v_lshlrev_b32 v23, 2, v20
    v_add_u32 v29, s81, v23
    v_lshlrev_b32 v1, 4, v20
    v_add_u32 v2, s81, v1
    v_add_u32 v1, 139264, v1
    s_lshl_b32 s16, s13, 10
    v_add_u32 v7, s16, v1
    v_and_b32 v23, 7, v20
    v_lshl_add_u32 v23, v22, 3, v23
    v_lshlrev_b32 v23, 4, v23
    v_add_u32 v3, 139264, v23
    v_mov_b32 v23, 0x8888
    v_mov_b32 v24, 0xdddd
    v_cmp_gt_u32 vcc, 8, v21
    s_nop 1
    v_cndmask_b32 v0, v24, v23, vcc
    s_mov_b64 s[50:51], vcc
    v_lshrrev_b32 v23, 1, v22
    v_lshlrev_b32 v23, 4, v23
    v_lshl_add_u32 v23, v21, 3, v23
    v_lshl_add_u32 v23, v22, 7, v23
    s_mul_i32 s16, s13, 544
    s_add_u32 s16, s16, 141312
    v_add_u32 v4, s16, v23
    v_bfe_u32 v23, v21, 2, 1
    v_lshrrev_b32 v24, 3, v21
    v_lshl_add_u32 v24, v22, 2, v24
    v_lshlrev_b32 v24, 3, v24
    v_mul_u32_u24 v25, 272, v23
    v_add_u32 v24, v24, v25
    v_and_b32 v23, 1, v21
    v_lshl_add_u32 v24, v23, 7, v24
    v_add_u32 v5, 141312, v24
    v_lshlrev_b32 v23, 3, v21
    v_lshl_add_u32 v6, v22, 12, v23
    v_bfe_u32 v23, v20, 2, 1
    v_lshlrev_b32 v23, 8, v23
    v_and_b32 v25, 3, v20
    v_lshl_add_u32 v23, v25, 2, v23
    v_and_b32 v25, 1, v22
    v_lshl_add_u32 v23, v25, 5, v23
    v_lshrrev_b32 v25, 5, v20
    v_lshl_add_u32 v23, v25, 4, v23
    v_mov_b32 v24, 0x40000000
    v_cndmask_b32 v8, v24, v23, vcc
    s_mov_b32 s24, -1
    s_mov_b32 s25, 0
    s_mov_b32 s46, 0x3e0293ee
    s_mov_b32 s47, 0x3f80
    s_mov_b32 s28, 0xaaaaaaaa
    s_mov_b32 s29, 0xaaaaaaaa
    s_mov_b32 s30, 0x3f803f80
    s_cmp_eq_u32 s13, 1
    s_cselect_b32 s16, 32, 0
    s_cmp_eq_u32 s13, 3
    s_cselect_b32 s16, 64, s16
    s_add_u32 s16, s16, s12
    s_cmp_lt_u32 s16, 72
    s_cselect_b32 s39, s13, 0
    s_lshl_b32 s37, s16, 12
    s_add_u32 s37, s37, 909312
    s_lshr_b32 s38, s16, 2
    s_lshl_b32 s38, s38, 9
    s_and_b32 s16, s16, 3
    s_lshl_b32 s16, s16, 6
    s_add_u32 s38, s38, s16
    s_lshl_b32 s16, s12, 7
    s_add_u32 s16, s16, 1048576
    s_lshl_b32 s19, s13, 15
    s_add_u32 s31, s16, s19
    s_add_u32 s32, s31, 16384
    s_add_u32 s33, s31, 131072
    s_add_u32 s34, s31, 147456
    s_lshl_b32 s19, s13, 14
    s_add_u32 s35, s16, s19
    s_add_u32 s35, s35, 262144
    s_lshl_b32 s43, s12, 14
    s_add_u32 s43, s43, 33554432
    s_lshl_b32 s44, s12, 12
    s_lshl_b32 s16, s13, 10
    s_add_u32 s44, s44, s16
    s_add_u32 s44, s44, 16637952
    s_waitcnt vmcnt(18)
    s_barrier
    ds_read2st64_b32 a[0:1], v10 offset0:0 offset1:2
    ds_read2st64_b32 a[2:3], v10 offset0:4 offset1:6
    ds_read2st64_b32 a[4:5], v11 offset0:0 offset1:2
    ds_read2st64_b32 a[6:7], v11 offset0:4 offset1:6
    s_add_u32 m0, s81, 20480
    s_add_u32 s18, s80, 2621440
    buffer_load_dwordx4 v26, s[52:55], s18 offen lds
    s_add_u32 m0, s81, 21504
    s_add_u32 s18, s80, 2654208
    buffer_load_dwordx4 v26, s[52:55], s18 offen lds
    s_waitcnt vmcnt(18)
    s_waitcnt lgkmcnt(0)
    s_barrier
    ds_read2st64_b32 a[8:9], v10 offset0:8 offset1:10
    ds_read2st64_b32 a[10:11], v10 offset0:12 offset1:14
    ds_read2st64_b32 a[12:13], v11 offset0:8 offset1:10
    ds_read2st64_b32 a[14:15], v11 offset0:12 offset1:14
    s_add_u32 m0, s81, 22528
    s_add_u32 s18, s80, 2883584
    buffer_load_dwordx4 v26, s[52:55], s18 offen lds
    s_add_u32 m0, s81, 23552
    s_add_u32 s18, s80, 2916352
    buffer_load_dwordx4 v26, s[52:55], s18 offen lds
    s_mov_b32 s16, 0x05040100
    s_mov_b32 s19, 0x07060302
    v_perm_b32 v52, v37, v36, s16
    v_perm_b32 v56, v37, v36, s19
    v_perm_b32 v53, v39, v38, s16
    v_perm_b32 v57, v39, v38, s19
    v_perm_b32 v54, v41, v40, s16
    v_perm_b32 v58, v41, v40, s19
    v_perm_b32 v55, v43, v42, s16
    v_perm_b32 v59, v43, v42, s19
    ds_write_b128 v35, v[52:55] offset:0
    ds_write_b128 v35, v[56:59] offset:128
    v_perm_b32 v60, v45, v44, s16
    v_perm_b32 v64, v45, v44, s19
    v_perm_b32 v61, v47, v46, s16
    v_perm_b32 v65, v47, v46, s19
    v_perm_b32 v62, v49, v48, s16
    v_perm_b32 v66, v49, v48, s19
    v_perm_b32 v63, v51, v50, s16
    v_perm_b32 v67, v51, v50, s19
    s_mov_b64 exec, 0xff
    ds_write_b128 v35, v[60:63] offset:2048
    ds_write_b128 v35, v[64:67] offset:2176
    s_mov_b64 exec, -1
    s_waitcnt lgkmcnt(0)
    s_waitcnt vmcnt(18)
    s_barrier
    ds_read2st64_b32 a[16:17], v10 offset0:16 offset1:18
    ds_read2st64_b32 a[18:19], v10 offset0:20 offset1:22
    ds_read2st64_b32 a[20:21], v11 offset0:16 offset1:18
    ds_read2st64_b32 a[22:23], v11 offset0:20 offset1:22
    s_add_u32 m0, s81, 24576
    s_add_u32 s18, s80, 3145728
    buffer_load_dwordx4 v26, s[52:55], s18 offen lds
    s_add_u32 m0, s81, 25600
    s_add_u32 s18, s80, 3178496
    buffer_load_dwordx4 v26, s[52:55], s18 offen lds
    s_waitcnt vmcnt(18)
    s_waitcnt lgkmcnt(0)
    s_barrier
    ds_read2st64_b32 a[24:25], v10 offset0:24 offset1:26
    ds_read2st64_b32 a[26:27], v10 offset0:28 offset1:30
    ds_read2st64_b32 a[28:29], v11 offset0:24 offset1:26
    ds_read2st64_b32 a[30:31], v11 offset0:28 offset1:30
    s_add_u32 m0, s81, 26624
    s_add_u32 s18, s80, 3407872
    buffer_load_dwordx4 v26, s[52:55], s18 offen lds
    s_add_u32 m0, s81, 27648
    s_add_u32 s18, s80, 3440640
    buffer_load_dwordx4 v26, s[52:55], s18 offen lds
    s_waitcnt vmcnt(18)
    s_waitcnt lgkmcnt(0)
    s_barrier
    ds_read2st64_b32 a[32:33], v10 offset0:32 offset1:34
    ds_read2st64_b32 a[34:35], v10 offset0:36 offset1:38
    ds_read2st64_b32 a[36:37], v11 offset0:32 offset1:34
    ds_read2st64_b32 a[38:39], v11 offset0:36 offset1:38
    s_add_u32 m0, s81, 28672
    s_add_u32 s18, s80, 3670016
    buffer_load_dwordx4 v26, s[52:55], s18 offen lds
    s_add_u32 m0, s81, 29696
    s_add_u32 s18, s80, 3702784
    buffer_load_dwordx4 v26, s[52:55], s18 offen lds
    s_cmp_ge_u32 s13, 2
    s_cbranch_scc1 L_no5b_6
    ds_read2st64_b32 v[36:37], v29 offset0:120 offset1:121
    ds_read2st64_b32 v[38:39], v29 offset0:122 offset1:123
    ds_read2st64_b32 v[40:41], v29 offset0:124 offset1:125
    ds_read2st64_b32 v[42:43], v29 offset0:126 offset1:127
    ds_read2st64_b32 v[44:45], v29 offset0:128 offset1:129
    ds_read2st64_b32 v[46:47], v29 offset0:130 offset1:131
    ds_read2st64_b32 v[48:49], v29 offset0:132 offset1:133
    ds_read2st64_b32 v[50:51], v29 offset0:134 offset1:135
    ds_read2st64_b32 v[52:53], v29 offset0:136 offset1:137
    ds_read2st64_b32 v[54:55], v29 offset0:138 offset1:139
    ds_read2st64_b32 v[56:57], v29 offset0:140 offset1:141
    ds_read2st64_b32 v[58:59], v29 offset0:142 offset1:143
    ds_read2st64_b32 v[60:61], v29 offset0:144 offset1:145
    ds_read2st64_b32 v[62:63], v29 offset0:146 offset1:147
    ds_read2st64_b32 v[64:65], v29 offset0:148 offset1:149
    ds_read2st64_b32 v[66:67], v29 offset0:150 offset1:151
    s_waitcnt lgkmcnt(0)
    ds_write_b128 v2, v[36:39] offset:30720
    ds_write_b128 v2, v[40:43] offset:31744
    ds_write_b128 v2, v[44:47] offset:32768
    ds_write_b128 v2, v[48:51] offset:33792
    ds_write_b128 v2, v[52:55] offset:34816
    ds_write_b128 v2, v[56:59] offset:35840
    ds_write_b128 v2, v[60:63] offset:36864
    ds_write_b128 v2, v[64:67] offset:37888
L_no5b_6:
    s_waitcnt lgkmcnt(0)
    s_waitcnt vmcnt(18)
    s_barrier
    ds_read2st64_b32 a[40:41], v10 offset0:40 offset1:42
    ds_read2st64_b32 a[42:43], v10 offset0:44 offset1:46
    ds_read2st64_b32 a[44:45], v11 offset0:40 offset1:42
    ds_read2st64_b32 a[46:47], v11 offset0:44 offset1:46
    s_add_u32 m0, s81, 0
    s_add_u32 s18, s80, 3932160
    buffer_load_dwordx4 v26, s[52:55], s18 offen lds
    s_add_u32 m0, s81, 1024
    s_add_u32 s18, s80, 3964928
    buffer_load_dwordx4 v26, s[52:55], s18 offen lds
    s_waitcnt vmcnt(18)
    s_waitcnt lgkmcnt(0)
    s_barrier
    ds_read2st64_b32 a[48:49], v10 offset0:48 offset1:50
    ds_read2st64_b32 a[50:51], v10 offset0:52 offset1:54
    ds_read2st64_b32 a[52:53], v11 offset0:48 offset1:50
    ds_read2st64_b32 a[54:55], v11 offset0:52 offset1:54
    s_add_u32 m0, s81, 2048
    s_add_u32 s18, s80, 4194304
    buffer_load_dwordx4 v26, s[52:55], s18 offen lds
    s_add_u32 m0, s81, 3072
    s_add_u32 s18, s80, 4227072
    buffer_load_dwordx4 v26, s[52:55], s18 offen lds
    s_waitcnt vmcnt(18)
    s_waitcnt lgkmcnt(0)
    s_barrier
    ds_read2st64_b32 a[56:57], v10 offset0:56 offset1:58
    ds_read2st64_b32 a[58:59], v10 offset0:60 offset1:62
    ds_read2st64_b32 a[60:61], v11 offset0:56 offset1:58
    ds_read2st64_b32 a[62:63], v11 offset0:60 offset1:62
    s_add_u32 m0, s81, 4096
    s_add_u32 s18, s80, 4456448
    buffer_load_dwordx4 v26, s[52:55], s18 offen lds
    s_add_u32 m0, s81, 5120
    s_add_u32 s18, s80, 4489216
    buffer_load_dwordx4 v26, s[52:55], s18 offen lds
    s_waitcnt vmcnt(18)
    s_waitcnt lgkmcnt(0)
    s_barrier
    ds_read2st64_b32 a[64:65], v10 offset0:64 offset1:66
    ds_read2st64_b32 a[66:67], v10 offset0:68 offset1:70
    ds_read2st64_b32 a[68:69], v11 offset0:64 offset1:66
    ds_read2st64_b32 a[70:71], v11 offset0:68 offset1:70
    s_add_u32 m0, s81, 6144
    s_add_u32 s18, s80, 0
    buffer_load_dwordx4 v26, s[56:59], s18 offen lds
    s_add_u32 m0, s81, 7168
    s_add_u32 s18, s80, 32768
    buffer_load_dwordx4 v26, s[56:59], s18 offen lds
    s_waitcnt vmcnt(18)
    s_waitcnt lgkmcnt(0)
    s_barrier
    ds_read2st64_b32 a[72:73], v10 offset0:72 offset1:74
    ds_read2st64_b32 a[74:75], v10 offset0:76 offset1:78
    ds_read2st64_b32 a[76:77], v11 offset0:72 offset1:74
    ds_read2st64_b32 a[78:79], v11 offset0:76 offset1:78
    s_add_u32 m0, s81, 8192
    s_add_u32 s18, s80, 262144
    buffer_load_dwordx4 v26, s[56:59], s18 offen lds
    s_add_u32 m0, s81, 9216
    s_add_u32 s18, s80, 294912
    buffer_load_dwordx4 v26, s[56:59], s18 offen lds
    s_waitcnt vmcnt(18)
    s_waitcnt lgkmcnt(0)
    s_barrier
    ds_read2st64_b32 a[80:81], v10 offset0:80 offset1:82
    ds_read2st64_b32 a[82:83], v10 offset0:84 offset1:86
    ds_read2st64_b32 a[84:85], v11 offset0:80 offset1:82
    ds_read2st64_b32 a[86:87], v11 offset0:84 offset1:86
    s_add_u32 m0, s81, 10240
    s_add_u32 s18, s80, 524288
    buffer_load_dwordx4 v26, s[56:59], s18 offen lds
    s_add_u32 m0, s81, 11264
    s_add_u32 s18, s80, 557056
    buffer_load_dwordx4 v26, s[56:59], s18 offen lds
    s_waitcnt vmcnt(18)
    s_waitcnt lgkmcnt(0)
    s_barrier
    ds_read2st64_b32 a[88:89], v10 offset0:88 offset1:90
    ds_read2st64_b32 a[90:91], v10 offset0:92 offset1:94
    ds_read2st64_b32 a[92:93], v11 offset0:88 offset1:90
    ds_read2st64_b32 a[94:95], v11 offset0:92 offset1:94
    s_add_u32 m0, s81, 12288
    s_add_u32 s18, s80, 786432
    buffer_load_dwordx4 v26, s[56:59], s18 offen lds
    s_add_u32 m0, s81, 13312
    s_add_u32 s18, s80, 819200
    buffer_load_dwordx4 v26, s[56:59], s18 offen lds
    s_waitcnt vmcnt(18)
    s_waitcnt lgkmcnt(0)
    s_barrier
    ds_read2st64_b32 a[96:97], v10 offset0:96 offset1:98
    ds_read2st64_b32 a[98:99], v10 offset0:100 offset1:102
    ds_read2st64_b32 a[100:101], v11 offset0:96 offset1:98
    ds_read2st64_b32 a[102:103], v11 offset0:100 offset1:102
    s_add_u32 m0, s81, 14336
    s_add_u32 s18, s80, 1048576
    buffer_load_dwordx4 v26, s[56:59], s18 offen lds
    s_add_u32 m0, s81, 15360
    s_add_u32 s18, s80, 1081344
    buffer_load_dwordx4 v26, s[56:59], s18 offen lds
    v_and_b32 v34, 31, v20
    v_lshlrev_b32 v34, 2, v34
    buffer_load_dword v35, v34, s[84:87], 0 offen sc1
    s_waitcnt vmcnt(19)
    s_waitcnt lgkmcnt(0)
    s_barrier
    ds_read2st64_b32 a[104:105], v10 offset0:104 offset1:106
    ds_read2st64_b32 a[106:107], v10 offset0:108 offset1:110
    ds_read2st64_b32 a[108:109], v11 offset0:104 offset1:106
    ds_read2st64_b32 a[110:111], v11 offset0:108 offset1:110
    s_add_u32 m0, s81, 16384
    s_add_u32 s18, s80, 1310720
    buffer_load_dwordx4 v26, s[56:59], s18 offen lds
    s_add_u32 m0, s81, 17408
    s_add_u32 s18, s80, 1343488
    buffer_load_dwordx4 v26, s[56:59], s18 offen lds
    s_waitcnt vmcnt(19)
    s_waitcnt lgkmcnt(0)
    s_barrier
    ds_read2st64_b32 a[112:113], v10 offset0:112 offset1:114
    ds_read2st64_b32 a[114:115], v10 offset0:116 offset1:118
    ds_read2st64_b32 a[116:117], v11 offset0:112 offset1:114
    ds_read2st64_b32 a[118:119], v11 offset0:116 offset1:118
    s_add_u32 m0, s81, 18432
    s_add_u32 s18, s80, 1572864
    buffer_load_dwordx4 v26, s[56:59], s18 offen lds
    s_add_u32 m0, s81, 19456
    s_add_u32 s18, s80, 1605632
    buffer_load_dwordx4 v26, s[56:59], s18 offen lds
    s_waitcnt vmcnt(19)
    s_waitcnt lgkmcnt(0)
    s_barrier
    ds_read2st64_b32 a[120:121], v10 offset0:0 offset1:2
    ds_read2st64_b32 a[122:123], v10 offset0:4 offset1:6
    ds_read2st64_b32 a[124:125], v11 offset0:0 offset1:2
    ds_read2st64_b32 a[126:127], v11 offset0:4 offset1:6
    s_add_u32 m0, s81, 20480
    s_add_u32 s18, s80, 1835008
    buffer_load_dwordx4 v26, s[56:59], s18 offen lds
    s_add_u32 m0, s81, 21504
    s_add_u32 s18, s80, 1867776
    buffer_load_dwordx4 v26, s[56:59], s18 offen lds
    s_waitcnt vmcnt(19)
    s_waitcnt lgkmcnt(0)
    s_barrier
    ds_read2st64_b32 a[128:129], v10 offset0:8 offset1:10
    ds_read2st64_b32 a[130:131], v10 offset0:12 offset1:14
    ds_read2st64_b32 a[132:133], v11 offset0:8 offset1:10
    ds_read2st64_b32 a[134:135], v11 offset0:12 offset1:14
    s_add_u32 m0, s81, 22528
    s_add_u32 s18, s80, 2097152
    buffer_load_dwordx4 v26, s[56:59], s18 offen lds
    s_add_u32 m0, s81, 23552
    s_add_u32 s18, s80, 2129920
    buffer_load_dwordx4 v26, s[56:59], s18 offen lds
    s_waitcnt vmcnt(19)
    s_waitcnt lgkmcnt(0)
    s_barrier
    ds_read2st64_b32 a[136:137], v10 offset0:16 offset1:18
    ds_read2st64_b32 a[138:139], v10 offset0:20 offset1:22
    ds_read2st64_b32 a[140:141], v11 offset0:16 offset1:18
    ds_read2st64_b32 a[142:143], v11 offset0:20 offset1:22
    s_add_u32 m0, s81, 24576
    s_add_u32 s18, s80, 2359296
    buffer_load_dwordx4 v26, s[56:59], s18 offen lds
    s_add_u32 m0, s81, 25600
    s_add_u32 s18, s80, 2392064
    buffer_load_dwordx4 v26, s[56:59], s18 offen lds
    s_waitcnt vmcnt(19)
    s_waitcnt lgkmcnt(0)
    s_barrier
    ds_read2st64_b32 a[144:145], v10 offset0:24 offset1:26
    ds_read2st64_b32 a[146:147], v10 offset0:28 offset1:30
    ds_read2st64_b32 a[148:149], v11 offset0:24 offset1:26
    ds_read2st64_b32 a[150:151], v11 offset0:28 offset1:30
    s_add_u32 m0, s81, 26624
    s_add_u32 s18, s80, 2621440
    buffer_load_dwordx4 v26, s[56:59], s18 offen lds
    s_add_u32 m0, s81, 27648
    s_add_u32 s18, s80, 2654208
    buffer_load_dwordx4 v26, s[56:59], s18 offen lds
    s_waitcnt vmcnt(19)
    s_waitcnt lgkmcnt(0)
    s_barrier
    ds_read2st64_b32 a[152:153], v10 offset0:32 offset1:34
    ds_read2st64_b32 a[154:155], v10 offset0:36 offset1:38
    ds_read2st64_b32 a[156:157], v11 offset0:32 offset1:34
    ds_read2st64_b32 a[158:159], v11 offset0:36 offset1:38
    s_add_u32 m0, s81, 28672
    s_add_u32 s18, s80, 2883584
    buffer_load_dwordx4 v26, s[56:59], s18 offen lds
    s_add_u32 m0, s81, 29696
    s_add_u32 s18, s80, 2916352
    buffer_load_dwordx4 v26, s[56:59], s18 offen lds
    s_waitcnt vmcnt(19)
    s_waitcnt lgkmcnt(0)
    s_barrier
    ds_read2st64_b32 a[160:161], v10 offset0:40 offset1:42
    ds_read2st64_b32 a[162:163], v10 offset0:44 offset1:46
    ds_read2st64_b32 a[164:165], v11 offset0:40 offset1:42
    ds_read2st64_b32 a[166:167], v11 offset0:44 offset1:46
    s_add_u32 m0, s81, 0
    s_add_u32 s18, s80, 3145728
    buffer_load_dwordx4 v26, s[56:59], s18 offen lds
    s_add_u32 m0, s81, 1024
    s_add_u32 s18, s80, 3178496
    buffer_load_dwordx4 v26, s[56:59], s18 offen lds
    s_waitcnt vmcnt(19)
    s_waitcnt lgkmcnt(0)
    s_barrier
    ds_read2st64_b32 a[168:169], v10 offset0:48 offset1:50
    ds_read2st64_b32 a[170:171], v10 offset0:52 offset1:54
    ds_read2st64_b32 a[172:173], v11 offset0:48 offset1:50
    ds_read2st64_b32 a[174:175], v11 offset0:52 offset1:54
    s_add_u32 m0, s81, 2048
    s_add_u32 s18, s80, 3407872
    buffer_load_dwordx4 v26, s[56:59], s18 offen lds
    s_add_u32 m0, s81, 3072
    s_add_u32 s18, s80, 3440640
    buffer_load_dwordx4 v26, s[56:59], s18 offen lds
    s_waitcnt vmcnt(19)
    s_waitcnt lgkmcnt(0)
    s_barrier
    ds_read2st64_b32 a[176:177], v10 offset0:56 offset1:58
    ds_read2st64_b32 a[178:179], v10 offset0:60 offset1:62
    ds_read2st64_b32 a[180:181], v11 offset0:56 offset1:58
    ds_read2st64_b32 a[182:183], v11 offset0:60 offset1:62
    s_add_u32 m0, s81, 4096
    s_add_u32 s18, s80, 3670016
    buffer_load_dwordx4 v26, s[56:59], s18 offen lds
    s_add_u32 m0, s81, 5120
    s_add_u32 s18, s80, 3702784
    buffer_load_dwordx4 v26, s[56:59], s18 offen lds
    s_waitcnt vmcnt(18)
    s_waitcnt lgkmcnt(0)
    s_barrier
    ds_read2st64_b32 a[184:185], v10 offset0:64 offset1:66
    ds_read2st64_b32 a[186:187], v10 offset0:68 offset1:70
    ds_read2st64_b32 a[188:189], v11 offset0:64 offset1:66
    ds_read2st64_b32 a[190:191], v11 offset0:68 offset1:70
    s_add_u32 m0, s81, 6144
    s_add_u32 s18, s80, 3932160
    buffer_load_dwordx4 v26, s[56:59], s18 offen lds
    s_add_u32 m0, s81, 7168
    s_add_u32 s18, s80, 3964928
    buffer_load_dwordx4 v26, s[56:59], s18 offen lds
    v_mbcnt_lo_u32_b32 v34, -1, 0
    v_mbcnt_hi_u32_b32 v34, -1, v34
    v_and_b32 v34, 31, v34
    v_lshlrev_b32 v34, 2, v34
    s_mov_b32 s45, 131072
    s_branch L_verchk_9
L_ver_7:
    buffer_load_dword v35, v34, s[84:87], 0 offen sc1
    s_sub_u32 s45, s45, 1
    s_cbranch_scc1 ABORT
    s_waitcnt vmcnt(0)
L_verchk_9:
    v_readlane_b32 s66, v35, 0
    v_readlane_b32 s67, v35, 4
    v_readlane_b32 s68, v35, 8
    v_readlane_b32 s69, v35, 12
    v_readlane_b32 s70, v35, 16
    v_readlane_b32 s71, v35, 20
    v_readlane_b32 s72, v35, 24
    v_readlane_b32 s73, v35, 28
    v_readlane_b32 s74, v35, 1
    s_add_u32 s75, s66, s67
    s_add_u32 s75, s75, s68
    s_add_u32 s75, s75, s69
    s_add_u32 s75, s75, s70
    s_add_u32 s75, s75, s71
    s_add_u32 s75, s75, s72
    s_add_u32 s75, s75, s73
    s_add_u32 s75, s75, s74
    s_cmp_ge_u32 s75, 267
    s_cbranch_scc1 L_ver_7_d
    s_sleep 16
    s_branch L_ver_7
L_ver_7_d:
    s_cmp_eq_u32 s93, 1
    s_cbranch_scc1 L_verok_8
    s_or_b32 s75, s66, s67
    s_or_b32 s75, s75, s68
    s_or_b32 s75, s75, s69
    s_or_b32 s75, s75, s70
    s_or_b32 s75, s75, s71
    s_or_b32 s75, s75, s72
    s_or_b32 s75, s75, s73
    s_cmp_lg_u32 s75, 32
    s_cbranch_scc1 REROLE
L_verok_8:
    s_cmp_eq_u32 s39, 0
    s_cselect_b32 s16, 0x40000000, s37
    s_cselect_b32 s19, 0x40000000, s38
    v_mov_b32 v44, -1
    v_mov_b64 v[48:49], 0
    v_mov_b64 v[50:51], 0
    v_lshrrev_b32 v32, 2, v7
    v_add_u32 v32, 104448, v32
    ds_read_b128 v[36:39], v7 offset:10496
    ds_read_b32 v40, v32 offset:14592
    s_lshl_b32 s49, s12, 13
    s_add_u32 s49, s49, 1630208
    s_add_u32 s36, s49, 4096
    buffer_store_dwordx4 v[48:51], v1, s[4:7], s16 offen offset:0
    buffer_store_dwordx4 v[48:51], v1, s[4:7], s16 offen offset:1024
    buffer_store_dwordx4 v[48:51], v1, s[4:7], s16 offen offset:2048
    buffer_store_dwordx4 v[48:51], v1, s[4:7], s16 offen offset:3072
    s_add_u32 s16, s19, 1703936
    buffer_store_dword v44, v8, s[4:7], s16 offen
    s_add_u32 s16, s19, 1720320
    buffer_store_dword v44, v8, s[4:7], s16 offen
    s_add_u32 s16, s19, 1736704
    buffer_store_dword v44, v8, s[4:7], s16 offen
    s_waitcnt lgkmcnt(0)
    v_min_u32 v36, -2, v36
    v_min_u32 v37, -2, v37
    v_min_u32 v38, -2, v38
    v_min_u32 v39, -2, v39
    v_min_u32 v40, -2, v40
    buffer_store_dwordx4 v[36:39], v7, s[4:7], s49 offen
    buffer_store_dword v40, v32, s[4:7], s36 offen
    s_waitcnt vmcnt(27)
    s_barrier
    ds_read2st64_b32 a[192:193], v10 offset0:72 offset1:74
    ds_read2st64_b32 a[194:195], v10 offset0:76 offset1:78
    ds_read2st64_b32 a[196:197], v11 offset0:72 offset1:74
    ds_read2st64_b32 a[198:199], v11 offset0:76 offset1:78
    s_add_u32 m0, s81, 8192
    s_add_u32 s18, s80, 4194304
    buffer_load_dwordx4 v26, s[56:59], s18 offen lds
    s_add_u32 m0, s81, 9216
    s_add_u32 s18, s80, 4227072
    buffer_load_dwordx4 v26, s[56:59], s18 offen lds
    s_waitcnt vmcnt(27)
    s_waitcnt lgkmcnt(0)
    s_barrier
    ds_read2st64_b32 a[200:201], v10 offset0:80 offset1:82
    ds_read2st64_b32 a[202:203], v10 offset0:84 offset1:86
    ds_read2st64_b32 a[204:205], v11 offset0:80 offset1:82
    ds_read2st64_b32 a[206:207], v11 offset0:84 offset1:86
    s_add_u32 m0, s81, 10240
    s_add_u32 s18, s80, 4456448
    buffer_load_dwordx4 v26, s[56:59], s18 offen lds
    s_add_u32 m0, s81, 11264
    s_add_u32 s18, s80, 4489216
    buffer_load_dwordx4 v26, s[56:59], s18 offen lds
    s_waitcnt vmcnt(27)
    s_waitcnt lgkmcnt(0)
    s_barrier
    ds_read2st64_b32 a[208:209], v10 offset0:88 offset1:90
    ds_read2st64_b32 a[210:211], v10 offset0:92 offset1:94
    ds_read2st64_b32 a[212:213], v11 offset0:88 offset1:90
    ds_read2st64_b32 a[214:215], v11 offset0:92 offset1:94
    s_add_u32 m0, s81, 12288
    s_add_u32 s18, s80, 1310720
    buffer_load_dwordx4 v26, s[60:63], s18 offen lds
    s_add_u32 m0, s81, 13312
    s_add_u32 s18, s80, 1343488
    buffer_load_dwordx4 v26, s[60:63], s18 offen lds
    s_waitcnt vmcnt(27)
    s_waitcnt lgkmcnt(0)
    s_barrier
    ds_read2st64_b32 a[216:217], v10 offset0:96 offset1:98
    ds_read2st64_b32 a[218:219], v10 offset0:100 offset1:102
    ds_read2st64_b32 a[220:221], v11 offset0:96 offset1:98
    ds_read2st64_b32 a[222:223], v11 offset0:100 offset1:102
    s_add_u32 m0, s81, 14336
    s_add_u32 s18, s80, 2359296
    buffer_load_dwordx4 v26, s[60:63], s18 offen lds
    s_add_u32 m0, s81, 15360
    s_add_u32 s18, s80, 2392064
    buffer_load_dwordx4 v26, s[60:63], s18 offen lds
    s_waitcnt vmcnt(27)
    s_waitcnt lgkmcnt(0)
    s_barrier
    ds_read2st64_b32 a[224:225], v10 offset0:104 offset1:106
    ds_read2st64_b32 a[226:227], v10 offset0:108 offset1:110
    ds_read2st64_b32 a[228:229], v11 offset0:104 offset1:106
    ds_read2st64_b32 a[230:231], v11 offset0:108 offset1:110
    s_add_u32 m0, s81, 16384
    s_add_u32 s18, s80, 2883584
    buffer_load_dwordx4 v26, s[60:63], s18 offen lds
    s_add_u32 m0, s81, 17408
    s_add_u32 s18, s80, 2916352
    buffer_load_dwordx4 v26, s[60:63], s18 offen lds
    s_waitcnt vmcnt(27)
    s_waitcnt lgkmcnt(0)
    s_barrier
    ds_read2st64_b32 a[232:233], v10 offset0:112 offset1:114
    ds_read2st64_b32 a[234:235], v10 offset0:116 offset1:118
    ds_read2st64_b32 a[236:237], v11 offset0:112 offset1:114
    ds_read2st64_b32 a[238:239], v11 offset0:116 offset1:118
    s_add_u32 m0, s81, 18432
    s_add_u32 s18, s80, 3407872
    buffer_load_dwordx4 v26, s[60:63], s18 offen lds
    s_add_u32 m0, s81, 19456
    s_add_u32 s18, s80, 3440640
    buffer_load_dwordx4 v26, s[60:63], s18 offen lds
    s_waitcnt vmcnt(27)
    s_waitcnt lgkmcnt(0)
    s_barrier
    ds_read2st64_b32 a[240:241], v10 offset0:0 offset1:2
    ds_read2st64_b32 a[242:243], v10 offset0:4 offset1:6
    ds_read2st64_b32 a[244:245], v11 offset0:0 offset1:2
    ds_read2st64_b32 a[246:247], v11 offset0:4 offset1:6
    s_add_u32 m0, s81, 20480
    s_add_u32 s18, s80, 3670016
    buffer_load_dwordx4 v26, s[60:63], s18 offen lds
    s_add_u32 m0, s81, 21504
    s_add_u32 s18, s80, 3702784
    buffer_load_dwordx4 v26, s[60:63], s18 offen lds
    s_waitcnt vmcnt(27)
    s_waitcnt lgkmcnt(0)
    s_barrier
    ds_read2st64_b32 a[248:249], v10 offset0:8 offset1:10
    ds_read2st64_b32 a[250:251], v10 offset0:12 offset1:14
    ds_read2st64_b32 a[252:253], v11 offset0:8 offset1:10
    ds_read2st64_b32 a[254:255], v11 offset0:12 offset1:14
    s_add_u32 m0, s81, 22528
    s_add_u32 s18, s80, 4194304
    buffer_load_dwordx4 v26, s[60:63], s18 offen lds
    s_add_u32 m0, s81, 23552
    s_add_u32 s18, s80, 4227072
    buffer_load_dwordx4 v26, s[60:63], s18 offen lds
    s_waitcnt vmcnt(27)
    s_waitcnt lgkmcnt(0)
    s_barrier
    ds_read2st64_b32 v[72:73], v10 offset0:16 offset1:18
    ds_read2st64_b32 v[74:75], v10 offset0:20 offset1:22
    ds_read2st64_b32 v[76:77], v11 offset0:16 offset1:18
    ds_read2st64_b32 v[78:79], v11 offset0:20 offset1:22
    s_add_u32 m0, s81, 24576
    s_add_u32 s18, s80, 4456448
    buffer_load_dwordx4 v26, s[60:63], s18 offen lds
    s_add_u32 m0, s81, 25600
    s_add_u32 s18, s80, 4489216
    buffer_load_dwordx4 v26, s[60:63], s18 offen lds
    s_waitcnt vmcnt(27)
    s_waitcnt lgkmcnt(0)
    s_barrier
    ds_read2st64_b32 v[80:81], v10 offset0:24 offset1:26
    ds_read2st64_b32 v[82:83], v10 offset0:28 offset1:30
    ds_read2st64_b32 v[84:85], v11 offset0:24 offset1:26
    ds_read2st64_b32 v[86:87], v11 offset0:28 offset1:30
    s_add_u32 m0, s81, 26624
    s_add_u32 s18, s88, 512
    buffer_load_dwordx4 v27, s[76:79], s18 offen lds
    s_add_u32 m0, s81, 27648
    s_add_u32 s18, s88, 2816
    buffer_load_dwordx4 v27, s[76:79], s18 offen lds
    s_add_u32 m0, s81, 28672
    s_add_u32 s18, s88, 18944
    buffer_load_dwordx4 v27, s[76:79], s18 offen lds
    s_add_u32 m0, s81, 29696
    s_add_u32 s18, s88, 21248
    buffer_load_dwordx4 v27, s[76:79], s18 offen lds
    s_waitcnt vmcnt(20)
    s_waitcnt lgkmcnt(0)
    s_barrier
    ds_read2st64_b32 v[88:89], v10 offset0:32 offset1:34
    ds_read2st64_b32 v[90:91], v10 offset0:36 offset1:38
    ds_read2st64_b32 v[92:93], v11 offset0:32 offset1:34
    ds_read2st64_b32 v[94:95], v11 offset0:36 offset1:38
    s_cmp_eq_u32 s13, 0
    s_cselect_b32 s16, 0, 0x40000000
    v_mov_b32 v34, 1
    s_mov_b64 exec, 1
    buffer_atomic_add v34, off, s[84:87], s16 offset:8 sc1
    s_mov_b64 exec, -1
    s_waitcnt vmcnt(19)
    s_waitcnt lgkmcnt(0)
    s_barrier
    ds_read2st64_b32 v[96:97], v10 offset0:40 offset1:42
    ds_read2st64_b32 v[98:99], v10 offset0:44 offset1:46
    ds_read2st64_b32 v[100:101], v11 offset0:40 offset1:42
    ds_read2st64_b32 v[102:103], v11 offset0:44 offset1:46
    s_add_u32 m0, s81, 0
    s_add_u32 s18, s89, 0
    buffer_load_dwordx4 v27, s[76:79], s18 offen lds
    s_add_u32 m0, s81, 1024
    s_add_u32 s18, s89, 2304
    buffer_load_dwordx4 v27, s[76:79], s18 offen lds
    s_add_u32 m0, s81, 2048
    s_add_u32 s18, s89, 18432
    buffer_load_dwordx4 v27, s[76:79], s18 offen lds
    s_add_u32 m0, s81, 3072
    s_add_u32 s18, s89, 20736
    buffer_load_dwordx4 v27, s[76:79], s18 offen lds
    s_waitcnt vmcnt(21)
    s_waitcnt lgkmcnt(0)
    s_barrier
    ds_read2st64_b32 v[104:105], v10 offset0:48 offset1:50
    ds_read2st64_b32 v[106:107], v10 offset0:52 offset1:54
    ds_read2st64_b32 v[108:109], v11 offset0:48 offset1:50
    ds_read2st64_b32 v[110:111], v11 offset0:52 offset1:54
    s_waitcnt vmcnt(19)
    s_waitcnt lgkmcnt(0)
    s_barrier
    ds_read2st64_b32 v[112:113], v10 offset0:56 offset1:58
    ds_read2st64_b32 v[114:115], v10 offset0:60 offset1:62
    ds_read2st64_b32 v[116:117], v11 offset0:56 offset1:58
    ds_read2st64_b32 v[118:119], v11 offset0:60 offset1:62
    s_add_u32 m0, s81, 4096
    s_add_u32 s18, s89, 512
    buffer_load_dwordx4 v27, s[76:79], s18 offen lds
    s_add_u32 m0, s81, 5120
    s_add_u32 s18, s89, 2816
    buffer_load_dwordx4 v27, s[76:79], s18 offen lds
    s_add_u32 m0, s81, 6144
    s_add_u32 s18, s89, 18944
    buffer_load_dwordx4 v27, s[76:79], s18 offen lds
    s_add_u32 m0, s81, 7168
    s_add_u32 s18, s89, 21248
    buffer_load_dwordx4 v27, s[76:79], s18 offen lds
    s_waitcnt vmcnt(21)
    s_waitcnt lgkmcnt(0)
    s_barrier
    ds_read2st64_b32 v[120:121], v10 offset0:64 offset1:66
    ds_read2st64_b32 v[122:123], v10 offset0:68 offset1:70
    ds_read2st64_b32 v[124:125], v11 offset0:64 offset1:66
    ds_read2st64_b32 v[126:127], v11 offset0:68 offset1:70
    s_waitcnt vmcnt(19)
    s_waitcnt lgkmcnt(0)
    s_barrier
    ds_read2st64_b32 v[128:129], v10 offset0:72 offset1:74
    ds_read2st64_b32 v[130:131], v10 offset0:76 offset1:78
    ds_read2st64_b32 v[132:133], v11 offset0:72 offset1:74
    ds_read2st64_b32 v[134:135], v11 offset0:76 offset1:78
    s_add_u32 m0, s81, 8192
    s_add_u32 s18, s90, 0
    buffer_load_dwordx4 v27, s[76:79], s18 offen lds
    s_add_u32 m0, s81, 9216
    s_add_u32 s18, s90, 2304
    buffer_load_dwordx4 v27, s[76:79], s18 offen lds
    s_add_u32 m0, s81, 10240
    s_add_u32 s18, s90, 18432
    buffer_load_dwordx4 v27, s[76:79], s18 offen lds
    s_add_u32 m0, s81, 11264
    s_add_u32 s18, s90, 20736
    buffer_load_dwordx4 v27, s[76:79], s18 offen lds
    s_waitcnt vmcnt(21)
    s_waitcnt lgkmcnt(0)
    s_barrier
    ds_read2st64_b32 v[136:137], v10 offset0:80 offset1:82
    ds_read2st64_b32 v[138:139], v10 offset0:84 offset1:86
    ds_read2st64_b32 v[140:141], v11 offset0:80 offset1:82
    ds_read2st64_b32 v[142:143], v11 offset0:84 offset1:86
    s_waitcnt vmcnt(19)
    s_waitcnt lgkmcnt(0)
    s_barrier
    ds_read2st64_b32 v[144:145], v10 offset0:88 offset1:90
    ds_read2st64_b32 v[146:147], v10 offset0:92 offset1:94
    ds_read2st64_b32 v[148:149], v11 offset0:88 offset1:90
    ds_read2st64_b32 v[150:151], v11 offset0:92 offset1:94
    s_add_u32 m0, s81, 12288
    s_add_u32 s18, s90, 512
    buffer_load_dwordx4 v27, s[76:79], s18 offen lds
    s_add_u32 m0, s81, 13312
    s_add_u32 s18, s90, 2816
    buffer_load_dwordx4 v27, s[76:79], s18 offen lds
    s_add_u32 m0, s81, 14336
    s_add_u32 s18, s90, 18944
    buffer_load_dwordx4 v27, s[76:79], s18 offen lds
    s_add_u32 m0, s81, 15360
    s_add_u32 s18, s90, 21248
    buffer_load_dwordx4 v27, s[76:79], s18 offen lds
    s_waitcnt vmcnt(21)
    s_waitcnt lgkmcnt(0)
    s_barrier
    ds_read2st64_b32 v[152:153], v10 offset0:96 offset1:98
    ds_read2st64_b32 v[154:155], v10 offset0:100 offset1:102
    ds_read2st64_b32 v[156:157], v11 offset0:96 offset1:98
    ds_read2st64_b32 v[158:159], v11 offset0:100 offset1:102
    s_waitcnt vmcnt(17)
    s_waitcnt lgkmcnt(0)
    s_barrier
    ds_read2st64_b32 v[160:161], v30 offset0:104 offset1:106
    ds_read2st64_b32 v[162:163], v30 offset0:108 offset1:110
    ds_read2st64_b32 v[164:165], v30 offset0:112 offset1:114
    ds_read2st64_b32 v[166:167], v30 offset0:116 offset1:118
    ds_read2st64_b32 v[168:169], v31 offset0:104 offset1:106
    ds_read2st64_b32 v[170:171], v31 offset0:108 offset1:110
    ds_read2st64_b32 v[172:173], v31 offset0:112 offset1:114
    ds_read2st64_b32 v[174:175], v31 offset0:116 offset1:118
    s_add_u32 m0, s81, 16384
    s_add_u32 s18, s91, 0
    buffer_load_dwordx4 v27, s[76:79], s18 offen lds
    s_add_u32 m0, s81, 17408
    s_add_u32 s18, s91, 2304
    buffer_load_dwordx4 v27, s[76:79], s18 offen lds
    s_add_u32 m0, s81, 18432
    s_add_u32 s18, s91, 18432
    buffer_load_dwordx4 v27, s[76:79], s18 offen lds
    s_add_u32 m0, s81, 19456
    s_add_u32 s18, s91, 20736
    buffer_load_dwordx4 v27, s[76:79], s18 offen lds
    s_waitcnt vmcnt(16)
    s_waitcnt lgkmcnt(0)
    s_barrier
    ds_read2st64_b32 v[176:177], v30 offset0:0 offset1:2
    ds_read2st64_b32 v[178:179], v30 offset0:4 offset1:6
    ds_read2st64_b32 v[180:181], v30 offset0:8 offset1:10
    ds_read2st64_b32 v[182:183], v30 offset0:12 offset1:14
    ds_read2st64_b32 v[184:185], v31 offset0:0 offset1:2
    ds_read2st64_b32 v[186:187], v31 offset0:4 offset1:6
    ds_read2st64_b32 v[188:189], v31 offset0:8 offset1:10
    ds_read2st64_b32 v[190:191], v31 offset0:12 offset1:14
    s_add_u32 m0, s81, 20480
    s_add_u32 s18, s80, 3932160
    buffer_load_dwordx4 v26, s[60:63], s18 offen lds
    s_add_u32 m0, s81, 21504
    s_add_u32 s18, s80, 3964928
    buffer_load_dwordx4 v26, s[60:63], s18 offen lds
    s_add_u32 m0, s81, 22528
    s_add_u32 s18, s88, 0
    buffer_load_dwordx4 v27, s[76:79], s18 offen lds
    s_add_u32 m0, s81, 23552
    s_add_u32 s18, s88, 2304
    buffer_load_dwordx4 v27, s[76:79], s18 offen lds
    s_add_u32 m0, s81, 24576
    s_add_u32 s18, s88, 18432
    buffer_load_dwordx4 v27, s[76:79], s18 offen lds
    s_add_u32 m0, s81, 25600
    s_add_u32 s18, s88, 20736
    buffer_load_dwordx4 v27, s[76:79], s18 offen lds
    s_waitcnt vmcnt(18)
    s_waitcnt lgkmcnt(0)
    s_barrier
    ds_read2st64_b32 v[192:193], v30 offset0:16 offset1:18
    ds_read2st64_b32 v[194:195], v30 offset0:20 offset1:22
    ds_read2st64_b32 v[196:197], v30 offset0:24 offset1:26
    ds_read2st64_b32 v[198:199], v30 offset0:28 offset1:30
    ds_read2st64_b32 v[200:201], v31 offset0:16 offset1:18
    ds_read2st64_b32 v[202:203], v31 offset0:20 offset1:22
    ds_read2st64_b32 v[204:205], v31 offset0:24 offset1:26
    ds_read2st64_b32 v[206:207], v31 offset0:28 offset1:30
    s_add_u32 m0, s81, 0
    s_add_u32 s18, s80, 0
    buffer_load_dwordx4 v26, s[60:63], s18 offen lds
    s_add_u32 m0, s81, 1024
    s_add_u32 s18, s80, 32768
    buffer_load_dwordx4 v26, s[60:63], s18 offen lds
    s_waitcnt vmcnt(16)
    s_waitcnt lgkmcnt(0)
    s_barrier
    ds_read2st64_b32 v[208:209], v30 offset0:32 offset1:34
    ds_read2st64_b32 v[210:211], v30 offset0:36 offset1:38
    ds_read2st64_b32 v[212:213], v30 offset0:40 offset1:42
    ds_read2st64_b32 v[214:215], v30 offset0:44 offset1:46
    ds_read2st64_b32 v[216:217], v31 offset0:32 offset1:34
    ds_read2st64_b32 v[218:219], v31 offset0:36 offset1:38
    ds_read2st64_b32 v[220:221], v31 offset0:40 offset1:42
    ds_read2st64_b32 v[222:223], v31 offset0:44 offset1:46
    s_add_u32 m0, s81, 6144
    s_add_u32 s18, s80, 786432
    buffer_load_dwordx4 v26, s[60:63], s18 offen lds
    s_add_u32 m0, s81, 7168
    s_add_u32 s18, s80, 819200
    buffer_load_dwordx4 v26, s[60:63], s18 offen lds
    s_add_u32 m0, s81, 4096
    s_add_u32 s18, s80, 524288
    buffer_load_dwordx4 v26, s[60:63], s18 offen lds
    s_add_u32 m0, s81, 5120
    s_add_u32 s18, s80, 557056
    buffer_load_dwordx4 v26, s[60:63], s18 offen lds
    s_waitcnt vmcnt(16)
    s_waitcnt lgkmcnt(0)
    s_barrier
    ds_read2st64_b32 v[224:225], v30 offset0:48 offset1:50
    ds_read2st64_b32 v[226:227], v30 offset0:52 offset1:54
    ds_read2st64_b32 v[228:229], v30 offset0:56 offset1:58
    ds_read2st64_b32 v[230:231], v30 offset0:60 offset1:62
    ds_read2st64_b32 v[232:233], v31 offset0:48 offset1:50
    ds_read2st64_b32 v[234:235], v31 offset0:52 offset1:54
    ds_read2st64_b32 v[236:237], v31 offset0:56 offset1:58
    ds_read2st64_b32 v[238:239], v31 offset0:60 offset1:62
    s_add_u32 m0, s81, 10240
    s_add_u32 s18, s80, 1572864
    buffer_load_dwordx4 v26, s[60:63], s18 offen lds
    s_add_u32 m0, s81, 11264
    s_add_u32 s18, s80, 1605632
    buffer_load_dwordx4 v26, s[60:63], s18 offen lds
    s_add_u32 m0, s81, 8192
    s_add_u32 s18, s80, 1048576
    buffer_load_dwordx4 v26, s[60:63], s18 offen lds
    s_add_u32 m0, s81, 9216
    s_add_u32 s18, s80, 1081344
    buffer_load_dwordx4 v26, s[60:63], s18 offen lds
    s_waitcnt vmcnt(16)
    s_waitcnt lgkmcnt(0)
    s_barrier
    ds_read2st64_b32 v[240:241], v30 offset0:64 offset1:66
    ds_read2st64_b32 v[242:243], v30 offset0:68 offset1:70
    ds_read2st64_b32 v[244:245], v30 offset0:72 offset1:74
    ds_read2st64_b32 v[246:247], v30 offset0:76 offset1:78
    ds_read2st64_b32 v[248:249], v31 offset0:64 offset1:66
    ds_read2st64_b32 v[250:251], v31 offset0:68 offset1:70
    ds_read2st64_b32 v[252:253], v31 offset0:72 offset1:74
    ds_read2st64_b32 v[254:255], v31 offset0:76 offset1:78
    s_add_u32 m0, s81, 14336
    s_add_u32 s18, s80, 2097152
    buffer_load_dwordx4 v26, s[60:63], s18 offen lds
    s_add_u32 m0, s81, 15360
    s_add_u32 s18, s80, 2129920
    buffer_load_dwordx4 v26, s[60:63], s18 offen lds
    s_add_u32 m0, s81, 12288
    s_add_u32 s18, s80, 1835008
    buffer_load_dwordx4 v26, s[60:63], s18 offen lds
    s_add_u32 m0, s81, 13312
    s_add_u32 s18, s80, 1867776
    buffer_load_dwordx4 v26, s[60:63], s18 offen lds
    s_waitcnt vmcnt(18)
    s_waitcnt lgkmcnt(0)
    s_barrier
    ds_read2st64_b32 v[44:45], v10 offset0:80 offset1:82
    ds_read2st64_b32 v[46:47], v10 offset0:84 offset1:86
    ds_read2st64_b32 v[48:49], v11 offset0:80 offset1:82
    ds_read2st64_b32 v[50:51], v11 offset0:84 offset1:86
    s_add_u32 m0, s81, 18432
    s_add_u32 s18, s80, 3145728
    buffer_load_dwordx4 v26, s[60:63], s18 offen lds
    s_add_u32 m0, s81, 19456
    s_add_u32 s18, s80, 3178496
    buffer_load_dwordx4 v26, s[60:63], s18 offen lds
    s_waitcnt vmcnt(16)
    s_waitcnt lgkmcnt(0)
    s_barrier
    ds_write_b128 v2, v[44:47] offset:20480
    ds_write_b128 v2, v[48:51] offset:21504
    ds_read2st64_b32 v[12:13], v30 offset0:88 offset1:90
    ds_read2st64_b32 v[14:15], v30 offset0:92 offset1:94
    ds_read2st64_b32 v[16:17], v30 offset0:96 offset1:98
    ds_read2st64_b32 v[18:19], v30 offset0:100 offset1:102
    ds_read2st64_b32 v[36:37], v31 offset0:88 offset1:90
    ds_read2st64_b32 v[38:39], v31 offset0:92 offset1:94
    ds_read2st64_b32 v[40:41], v31 offset0:96 offset1:98
    ds_read2st64_b32 v[42:43], v31 offset0:100 offset1:102
    s_add_u32 m0, s81, 16384
    s_add_u32 s18, s80, 2621440
    buffer_load_dwordx4 v26, s[60:63], s18 offen lds
    s_add_u32 m0, s81, 17408
    s_add_u32 s18, s80, 2654208
    buffer_load_dwordx4 v26, s[60:63], s18 offen lds
    s_add_u32 m0, s81, 2048
    s_add_u32 s18, s80, 262144
    buffer_load_dwordx4 v26, s[60:63], s18 offen lds
    s_add_u32 m0, s81, 3072
    s_add_u32 s18, s80, 294912
    buffer_load_dwordx4 v26, s[60:63], s18 offen lds
    s_waitcnt vmcnt(18)
    s_waitcnt lgkmcnt(0)
    s_barrier
    ds_write_b128 v2, v[12:15] offset:22528
    ds_write_b128 v2, v[16:19] offset:23552
    ds_write_b128 v2, v[36:39] offset:24576
    ds_write_b128 v2, v[40:43] offset:25600
    ds_read2st64_b32 v[44:45], v10 offset0:0 offset1:2
    ds_read2st64_b32 v[46:47], v10 offset0:4 offset1:6
    ds_read2st64_b32 v[48:49], v11 offset0:0 offset1:2
    ds_read2st64_b32 v[50:51], v11 offset0:4 offset1:6
    s_add_u32 m0, s81, 26624
    s_add_u32 s18, s91, 512
    buffer_load_dwordx4 v27, s[76:79], s18 offen lds
    s_add_u32 m0, s81, 27648
    s_add_u32 s18, s91, 2816
    buffer_load_dwordx4 v27, s[76:79], s18 offen lds
    s_add_u32 m0, s81, 28672
    s_add_u32 s18, s91, 18944
    buffer_load_dwordx4 v27, s[76:79], s18 offen lds
    s_add_u32 m0, s81, 29696
    s_add_u32 s18, s91, 21248
    buffer_load_dwordx4 v27, s[76:79], s18 offen lds
    s_waitcnt vmcnt(20)
    s_waitcnt lgkmcnt(0)
    s_barrier
    ds_write_b128 v2, v[44:47] offset:0
    ds_write_b128 v2, v[48:51] offset:1024
    ds_read2st64_b32 v[12:13], v10 offset0:24 offset1:26
    ds_read2st64_b32 v[14:15], v10 offset0:28 offset1:30
    ds_read2st64_b32 v[16:17], v11 offset0:24 offset1:26
    ds_read2st64_b32 v[18:19], v11 offset0:28 offset1:30
    s_waitcnt vmcnt(18)
    s_waitcnt lgkmcnt(0)
    s_barrier
    ds_write_b128 v2, v[12:15] offset:6144
    ds_write_b128 v2, v[16:19] offset:7168
    ds_read2st64_b32 v[44:45], v10 offset0:16 offset1:18
    ds_read2st64_b32 v[46:47], v10 offset0:20 offset1:22
    ds_read2st64_b32 v[48:49], v11 offset0:16 offset1:18
    ds_read2st64_b32 v[50:51], v11 offset0:20 offset1:22
    s_waitcnt vmcnt(16)
    s_waitcnt lgkmcnt(0)
    s_barrier
    ds_write_b128 v2, v[44:47] offset:4096
    ds_write_b128 v2, v[48:51] offset:5120
    ds_read2st64_b32 v[12:13], v10 offset0:40 offset1:42
    ds_read2st64_b32 v[14:15], v10 offset0:44 offset1:46
    ds_read2st64_b32 v[16:17], v11 offset0:40 offset1:42
    ds_read2st64_b32 v[18:19], v11 offset0:44 offset1:46
    s_getpc_b64 s[8:9]
L_chpc:
    s_add_u32 s8, s8, CH_STEP - L_chpc
    s_addc_u32 s9, s9, 0
    v_lshlrev_b32 v34, 6, v20
    s_lshl_b32 s16, s13, 12
    v_add_u32 v35, s16, v34
    v_lshrrev_b32 v60, 1, v35
    global_load_dword v60, v60, s[8:9]
    s_add_u32 s16, s37, 139264
    buffer_load_dword v61, v34, s[4:7], s16 offen sc1
    s_lshl_b32 s16, s13, 14
    s_lshl_b32 s19, s12, 8
    s_add_u32 s16, s16, s19
    s_add_u32 s16, s16, 1703936
    buffer_load_dword v62, v34, s[4:7], s16 offen sc1
    s_add_u32 s16, s49, 139264
    buffer_load_dword v63, v35, s[4:7], s16 offen sc1
    s_lshl_b32 s16, s12, 7
    buffer_load_dword v9, off, s[4:7], s16 offset:0 sc1
    buffer_load_dword v64, off, s[84:87], 0 offset:8 sc1
    s_add_u32 s16, s16, 4096
    buffer_load_dword v65, off, s[4:7], s16 sc1
    s_waitcnt vmcnt(21)
    s_waitcnt lgkmcnt(0)
    s_barrier
    ds_write_b128 v2, v[12:15] offset:10240
    ds_write_b128 v2, v[16:19] offset:11264
    ds_read2st64_b32 v[44:45], v10 offset0:32 offset1:34
    ds_read2st64_b32 v[46:47], v10 offset0:36 offset1:38
    ds_read2st64_b32 v[48:49], v11 offset0:32 offset1:34
    ds_read2st64_b32 v[50:51], v11 offset0:36 offset1:38
    s_waitcnt vmcnt(19)
    s_waitcnt lgkmcnt(0)
    s_barrier
    ds_write_b128 v2, v[44:47] offset:8192
    ds_write_b128 v2, v[48:51] offset:9216
    ds_read2st64_b32 v[12:13], v10 offset0:56 offset1:58
    ds_read2st64_b32 v[14:15], v10 offset0:60 offset1:62
    ds_read2st64_b32 v[16:17], v11 offset0:56 offset1:58
    ds_read2st64_b32 v[18:19], v11 offset0:60 offset1:62
    s_waitcnt vmcnt(17)
    s_waitcnt lgkmcnt(0)
    s_barrier
    ds_write_b128 v2, v[12:15] offset:14336
    ds_write_b128 v2, v[16:19] offset:15360
    ds_read2st64_b32 v[44:45], v10 offset0:48 offset1:50
    ds_read2st64_b32 v[46:47], v10 offset0:52 offset1:54
    ds_read2st64_b32 v[48:49], v11 offset0:48 offset1:50
    ds_read2st64_b32 v[50:51], v11 offset0:52 offset1:54
    s_waitcnt vmcnt(15)
    s_waitcnt lgkmcnt(0)
    s_barrier
    ds_write_b128 v2, v[44:47] offset:12288
    ds_write_b128 v2, v[48:51] offset:13312
    ds_read2st64_b32 v[12:13], v10 offset0:72 offset1:74
    ds_read2st64_b32 v[14:15], v10 offset0:76 offset1:78
    ds_read2st64_b32 v[16:17], v11 offset0:72 offset1:74
    ds_read2st64_b32 v[18:19], v11 offset0:76 offset1:78
    s_waitcnt vmcnt(13)
    s_waitcnt lgkmcnt(0)
    s_barrier
    ds_write_b128 v2, v[12:15] offset:18432
    ds_write_b128 v2, v[16:19] offset:19456
    ds_read2st64_b32 v[44:45], v10 offset0:64 offset1:66
    ds_read2st64_b32 v[46:47], v10 offset0:68 offset1:70
    ds_read2st64_b32 v[48:49], v11 offset0:64 offset1:66
    ds_read2st64_b32 v[50:51], v11 offset0:68 offset1:70
    s_waitcnt vmcnt(11)
    s_waitcnt lgkmcnt(0)
    s_barrier
    ds_write_b128 v2, v[44:47] offset:16384
    ds_write_b128 v2, v[48:51] offset:17408
    ds_read2st64_b32 v[12:13], v10 offset0:8 offset1:10
    ds_read2st64_b32 v[14:15], v10 offset0:12 offset1:14
    ds_read2st64_b32 v[16:17], v11 offset0:8 offset1:10
    ds_read2st64_b32 v[18:19], v11 offset0:12 offset1:14
    s_waitcnt vmcnt(7)
    s_waitcnt lgkmcnt(0)
    s_barrier
    ds_write_b128 v2, v[12:15] offset:2048
    ds_write_b128 v2, v[16:19] offset:3072
    ds_read2st64_b32 v[44:45], v30 offset0:104 offset1:106
    ds_read2st64_b32 v[46:47], v30 offset0:108 offset1:110
    ds_read2st64_b32 v[48:49], v30 offset0:112 offset1:114
    ds_read2st64_b32 v[50:51], v30 offset0:116 offset1:118
    ds_read2st64_b32 v[52:53], v31 offset0:104 offset1:106
    ds_read2st64_b32 v[54:55], v31 offset0:108 offset1:110
    ds_read2st64_b32 v[56:57], v31 offset0:112 offset1:114
    ds_read2st64_b32 v[58:59], v31 offset0:116 offset1:118
    s_waitcnt lgkmcnt(0)
    s_barrier
    ds_write_b128 v2, v[44:47] offset:26624
    ds_write_b128 v2, v[48:51] offset:27648
    ds_write_b128 v2, v[52:55] offset:28672
    ds_write_b128 v2, v[56:59] offset:29696
    s_waitcnt vmcnt(0)
    s_mov_b32 s16, 2
    v_readfirstlane_b32 s17, v9
    s_nop 0
    s_cmp_ge_u32 s17, s16
    s_cbranch_scc1 L_kvokinit_13
    s_mov_b32 s45, 131072
    s_lshl_b32 s18, s12, 7
L_kvwinit_12:
    buffer_load_dword v9, off, s[4:7], s18 offset:0 sc1
    s_sub_u32 s45, s45, 1
    s_cbranch_scc1 ABORT
    s_waitcnt vmcnt(0)
    v_readfirstlane_b32 s17, v9
    s_nop 0
    s_cmp_ge_u32 s17, s16
    s_cbranch_scc0 L_kvwinit_12
L_kvokinit_13:
    s_lshl_b32 s16, s13, 11
    s_add_u32 s26, s16, 154880
    s_mov_b32 m0, s26
    s_sub_u32 s100, s43, 32768
    s_add_u32 s43, s43, s16
    s_sub_u32 s43, s43, 139264
    s_add_u32 s48, s43, 8192
    buffer_load_dwordx4 v1, s[4:7], s43 offen sc1 lds
    buffer_load_dwordx4 v1, s[4:7], s43 offen offset:1024 sc1 lds
    s_add_u32 s43, s43, 524288
    v_readfirstlane_b32 s17, v64
    s_nop 0
    s_cmp_ge_u32 s17, 32
    s_cbranch_scc1 L_rdyok_11
    s_mov_b32 s45, 131072
L_rdy_10:
    buffer_load_dword v21, off, s[84:87], 0 offset:8 sc1
    s_sub_u32 s45, s45, 1
    s_cbranch_scc1 ABORT
    s_waitcnt vmcnt(0)
    v_readfirstlane_b32 s17, v21
    s_nop 0
    s_cmp_ge_u32 s17, 32
    s_cbranch_scc0 L_rdy_10
L_rdyok_11:
    v_readfirstlane_b32 s17, v65
    s_nop 0
    s_cmp_ge_u32 s17, 1
    s_cbranch_scc1 L_poi_ok
    s_mov_b32 s45, 131072
    s_lshl_b32 s16, s12, 7
    s_add_u32 s16, s16, 4096
L_poi:
    buffer_load_dword v21, off, s[4:7], s16 sc1
    s_sub_u32 s45, s45, 1
    s_cbranch_scc1 ABORT
    s_waitcnt vmcnt(0)
    v_readfirstlane_b32 s17, v21
    s_nop 0
    s_cmp_ge_u32 s17, 1
    s_cbranch_scc0 L_poi
L_poi_ok:
    s_mov_b32 s14, 0
    s_mov_b32 s40, 1
    s_mov_b32 s42, 1703936
    s_mov_b32 s41, 1720320
    v_lshrrev_b32 v11, 2, v7
    v_add_u32 v11, 104448, v11
    s_mov_b32 m0, s2
    s_lshl_b32 s27, s12, 7
    s_add_u32 s15, s27, 4096
    s_lshl_b32 s2, s13, 10
    s_add_u32 s2, s2, 149760
    s_lshl_b32 s3, s13, 8
    s_add_u32 s3, s3, 153856
    s_mov_b32 s97, 131072
    s_mov_b32 s8, 0x3f803f80
    s_mov_b32 s9, 0x3f803f80
    s_mov_b32 s10, 0x3f003f00
    s_mov_b32 s11, 0x3f003f00
    s_mov_b64 s[98:99], 0
    s_waitcnt lgkmcnt(0)
    ds_read_b128 v[48:51], v2 offset:0
    ds_read_b128 v[52:55], v2 offset:1024
    ds_read_b128 v[56:59], v2 offset:2048
    ds_read_b128 v[60:63], v2 offset:3072
    ds_read_b128 v[64:67], v2 offset:4096
    ds_read_b128 v[68:71], v2 offset:5120
    v_mov_b64 v[36:37], 0
    v_mov_b64 v[38:39], 0
    v_mov_b64 v[40:41], 0
    v_mov_b64 v[42:43], 0
    v_mov_b64 v[44:45], 0
    v_mov_b64 v[46:47], 0
    s_mov_b32 m0, s2
    s_waitcnt lgkmcnt(0)
.p2align 6
CH_STEP:
    s_waitcnt lgkmcnt(0)
    s_barrier
    ds_read_b128 v[20:23], v3 offset:6400
    ds_read_b128 v[24:27], v3 offset:6912
    ds_read_b128 v[28:31], v3 offset:7424
    ds_read_b128 v[32:35], v3 offset:7936
    s_waitcnt lgkmcnt(3)
    v_smfmac_f32_16x16x64_bf16 v[40:43], v[20:23], a[0:7], v0
    buffer_load_dwordx4 v7, s[4:7], s49 offen sc1 lds
    s_mov_b32 m0, s3
    v_smfmac_f32_16x16x64_bf16 v[36:39], v[20:23], v[48:55], v0
    ds_read_b128 v[48:51], v2 offset:6144
    buffer_load_dword v11, s[4:7], s36 offen sc1 lds
    v_smfmac_f32_16x16x64_bf16 v[44:47], v[20:23], a[144:151], v0
    ds_read_b128 v[20:23], v3 offset:8448
    s_waitcnt lgkmcnt(4)
    v_smfmac_f32_16x16x64_bf16 v[40:43], v[24:27], a[8:15], v0
    ds_read_b128 v[52:55], v2 offset:7168
    v_smfmac_f32_16x16x64_bf16 v[36:39], v[24:27], v[56:63], v0
    ds_read_b128 v[56:59], v2 offset:8192
    v_smfmac_f32_16x16x64_bf16 v[44:47], v[24:27], a[152:159], v0
    ds_read_b128 v[24:27], v3 offset:8960
    s_waitcnt lgkmcnt(6)
    v_smfmac_f32_16x16x64_bf16 v[40:43], v[28:31], a[16:23], v0
    ds_read_b128 v[60:63], v2 offset:9216
    v_smfmac_f32_16x16x64_bf16 v[36:39], v[28:31], v[64:71], v0
    ds_read_b128 v[64:67], v2 offset:10240
    v_smfmac_f32_16x16x64_bf16 v[44:47], v[28:31], a[160:167], v0
    ds_read_b128 v[28:31], v3 offset:9472
    s_waitcnt lgkmcnt(8)
    v_smfmac_f32_16x16x64_bf16 v[40:43], v[32:35], a[24:31], v0
    ds_read_b128 v[68:71], v2 offset:11264
    s_waitcnt lgkmcnt(6)
    v_smfmac_f32_16x16x64_bf16 v[36:39], v[32:35], v[48:55], v0
    ds_read_b128 v[48:51], v2 offset:12288
    v_smfmac_f32_16x16x64_bf16 v[44:47], v[32:35], a[168:175], v0
    ds_read_b128 v[32:35], v3 offset:9984
    v_smfmac_f32_16x16x64_bf16 v[40:43], v[20:23], a[32:39], v0
    ds_read_b128 v[52:55], v2 offset:13312
    s_waitcnt lgkmcnt(6)
    v_smfmac_f32_16x16x64_bf16 v[36:39], v[20:23], v[56:63], v0
    ds_read_b128 v[56:59], v2 offset:14336
    v_smfmac_f32_16x16x64_bf16 v[44:47], v[20:23], a[176:183], v0
    ds_read_b128 v[60:63], v2 offset:15360
    v_smfmac_f32_16x16x64_bf16 v[40:43], v[24:27], a[40:47], v0
    s_mov_b32 m0, s26
    v_smfmac_f32_16x16x64_bf16 v[36:39], v[24:27], v[104:111], v0
    s_waitcnt vmcnt(0)
    v_lshlrev_b32 v9, 2, v7
    v_smfmac_f32_16x16x64_bf16 v[44:47], v[24:27], a[184:191], v0
    s_barrier
    ds_read_b128 v[20:23], v3 offset:10496
    s_waitcnt lgkmcnt(7)
    v_smfmac_f32_16x16x64_bf16 v[40:43], v[28:31], a[48:55], v0
    ds_read_b128 v[24:27], v3 offset:11008
    s_waitcnt lgkmcnt(7)
    v_smfmac_f32_16x16x64_bf16 v[36:39], v[28:31], v[64:71], v0
    ds_read_b128 v[64:67], v2 offset:16384
    v_smfmac_f32_16x16x64_bf16 v[44:47], v[28:31], a[192:199], v0
    ds_read_b128 v[28:31], v3 offset:11520
    s_waitcnt lgkmcnt(7)
    v_smfmac_f32_16x16x64_bf16 v[40:43], v[32:35], a[56:63], v0
    ds_read_b128 v[68:71], v2 offset:17408
    s_waitcnt lgkmcnt(7)
    v_smfmac_f32_16x16x64_bf16 v[36:39], v[32:35], v[48:55], v0
    ds_read_b128 v[48:51], v2 offset:18432
    buffer_load_dwordx4 v[12:15], v1, s[4:7], s48 offen sc1
    v_smfmac_f32_16x16x64_bf16 v[44:47], v[32:35], a[200:207], v0
    ds_read_b128 v[32:35], v3 offset:12032
    s_waitcnt lgkmcnt(6)
    v_smfmac_f32_16x16x64_bf16 v[40:43], v[20:23], a[64:71], v0
    ds_read_b128 v[52:55], v2 offset:19456
    v_smfmac_f32_16x16x64_bf16 v[36:39], v[20:23], v[56:63], v0
    ds_read_b128 v[56:59], v2 offset:20480
    buffer_load_dwordx4 v[16:19], v1, s[4:7], s48 offen offset:1024 sc1
    v_smfmac_f32_16x16x64_bf16 v[44:47], v[20:23], a[208:215], v0
    ds_read_b128 v[20:23], v3 offset:12544
    s_waitcnt lgkmcnt(8)
    v_smfmac_f32_16x16x64_bf16 v[40:43], v[24:27], a[72:79], v0
    ds_read_b128 v[60:63], v2 offset:21504
    v_smfmac_f32_16x16x64_bf16 v[36:39], v[24:27], v[112:119], v0
    buffer_load_dword v9, v9, s[4:7], s100 offen sc1
    v_smfmac_f32_16x16x64_bf16 v[44:47], v[24:27], a[216:223], v0
    ds_read_b128 v[24:27], v3 offset:13056
    s_waitcnt lgkmcnt(8)
    v_smfmac_f32_16x16x64_bf16 v[40:43], v[28:31], a[80:87], v0
    s_waitcnt lgkmcnt(7)
    v_smfmac_f32_16x16x64_bf16 v[36:39], v[28:31], v[64:71], v0
    ds_read_b128 v[28:31], v3 offset:13568
    s_waitcnt lgkmcnt(6)
    v_smfmac_f32_16x16x64_bf16 v[40:43], v[32:35], a[88:95], v0
    ds_read_b128 v[64:67], v1 offset:17664
    buffer_load_dword v9, off, s[4:7], s27 offset:0 sc1
    v_smfmac_f32_16x16x64_bf16 v[36:39], v[32:35], v[120:127], v0
    ds_read_b128 v[32:35], v3 offset:14080
    s_waitcnt lgkmcnt(5)
    v_smfmac_f32_16x16x64_bf16 v[40:43], v[20:23], a[96:103], v0
    ds_read_b128 v[68:71], v1 offset:18688
    v_smfmac_f32_16x16x64_bf16 v[36:39], v[20:23], v[48:55], v0
    ds_read_b128 v[20:23], v3 offset:14592
    s_waitcnt lgkmcnt(5)
    v_smfmac_f32_16x16x64_bf16 v[40:43], v[24:27], a[104:111], v0
    ds_read_b128 v[48:51], v1 offset:15616
    v_smfmac_f32_16x16x64_bf16 v[36:39], v[24:27], v[128:135], v0
    ds_read_b128 v[24:27], v3 offset:15104
    s_waitcnt lgkmcnt(6)
    v_smfmac_f32_16x16x64_bf16 v[40:43], v[28:31], a[112:119], v0
    ds_read_b128 v[52:55], v1 offset:16640
    v_smfmac_f32_16x16x64_bf16 v[36:39], v[28:31], v[136:143], v0
    s_waitcnt lgkmcnt(5)
    v_smfmac_f32_16x16x64_bf16 v[40:43], v[32:35], a[120:127], v0
    s_waitcnt lgkmcnt(3)
    v_smfmac_f32_16x16x64_bf16 v[40:43], v[20:23], a[128:135], v0
    s_waitcnt lgkmcnt(1)
    v_smfmac_f32_16x16x64_bf16 v[40:43], v[24:27], a[136:143], v0
    s_nop 2
    v_smfmac_f32_16x16x64_bf16 v[36:39], v[32:35], v[56:63], v0
    s_nop 2
    v_smfmac_f32_16x16x64_bf16 v[36:39], v[20:23], v[144:151], v0
    v_cvt_pk_bf16_f32 v40, v40, v41
    v_smfmac_f32_16x16x64_bf16 v[36:39], v[24:27], v[152:159], v0
    v_cvt_pk_bf16_f32 v41, v42, v43
    v_smfmac_f32_16x16x64_bf16 v[44:47], v[28:31], v[72:79], v0
    ds_write_b64 v4, v[40:41]
    ds_read_b128 v[28:31], v3 offset:11520
    v_smfmac_f32_16x16x64_bf16 v[44:47], v[32:35], v[80:87], v0
    ds_read_b128 v[32:35], v3 offset:12032
    v_smfmac_f32_16x16x64_bf16 v[44:47], v[20:23], v[88:95], v0
    ds_read_b128 v[20:23], v3 offset:12544
    v_cmp_u_f32 s[16:17], v36, v37
    v_smfmac_f32_16x16x64_bf16 v[44:47], v[24:27], v[96:103], v0
    ds_read_b128 v[24:27], v3 offset:13056
    s_waitcnt lgkmcnt(3)
    v_smfmac_f32_16x16x64_bf16 v[44:47], v[28:31], a[224:231], v0
    s_barrier
    ds_read_b64_tr_b16 v[40:41], v5 offset:0
    ds_read_b64_tr_b16 v[42:43], v5 offset:16
    s_waitcnt lgkmcnt(4)
    v_smfmac_f32_16x16x64_bf16 v[44:47], v[32:35], a[232:239], v0
    s_waitcnt lgkmcnt(2)
    ds_read_b64_tr_b16 v[56:57], v5 offset:544
    ds_read_b64_tr_b16 v[58:59], v5 offset:560
    v_smfmac_f32_16x16x64_bf16 v[44:47], v[20:23], a[240:247], v0
    ds_read_b64_tr_b16 v[60:61], v5 offset:1088
    ds_read_b64_tr_b16 v[62:63], v5 offset:1104
    v_smfmac_f32_16x16x64_bf16 v[44:47], v[24:27], a[248:255], v0
    s_waitcnt lgkmcnt(4)
    ds_read_b64_tr_b16 v[32:33], v5 offset:1632
    ds_read_b64_tr_b16 v[34:35], v5 offset:1648
    v_mfma_f32_16x16x32_bf16 v[24:27], v[48:51], v[40:43], 0
    ds_read_b128 v[48:51], v1 offset:19712
    v_cmp_u_f32 vcc, v38, v39
    v_mfma_f32_16x16x32_bf16 v[28:31], v[52:55], v[40:43], 0
    s_waitcnt lgkmcnt(5)
    v_cvt_pk_bf16_f32 v10, v44, v45
    v_cvt_pk_bf16_f32 v11, v46, v47
    v_mfma_f32_16x16x32_bf16 v[24:27], v[64:67], v[56:59], v[24:27]
    ds_write_b64 v4, v[10:11] offset:2176
    ds_read_b128 v[52:55], v1 offset:20736
    v_mfma_f32_16x16x32_bf16 v[28:31], v[68:71], v[56:59], v[28:31]
    s_waitcnt lgkmcnt(2)
    ds_read_b128 v[64:67], v1 offset:21760
    ds_read_b128 v[68:71], v1 offset:22784
    v_mfma_f32_16x16x32_bf16 v[24:27], v[48:51], v[60:63], v[24:27]
    s_or_b64 vcc, vcc, s[16:17]
    v_cvt_pk_bf16_f32 v36, v36, v37
    v_cvt_pk_bf16_f32 v37, v38, v39
    s_waitcnt lgkmcnt(2)
    v_mfma_f32_16x16x32_bf16 v[28:31], v[52:55], v[60:63], v[28:31]
    s_or_b64 s[16:17], vcc, s[98:99]
    s_cbranch_scc1 CH_SCAN
CH_SCAN_OK:
    s_waitcnt lgkmcnt(1)
    v_mfma_f32_16x16x32_bf16 v[24:27], v[64:67], v[32:35], v[24:27]
    s_barrier
    ds_read_b64_tr_b16 v[44:45], v5 offset:2176
    ds_read_b64_tr_b16 v[46:47], v5 offset:2192
    s_waitcnt lgkmcnt(2)
    v_mfma_f32_16x16x32_bf16 v[28:31], v[68:71], v[32:35], v[28:31]
    ds_read_b64_tr_b16 v[48:49], v5 offset:2720
    ds_read_b64_tr_b16 v[50:51], v5 offset:2736
    v_mov_b64 v[38:39], v[10:11]
    ds_read_b64_tr_b16 v[52:53], v5 offset:3264
    ds_read_b64_tr_b16 v[54:55], v5 offset:3280
    v_cndmask_b32 v10, 0, v36, s[24:25]
    ds_read_b64_tr_b16 v[64:65], v5 offset:3808
    ds_read_b64_tr_b16 v[66:67], v5 offset:3824
    v_cndmask_b32 v11, 0, v37, s[24:25]
    s_waitcnt lgkmcnt(6)
    v_mfma_f32_16x16x32_bf16 v[20:23], v[44:47], v[40:43], 0
    s_waitcnt lgkmcnt(4)
    buffer_store_dwordx4 v[36:39], v1, s[4:7], s44 offen sc1
    v_max3_f32 v68, v24, v25, v26
    v_mfma_f32_16x16x32_bf16 v[20:23], v[48:51], v[56:59], v[20:23]
    s_waitcnt lgkmcnt(2)
    v_max3_f32 v69, v27, v28, v29
    v_max3_f32 v68, v68, v30, v31
    v_mfma_f32_16x16x32_bf16 v[20:23], v[52:55], v[60:63], v[20:23]
    s_waitcnt lgkmcnt(0)
    v_max_f32 v70, v68, v69
    v_max_f32 v71, v68, v69
    v_mfma_f32_16x16x32_bf16 v[20:23], v[64:67], v[32:35], v[20:23]
    v_cndmask_b32 v38, v36, 0, s[24:25]
    v_permlane32_swap_b32 v70, v71
    v_max_f32 v70, v70, v71
    v_cndmask_b32 v39, v37, 0, s[24:25]
    v_mov_b64 v[36:37], s[10:11]
    v_mov_b64 v[32:33], s[8:9]
    v_mov_b64 v[34:35], s[8:9]
    s_nop 0
    v_max3_f32 v70, v70, v20, v21
    v_max3_f32 v68, v70, v22, v23
    v_max3_f32 v69, v70, v22, v23
    s_nop 1
    v_permlane16_swap_b32 v68, v69
    v_max_f32 v68, v68, v69
    v_mul_f32 v68, s46, v68
    v_pk_fma_f32 v[24:25], v[24:25], s[46:47], v[68:69] op_sel_hi:[1,0,0] neg_lo:[0,0,1] neg_hi:[0,0,1]
    v_pk_fma_f32 v[26:27], v[26:27], s[46:47], v[68:69] op_sel_hi:[1,0,0] neg_lo:[0,0,1] neg_hi:[0,0,1]
    v_pk_fma_f32 v[28:29], v[28:29], s[46:47], v[68:69] op_sel_hi:[1,0,0] neg_lo:[0,0,1] neg_hi:[0,0,1]
    v_pk_fma_f32 v[30:31], v[30:31], s[46:47], v[68:69] op_sel_hi:[1,0,0] neg_lo:[0,0,1] neg_hi:[0,0,1]
    v_pk_fma_f32 v[20:21], v[20:21], s[46:47], v[68:69] op_sel_hi:[1,0,0] neg_lo:[0,0,1] neg_hi:[0,0,1]
    v_pk_fma_f32 v[22:23], v[22:23], s[46:47], v[68:69] op_sel_hi:[1,0,0] neg_lo:[0,0,1] neg_hi:[0,0,1]
    v_exp_f32 v24, v24
    v_exp_f32 v25, v25
    v_exp_f32 v26, v26
    v_exp_f32 v27, v27
    v_exp_f32 v28, v28
    v_exp_f32 v29, v29
    v_exp_f32 v30, v30
    v_exp_f32 v31, v31
    v_cvt_pk_bf16_f32 v24, v24, v25
    v_cvt_pk_bf16_f32 v25, v26, v27
    v_cvt_pk_bf16_f32 v26, v28, v29
    v_cvt_pk_bf16_f32 v27, v30, v31
    v_exp_f32 v20, v20
    s_waitcnt vmcnt(3)
    v_mfma_f32_16x16x32_bf16 v[44:47], v[12:15], v[24:27], 0
    ds_read_b128 v[56:59], v2 offset:22528
    v_exp_f32_e64 v21, v21
    v_mfma_f32_16x16x32_bf16 v[48:51], v[16:19], v[24:27], 0
    ds_read_b128 v[60:63], v2 offset:23552
    v_exp_f32_e64 v22, v22
    v_mfma_f32_16x16x32_bf16 v[52:55], v[32:35], v[24:27], 0
    ds_read_b128 v[64:67], v2 offset:24576
    v_exp_f32_e64 v23, v23
    v_cvt_pk_bf16_f32 v20, v20, v21
    v_cvt_pk_bf16_f32 v21, v22, v23
    v_xor_b32 v33, s20, v3
    v_mov_b64 v[24:25], 0
    v_mfma_f32_16x16x16_bf16 v[52:55], v[36:37], v[20:21], v[52:55]
    ds_read_b128 v[68:71], v2 offset:25600
    v_mov_b64_e64 v[26:27], 0
    v_mfma_f32_16x16x16_bf16 v[44:47], v[10:11], v[20:21], v[44:47]
    v_mov_b64 v[28:29], 0
    v_mov_b64 v[30:31], 0
    v_mfma_f32_16x16x16_bf16 v[48:51], v[38:39], v[20:21], v[48:51]
    v_mov_b64 v[22:23], 0
    v_mov_b64 v[20:21], 0
    v_rcp_f32 v52, v52
    v_mov_b64 v[36:37], 0
    v_mov_b64_e64 v[38:39], 0
    v_pk_mul_f32 v[44:45], v[44:45], v[52:53] op_sel_hi:[1,0]
    v_pk_mul_f32 v[46:47], v[46:47], v[52:53] op_sel_hi:[1,0]
    s_nop 0
    v_pk_mul_f32 v[48:49], v[48:49], v[52:53] op_sel_hi:[1,0]
    v_pk_mul_f32 v[50:51], v[50:51], v[52:53] op_sel_hi:[1,0]
    v_cvt_pk_bf16_f32 v40, v44, v48
    v_cvt_pk_bf16_f32 v41, v45, v49
    v_cvt_pk_bf16_f32 v42, v46, v50
    v_cvt_pk_bf16_f32 v43, v47, v51
    s_mov_b64 exec, s[50:51]
    ds_write_b128 v33, v[40:43] offset:0
    s_mov_b64 exec, -1
    s_cmp_ge_u32 s13, 2
    s_cbranch_scc1 L_wo4_16
    s_waitcnt lgkmcnt(3)
    v_smfmac_f32_16x16x64_bf16 v[20:23], v[40:43], v[56:63], v0
    s_waitcnt lgkmcnt(1)
    ds_read_b128 v[12:15], v2 offset:30720
    v_xor_b32 v44, s21, v3
    v_smfmac_f32_16x16x64_bf16 v[24:27], v[40:43], v[64:71], v0
    ds_read_b128 v[16:19], v2 offset:31744
    v_xor_b32_e64 v48, s22, v3
    v_smfmac_f32_16x16x64_bf16 v[28:31], v[40:43], v[160:167], v0
    v_xor_b32_e64 v32, s23, v3
    s_waitcnt lgkmcnt(2)
    s_barrier
    ds_read_b128 v[44:47], v44 offset:0
    ds_read_b128 v[48:51], v48 offset:0
    ds_read_b128 v[32:35], v32 offset:0
    v_mov_b64 v[52:53], 0
    v_mov_b64 v[54:55], 0
    v_smfmac_f32_16x16x64_bf16 v[36:39], v[40:43], v[168:175], v0
    s_waitcnt lgkmcnt(3)
    v_smfmac_f32_16x16x64_bf16 v[52:55], v[40:43], v[12:19], v0
    s_waitcnt lgkmcnt(2)
    v_smfmac_f32_16x16x64_bf16 v[20:23], v[44:47], v[176:183], v0
    ds_read_b128 v[56:59], v2 offset:32768
    s_waitcnt lgkmcnt(2)
    v_smfmac_f32_16x16x64_bf16 v[20:23], v[48:51], v[208:215], v0
    ds_read_b128 v[60:63], v2 offset:33792
    s_waitcnt lgkmcnt(2)
    v_smfmac_f32_16x16x64_bf16 v[20:23], v[32:35], v[240:247], v0
    s_nop 0
    ds_read_b128 v[64:67], v2 offset:34816
    v_smfmac_f32_16x16x64_bf16 v[24:27], v[44:47], v[184:191], v0
    s_nop 0
    ds_read_b128 v[68:71], v2 offset:35840
    v_smfmac_f32_16x16x64_bf16 v[24:27], v[48:51], v[216:223], v0
    ds_read_b128 v[12:15], v2 offset:36864
    v_smfmac_f32_16x16x64_bf16 v[24:27], v[32:35], v[248:255], v0
    ds_read_b128 v[16:19], v2 offset:37888
    v_cvt_pk_bf16_f32 v20, v20, v21
    v_cvt_pk_bf16_f32 v21, v22, v23
    v_and_or_b32 v20, v20, -2, s40
    buffer_store_dwordx2 v[20:21], v6, s[4:7], s31 offen
    s_nop 1
    v_mov_b32 v6, v6
    v_cvt_pk_bf16_f32 v24, v24, v25
    v_cvt_pk_bf16_f32 v25, v26, v27
    v_and_or_b32 v24, v24, -2, s40
    buffer_store_dwordx2 v[24:25], v6, s[4:7], s32 offen
    s_waitcnt lgkmcnt(4)
    v_smfmac_f32_16x16x64_bf16 v[52:55], v[44:47], v[56:63], v0
    ds_read_b128 v[56:59], v2 offset:26624
    s_waitcnt lgkmcnt(3)
    v_smfmac_f32_16x16x64_bf16 v[52:55], v[48:51], v[64:71], v0
    ds_read_b128 v[60:63], v2 offset:27648
    s_waitcnt lgkmcnt(2)
    v_smfmac_f32_16x16x64_bf16 v[52:55], v[32:35], v[12:19], v0
    s_nop 0
    ds_read_b128 v[64:67], v2 offset:28672
    s_nop 0
    v_smfmac_f32_16x16x64_bf16 v[28:31], v[44:47], v[192:199], v0
    s_nop 0
    ds_read_b128 v[68:71], v2 offset:29696
    s_nop 0
    v_smfmac_f32_16x16x64_bf16 v[28:31], v[48:51], v[224:231], v0
    s_waitcnt lgkmcnt(2)
    v_cvt_pk_bf16_f32 v52, v52, v53
    v_cvt_pk_bf16_f32 v53, v54, v55
    v_smfmac_f32_16x16x64_bf16 v[28:31], v[32:35], v[56:63], v0
    s_nop 0
    v_and_or_b32 v52, v52, -2, s40
    buffer_store_dwordx2 v[52:53], v6, s[4:7], s35 offen
    v_smfmac_f32_16x16x64_bf16 v[36:39], v[44:47], v[200:207], v0
    s_nop 0
    buffer_load_dwordx4 v1, s[4:7], s43 offen offset:0 sc1 lds
    s_nop 0
    v_smfmac_f32_16x16x64_bf16 v[36:39], v[48:51], v[232:239], v0
    s_waitcnt lgkmcnt(0)
    buffer_load_dwordx4 v1, s[4:7], s43 offen offset:1024 sc1 lds
    v_cvt_pk_bf16_f32 v28, v28, v29
    v_cvt_pk_bf16_f32 v29, v30, v31
    v_smfmac_f32_16x16x64_bf16 v[36:39], v[32:35], v[64:71], v0
    v_and_or_b32 v28, v28, -2, s40
    buffer_store_dwordx2 v[28:29], v6, s[4:7], s33 offen
    s_nop 1
    v_mov_b32 v6, v6
    s_nop 1
    v_mov_b32 v6, v6
    v_cvt_pk_bf16_f32 v36, v36, v37
    v_cvt_pk_bf16_f32 v37, v38, v39
    v_and_or_b32 v36, v36, -2, s40
    buffer_store_dwordx2 v[36:37], v6, s[4:7], s34 offen
    s_branch L_wodone_17
L_wo4_16:
    s_waitcnt lgkmcnt(3)
    v_smfmac_f32_16x16x64_bf16 v[20:23], v[40:43], v[56:63], v0
    s_waitcnt lgkmcnt(1)
    ds_read_b128 v[12:15], v2 offset:26624
    v_xor_b32 v44, s21, v3
    v_smfmac_f32_16x16x64_bf16 v[24:27], v[40:43], v[64:71], v0
    ds_read_b128 v[16:19], v2 offset:27648
    v_xor_b32_e64 v48, s22, v3
    v_smfmac_f32_16x16x64_bf16 v[28:31], v[40:43], v[160:167], v0
    v_xor_b32_e64 v32, s23, v3
    s_waitcnt lgkmcnt(2)
    s_barrier
    ds_read_b128 v[44:47], v44 offset:0
    ds_read_b128 v[48:51], v48 offset:0
    ds_read_b128 v[32:35], v32 offset:0
    v_smfmac_f32_16x16x64_bf16 v[36:39], v[40:43], v[168:175], v0
    s_waitcnt lgkmcnt(2)
    v_smfmac_f32_16x16x64_bf16 v[20:23], v[44:47], v[176:183], v0
    ds_read_b128 v[56:59], v2 offset:28672
    s_waitcnt lgkmcnt(2)
    v_smfmac_f32_16x16x64_bf16 v[20:23], v[48:51], v[208:215], v0
    ds_read_b128 v[60:63], v2 offset:29696
    s_waitcnt lgkmcnt(2)
    v_smfmac_f32_16x16x64_bf16 v[20:23], v[32:35], v[240:247], v0
    s_nop 1
    v_smfmac_f32_16x16x64_bf16 v[24:27], v[44:47], v[184:191], v0
    s_nop 1
    v_smfmac_f32_16x16x64_bf16 v[24:27], v[48:51], v[216:223], v0
    v_smfmac_f32_16x16x64_bf16 v[24:27], v[32:35], v[248:255], v0
    s_nop 0
    v_cvt_pk_bf16_f32 v20, v20, v21
    v_cvt_pk_bf16_f32 v21, v22, v23
    v_and_or_b32 v20, v20, -2, s40
    buffer_store_dwordx2 v[20:21], v6, s[4:7], s31 offen
    s_nop 1
    v_mov_b32 v6, v6
    v_cvt_pk_bf16_f32 v24, v24, v25
    v_cvt_pk_bf16_f32 v25, v26, v27
    v_and_or_b32 v24, v24, -2, s40
    buffer_store_dwordx2 v[24:25], v6, s[4:7], s32 offen
    v_smfmac_f32_16x16x64_bf16 v[28:31], v[44:47], v[192:199], v0
    v_smfmac_f32_16x16x64_bf16 v[28:31], v[48:51], v[224:231], v0
    v_smfmac_f32_16x16x64_bf16 v[28:31], v[32:35], v[12:19], v0
    s_nop 2
    v_smfmac_f32_16x16x64_bf16 v[36:39], v[44:47], v[200:207], v0
    s_nop 0
    buffer_load_dwordx4 v1, s[4:7], s43 offen offset:0 sc1 lds
    s_nop 0
    v_smfmac_f32_16x16x64_bf16 v[36:39], v[48:51], v[232:239], v0
    s_waitcnt lgkmcnt(0)
    buffer_load_dwordx4 v1, s[4:7], s43 offen offset:1024 sc1 lds
    v_cvt_pk_bf16_f32 v28, v28, v29
    v_cvt_pk_bf16_f32 v29, v30, v31
    v_smfmac_f32_16x16x64_bf16 v[36:39], v[32:35], v[56:63], v0
    v_and_or_b32 v28, v28, -2, s40
    buffer_store_dwordx2 v[28:29], v6, s[4:7], s33 offen
    s_nop 1
    v_mov_b32 v6, v6
    s_nop 1
    v_mov_b32 v6, v6
    v_cvt_pk_bf16_f32 v36, v36, v37
    v_cvt_pk_bf16_f32 v37, v38, v39
    v_and_or_b32 v36, v36, -2, s40
    buffer_store_dwordx2 v[36:37], v6, s[4:7], s34 offen
L_wodone_17:
    s_cmp_eq_u32 s39, 0
    s_cbranch_scc1 L_nored_18
    v_bfe_u32 v40, v3, 6, 1
    v_lshlrev_b32_e64 v40, 4, v40
    v_lshlrev_b32_e64 v40, v40, s47
    v_cndmask_b32 v12, v40, 0, s[28:29]
    v_cndmask_b32 v13, 0, v40, s[28:29]
    v_mov_b64 v[14:15], v[12:13]
    v_mov_b64 v[16:17], 0
    v_mov_b64 v[18:19], 0
    s_mov_b32 s19, s40
    s_add_u32 s17, s41, s38
    s_add_u32 s18, s42, s38
    s_cmp_eq_u32 s13, 2
    s_cbranch_scc1 L_dl_22
    s_cmp_eq_u32 s13, 3
    s_cbranch_scc1 L_dl_23
    v_mov_b32 v6, v6
    s_nop 2
    v_mov_b32 v6, v6
    s_nop 2
    v_mov_b32 v6, v6
    s_nop 2
    v_mov_b32 v6, v6
    s_nop 2
    v_mov_b32 v6, v6
    s_nop 2
    v_mov_b32 v6, v6
    s_nop 2
    v_mov_b32 v6, v6
    s_nop 2
    v_mov_b32 v6, v6
    s_nop 2
    v_mov_b32 v6, v6
    s_nop 2
    v_mov_b32 v6, v6
    s_nop 2
    v_mov_b32 v6, v6
    s_nop 2
    v_mov_b32 v6, v6
    s_nop 2
    v_mov_b32 v6, v6
    s_nop 2
    v_mov_b32 v6, v6
    s_nop 2
    v_mov_b32 v6, v6
    s_nop 2
    v_mov_b32 v6, v6
    s_nop 2
    v_mov_b32 v6, v6
    s_nop 2
    v_mov_b32 v6, v6
    s_nop 2
    s_branch L_dl_24
L_dl_23:
    v_mov_b32 v6, v6
    s_nop 2
    v_mov_b32 v6, v6
    s_nop 2
    v_mov_b32 v6, v6
    s_nop 2
    v_mov_b32 v6, v6
    s_nop 2
    v_mov_b32 v6, v6
    s_nop 2
    v_mov_b32 v6, v6
    s_nop 2
    v_mov_b32 v6, v6
    s_nop 2
    v_mov_b32 v6, v6
    s_nop 2
    v_mov_b32 v6, v6
    s_nop 2
    v_mov_b32 v6, v6
    s_nop 2
    v_mov_b32 v6, v6
    s_nop 2
    v_mov_b32 v6, v6
    s_nop 2
    v_mov_b32 v6, v6
    s_nop 2
    v_mov_b32 v6, v6
    s_nop 2
    v_mov_b32 v6, v6
    s_nop 2
    v_mov_b32 v6, v6
    s_nop 2
    v_mov_b32 v6, v6
    s_nop 2
    v_mov_b32 v6, v6
    s_nop 2
    v_mov_b32 v6, v6
    s_nop 2
    v_mov_b32 v6, v6
    s_nop 2
    v_mov_b32 v6, v6
    s_nop 2
    v_mov_b32 v6, v6
    s_nop 2
    s_branch L_dl_24
L_dl_22:
    v_mov_b32 v6, v6
    s_nop 2
    v_mov_b32 v6, v6
    s_nop 2
    v_mov_b32 v6, v6
    s_nop 2
    v_mov_b32 v6, v6
    s_nop 2
    v_mov_b32 v6, v6
    s_nop 2
    v_mov_b32 v6, v6
    s_nop 2
    v_mov_b32 v6, v6
    s_nop 2
    v_mov_b32 v6, v6
    s_nop 2
L_dl_24:
    buffer_load_dwordx4 v[20:23], v1, s[4:7], s37 offen offset:0 sc1
    buffer_load_dwordx4 v[24:27], v1, s[4:7], s37 offen offset:1024 sc1
    buffer_load_dwordx4 v[28:31], v1, s[4:7], s37 offen offset:2048 sc1
    buffer_load_dwordx4 v[32:35], v1, s[4:7], s37 offen offset:3072 sc1
    ds_read_b128 v[48:51], v2 offset:0
    ds_read_b128 v[52:55], v2 offset:1024
    ds_read_b128 v[56:59], v2 offset:2048
    ds_read_b128 v[60:63], v2 offset:3072
    ds_read_b128 v[64:67], v2 offset:4096
    ds_read_b128 v[68:71], v2 offset:5120
    v_mov_b64 v[36:37], 0
    v_mov_b64 v[38:39], 0
    v_mov_b64 v[40:41], 0
    v_mov_b64 v[42:43], 0
    v_mov_b64 v[44:45], 0
    v_mov_b64 v[46:47], 0
    v_lshrrev_b32_e64 v11, 2, v7
    v_add_u32 v11, 104448, v11
    s_mov_b32 m0, s2
    s_add_u32 s48, s48, 524288
    s_add_u32 s43, s43, 524288
    s_add_u32 s100, s100, 524288
    s_sub_u32 s16, s41, 139264
    s_add_u32 s49, s16, 4096
    s_add_u32 s36, s16, 8192
    s_add_u32 s44, s44, 131072
    s_add_u32 s14, s14, 1
    s_xor_b32 s40, s40, 1
    s_cmp_eq_u32 s14, 63
    s_cselect_b64 s[98:99], 1, 0
    s_mov_b32 s42, s41
    s_add_u32 s41, s41, 16384
    s_cmp_eq_u32 s41, 1753088
    s_cselect_b32 s41, 1703936, s41
    s_waitcnt vmcnt(2)
    v_smfmac_f32_16x16x64_bf16 v[16:19], v[12:15], v[20:27], v0
    v_bitop3_b32 v9, v20, v22, s19 bitop3:0x7e
    v_bitop3_b32 v10, v24, v26, s19 bitop3:0x7e
    v_bitop3_b32 v9, v9, v10, 1 bitop3:0xa8
    s_waitcnt vmcnt(0)
    v_smfmac_f32_16x16x64_bf16 v[16:19], v[12:15], v[28:35], v0
    v_bitop3_b32 v20, v28, v30, s19 bitop3:0x7e
    v_bitop3_b32 v10, v32, v34, s19 bitop3:0x7e
    v_bitop3_b32 v10, v10, v20, 1 bitop3:0xa8
    v_or_b32 v9, v9, v10
    v_cmp_ne_u32 vcc, 0, v9
    s_nop 1
    v_mov_b32 v6, v6
    v_add_f32_dpp v16, v16, v16 row_ror:8 row_mask:0xf bank_mask:0xf
    v_add_f32_dpp v17, v17, v17 row_ror:8 row_mask:0xf bank_mask:0xf
    v_cvt_pk_bf16_f32 v10, v16, v17
    v_min_u32 v10, -2, v10
    s_cbranch_vccnz CH_P1_RETRY
CH_P1_OK:
    buffer_store_dword v10, v8, s[4:7], s17 offen
    v_mov_b32_e64 v9, -1
    buffer_store_dword v9, v8, s[4:7], s18 offen
    s_branch L_reddone_21
L_nored_18:
    ds_read_b128 v[48:51], v2 offset:0
    ds_read_b128 v[52:55], v2 offset:1024
    ds_read_b128 v[56:59], v2 offset:2048
    ds_read_b128 v[60:63], v2 offset:3072
    ds_read_b128 v[64:67], v2 offset:4096
    ds_read_b128 v[68:71], v2 offset:5120
    s_cmp_lg_u32 s13, 0
    s_cbranch_scc1 CH_W3IDLE
    s_waitcnt vmcnt(6)
    s_add_u32 s16, s14, 3
    s_min_u32 s16, s16, 63
    v_readfirstlane_b32 s17, v9
    s_nop 0
    s_cmp_ge_u32 s17, s16
    s_cbranch_scc1 L_kvokstep_27
    s_mov_b32 s45, 131072
    s_lshl_b32 s18, s12, 7
L_kvwstep_26:
    buffer_load_dword v9, off, s[4:7], s18 offset:0 sc1
    s_sub_u32 s45, s45, 1
    s_cbranch_scc1 ABORT
    s_waitcnt vmcnt(0)
    v_readfirstlane_b32 s17, v9
    s_nop 0
    s_cmp_ge_u32 s17, s16
    s_cbranch_scc0 L_kvwstep_26
L_kvokstep_27:
    v_mov_b64 v[36:37], 0
    v_mov_b64 v[38:39], 0
    v_mov_b64 v[40:41], 0
    v_mov_b64 v[42:43], 0
    v_mov_b64 v[44:45], 0
    v_mov_b64 v[46:47], 0
    v_lshrrev_b32_e64 v11, 2, v7
    v_add_u32 v11, 104448, v11
    s_mov_b32 m0, s2
    s_add_u32 s48, s48, 524288
    s_add_u32 s43, s43, 524288
    s_add_u32 s100, s100, 524288
    s_sub_u32 s16, s41, 139264
    s_add_u32 s49, s16, 4096
    s_add_u32 s36, s16, 8192
    s_add_u32 s44, s44, 131072
    s_add_u32 s14, s14, 1
    s_xor_b32 s40, s40, 1
    s_cmp_eq_u32 s14, 63
    s_cselect_b64 s[98:99], 1, 0
    s_mov_b32 s42, s41
    s_add_u32 s41, s41, 16384
    s_cmp_eq_u32 s41, 1753088
    s_cselect_b32 s41, 1703936, s41
    v_mov_b32 v6, v6
    s_nop 2
    v_mov_b32 v6, v6
    s_nop 2
    v_mov_b32 v6, v6
    s_nop 2
    v_mov_b32 v6, v6
    s_nop 2
    v_mov_b32 v6, v6
    s_nop 2
    v_mov_b32 v6, v6
    s_nop 2
    v_mov_b32 v6, v6
    s_nop 2
    v_mov_b32 v6, v6
    s_nop 2
    v_mov_b32 v6, v6
    s_nop 2
    v_mov_b32 v6, v6
    s_nop 2
    v_mov_b32 v6, v6
    s_nop 2
    v_mov_b32 v6, v6
    s_nop 2
    v_mov_b32 v6, v6
    s_nop 2
    v_mov_b32 v6, v6
    s_nop 2
    v_mov_b32 v6, v6
    s_nop 2
    v_mov_b32 v6, v6
    s_nop 2
    v_mov_b32 v6, v6
    s_nop 2
    v_mov_b32 v6, v6
    s_nop 2
L_nw0_25:
L_reddone_21:
    s_bitcmp1_b32 s13, 0
    s_cbranch_scc1 CH_E_SKIP
    v_mov_b32 v6, v6
    s_nop 2
    v_mov_b32 v6, v6
    s_nop 2
    v_mov_b32 v6, v6
    s_nop 2
    v_mov_b32 v6, v6
    s_nop 2
    v_mov_b32 v6, v6
    s_nop 2
    v_mov_b32 v6, v6
    s_nop 2
    buffer_load_dwordx4 v[12:15], v7, s[4:7], s16 offen sc1
    buffer_load_dwordx4 v[16:19], v7, s[4:7], s16 offen offset:1024 sc1
    v_mov_b32 v6, v6
    s_nop 2
    v_mov_b32 v6, v6
    s_nop 2
    v_mov_b32 v6, v6
    s_nop 2
    v_mov_b32 v6, v6
    s_nop 2
    v_mov_b32 v6, v6
    s_nop 2
    v_mov_b32 v6, v6
    s_nop 2
    v_mov_b32 v6, v6
    s_nop 2
    buffer_load_dwordx4 v[12:15], v7, s[4:7], s16 offen sc1
    buffer_load_dwordx4 v[16:19], v7, s[4:7], s16 offen offset:1024 sc1
    s_mov_b32 s45, 131072
CH_E_CHK:
    s_waitcnt vmcnt(3)
    v_max3_u32 v10, v12, v13, v14
    v_max_u32 v10, v10, v15
    ds_write_b128 v7, v[12:15] offset:6400
    s_waitcnt vmcnt(2)
    v_max3_u32 v10, v10, v16, v17
    v_max3_u32 v10, v10, v18, v19
    v_cmp_eq_u32 vcc, -1, v10
    ds_write_b128 v7, v[16:19] offset:7424
    s_cbranch_vccnz CH_E_NEXT
CH_E_OK:
    s_branch CH_STEP
CH_E_SKIP:
    s_branch CH_E_OK
CH_W3IDLE:
    v_mov_b64 v[36:37], 0
    v_mov_b64 v[38:39], 0
    v_mov_b64 v[40:41], 0
    v_mov_b64 v[42:43], 0
    v_mov_b64 v[44:45], 0
    v_mov_b64 v[46:47], 0
    v_lshrrev_b32 v11, 2, v7
    v_add_u32 v11, 104448, v11
    s_mov_b32 m0, s2
    s_add_u32 s48, s48, 524288
    s_add_u32 s43, s43, 524288
    s_add_u32 s100, s100, 524288
    s_sub_u32 s16, s41, 139264
    s_add_u32 s49, s16, 4096
    s_add_u32 s36, s16, 8192
    s_add_u32 s44, s44, 131072
    s_add_u32 s14, s14, 1
    s_xor_b32 s40, s40, 1
    s_cmp_eq_u32 s14, 63
    s_cselect_b64 s[98:99], 1, 0
    s_mov_b32 s42, s41
    s_add_u32 s41, s41, 16384
    s_cmp_eq_u32 s41, 1753088
    s_cselect_b32 s41, 1703936, s41
    s_branch L_reddone_21
CH_P1_RETRY:
    s_mov_b32 s45, 131072
L_poll1_19:
    buffer_load_dwordx4 v[20:23], v1, s[4:7], s37 offen offset:0 sc1
    buffer_load_dwordx4 v[24:27], v1, s[4:7], s37 offen offset:1024 sc1
    buffer_load_dwordx4 v[28:31], v1, s[4:7], s37 offen offset:2048 sc1
    buffer_load_dwordx4 v[32:35], v1, s[4:7], s37 offen offset:3072 sc1
    s_sub_u32 s45, s45, 1
    s_cbranch_scc1 ABORT
    s_waitcnt vmcnt(0)
    v_bitop3_b32 v9, v20, v22, s19 bitop3:0x7e
    v_bitop3_b32 v10, v24, v26, s19 bitop3:0x7e
    v_bitop3_b32 v9, v9, v10, 1 bitop3:0xa8
    v_bitop3_b32 v16, v28, v30, s19 bitop3:0x7e
    v_bitop3_b32 v10, v32, v34, s19 bitop3:0x7e
    v_bitop3_b32 v10, v10, v16, 1 bitop3:0xa8
    v_or_b32 v9, v9, v10
    v_cmpx_ne_u32 vcc, 0, v9
    s_cbranch_execnz L_poll1_19
    s_mov_b64 exec, -1
    v_mov_b64 v[16:17], 0
    v_mov_b64 v[18:19], 0
    s_nop 1
    v_smfmac_f32_16x16x64_bf16 v[16:19], v[12:15], v[20:27], v0
    v_smfmac_f32_16x16x64_bf16 v[16:19], v[12:15], v[28:35], v0
    s_nop 1
    v_mov_b32 v6, v6
    s_nop 1
    v_mov_b32 v6, v6
    s_nop 0
    v_mov_b32 v6, v6
    v_add_f32_dpp v16, v16, v16 row_ror:8 row_mask:0xf bank_mask:0xf
    v_add_f32_dpp v17, v17, v17 row_ror:8 row_mask:0xf bank_mask:0xf
    v_cvt_pk_bf16_f32 v10, v16, v17
    v_min_u32 v10, -2, v10
    s_branch CH_P1_OK
CH_E_NEXT:
    buffer_load_dwordx4 v[12:15], v7, s[4:7], s16 offen sc1
    buffer_load_dwordx4 v[16:19], v7, s[4:7], s16 offen offset:1024 sc1
    s_sub_u32 s45, s45, 1
    s_cbranch_scc1 ABORT
    s_branch CH_E_CHK
CH_SCAN:
    s_cmp_eq_u64 vcc, 0
    s_cbranch_scc1 CH_LAST
    ds_read_b128 v[20:23], v1 offset:10496
    s_waitcnt lgkmcnt(0)
    v_max_u32 v38, v20, v21
    v_max3_u32 v38, v38, v22, v23
    ds_read_b128 v[20:23], v1 offset:11520
    s_waitcnt lgkmcnt(0)
    v_max3_u32 v38, v38, v20, v21
    v_max3_u32 v38, v38, v22, v23
    ds_read_b128 v[20:23], v1 offset:12544
    s_waitcnt lgkmcnt(0)
    v_max3_u32 v38, v38, v20, v21
    v_max3_u32 v38, v38, v22, v23
    ds_read_b128 v[20:23], v1 offset:13568
    s_waitcnt lgkmcnt(0)
    v_max3_u32 v38, v38, v20, v21
    v_max3_u32 v38, v38, v22, v23
    ds_read_b128 v[20:23], v1 offset:14592
    s_waitcnt lgkmcnt(0)
    v_max3_u32 v38, v38, v20, v21
    v_max3_u32 v38, v38, v22, v23
    v_cmp_eq_u32 vcc, -1, v38
    s_cbranch_vccnz CH_REDO
    v_min_u32 v36, -2, v36
    v_min_u32 v37, -2, v37
    s_cmp_eq_u32 s14, 63
    s_cbranch_scc1 CH_LAST
    s_branch CH_SCAN_OK
CH_REDO:
    s_sub_u32 s97, s97, 1
    s_cbranch_scc1 ABORT
    s_waitcnt vmcnt(0) lgkmcnt(0)
    s_nop 7
    ds_read_b128 v[48:51], v2 offset:0
    ds_read_b128 v[52:55], v2 offset:1024
    ds_read_b128 v[56:59], v2 offset:2048
    ds_read_b128 v[60:63], v2 offset:3072
    ds_read_b128 v[64:67], v2 offset:4096
    ds_read_b128 v[68:71], v2 offset:5120
    v_mov_b64 v[36:37], 0
    v_mov_b64 v[38:39], 0
    v_mov_b64 v[40:41], 0
    v_mov_b64 v[42:43], 0
    v_mov_b64 v[44:45], 0
    v_mov_b64 v[46:47], 0
    v_lshrrev_b32 v11, 2, v7
    v_add_u32 v11, 104448, v11
    s_mov_b32 m0, s2
    s_branch CH_STEP
CH_LAST:
    v_mov_b64 v[38:39], v[10:11]
    buffer_store_dwordx4 v[36:39], v1, s[4:7], s44 offen sc1
    s_cmp_lg_u32 s13, 0
    s_cbranch_scc1 L_chend_28
L_chend_28:
    s_endpgm
ABORT:
    v_mov_b32 v1, 0xdead
    s_waitcnt lgkmcnt(0) vmcnt(0)
    s_mov_b64 exec, 1
    buffer_store_dword v1, off, s[84:87], 0 offset:12 sc1
END:
    s_endpgm
ROLE_KV:
    v_mbcnt_lo_u32_b32 v1, -1, 0
    v_mbcnt_hi_u32_b32 v1, -1, v1
    s_load_dwordx2 s[8:9], s[0:1], 24
    s_load_dwordx2 s[52:53], s[0:1], 32
    s_mov_b32 s10, 4718592
    s_mov_b32 s11, 0x20000
    s_mov_b32 s54, 4718592
    s_mov_b32 s55, 0x20000
    v_lshrrev_b32 v13, 4, v1
    v_lshlrev_b32 v13, 13, v13
    v_and_b32 v2, 15, v1
    v_lshl_add_u32 v13, v2, 4, v13
    s_lshl_b32 s19, s12, 8
    s_lshl_b32 s16, s13, 15
    s_add_u32 s19, s19, s16
    s_lshl_b32 s18, s13, 10
    s_waitcnt lgkmcnt(0)
    s_add_u32 m0, s18, 0
    s_add_u32 s17, s19, 0
    buffer_load_dwordx4 v13, s[8:11], s17 offen lds
    s_add_u32 m0, s18, 4096
    s_add_u32 s17, s19, 131072
    buffer_load_dwordx4 v13, s[8:11], s17 offen lds
    s_add_u32 m0, s18, 8192
    s_add_u32 s17, s19, 262144
    buffer_load_dwordx4 v13, s[8:11], s17 offen lds
    s_add_u32 m0, s18, 12288
    s_add_u32 s17, s19, 393216
    buffer_load_dwordx4 v13, s[8:11], s17 offen lds
    s_add_u32 m0, s18, 16384
    s_add_u32 s17, s19, 524288
    buffer_load_dwordx4 v13, s[8:11], s17 offen lds
    s_add_u32 m0, s18, 20480
    s_add_u32 s17, s19, 655360
    buffer_load_dwordx4 v13, s[8:11], s17 offen lds
    s_add_u32 m0, s18, 24576
    s_add_u32 s17, s19, 786432
    buffer_load_dwordx4 v13, s[8:11], s17 offen lds
    s_add_u32 m0, s18, 28672
    s_add_u32 s17, s19, 917504
    buffer_load_dwordx4 v13, s[8:11], s17 offen lds
    s_add_u32 m0, s18, 32768
    s_add_u32 s17, s19, 1048576
    buffer_load_dwordx4 v13, s[8:11], s17 offen lds
    s_add_u32 m0, s18, 36864
    s_add_u32 s17, s19, 1179648
    buffer_load_dwordx4 v13, s[8:11], s17 offen lds
    s_add_u32 m0, s18, 40960
    s_add_u32 s17, s19, 1310720
    buffer_load_dwordx4 v13, s[8:11], s17 offen lds
    s_add_u32 m0, s18, 45056
    s_add_u32 s17, s19, 1441792
    buffer_load_dwordx4 v13, s[8:11], s17 offen lds
    s_add_u32 m0, s18, 49152
    s_add_u32 s17, s19, 1572864
    buffer_load_dwordx4 v13, s[8:11], s17 offen lds
    s_add_u32 m0, s18, 53248
    s_add_u32 s17, s19, 1703936
    buffer_load_dwordx4 v13, s[8:11], s17 offen lds
    s_add_u32 m0, s18, 57344
    s_add_u32 s17, s19, 1835008
    buffer_load_dwordx4 v13, s[8:11], s17 offen lds
    s_add_u32 m0, s18, 61440
    s_add_u32 s17, s19, 1966080
    buffer_load_dwordx4 v13, s[8:11], s17 offen lds
    s_add_u32 m0, s18, 65536
    s_add_u32 s17, s19, 2097152
    buffer_load_dwordx4 v13, s[8:11], s17 offen lds
    s_add_u32 m0, s18, 69632
    s_add_u32 s17, s19, 2228224
    buffer_load_dwordx4 v13, s[8:11], s17 offen lds
    s_add_u32 m0, s18, 73728
    s_add_u32 s17, s19, 2359296
    buffer_load_dwordx4 v13, s[8:11], s17 offen lds
    s_add_u32 m0, s18, 77824
    s_add_u32 s17, s19, 2490368
    buffer_load_dwordx4 v13, s[8:11], s17 offen lds
    s_add_u32 m0, s18, 81920
    s_add_u32 s17, s19, 2621440
    buffer_load_dwordx4 v13, s[8:11], s17 offen lds
    s_add_u32 m0, s18, 86016
    s_add_u32 s17, s19, 2752512
    buffer_load_dwordx4 v13, s[8:11], s17 offen lds
    s_add_u32 m0, s18, 90112
    s_add_u32 s17, s19, 2883584
    buffer_load_dwordx4 v13, s[8:11], s17 offen lds
    s_add_u32 m0, s18, 94208
    s_add_u32 s17, s19, 3014656
    buffer_load_dwordx4 v13, s[8:11], s17 offen lds
    s_add_u32 m0, s18, 98304
    s_add_u32 s17, s19, 3145728
    buffer_load_dwordx4 v13, s[8:11], s17 offen lds
    s_add_u32 m0, s18, 102400
    s_add_u32 s17, s19, 3276800
    buffer_load_dwordx4 v13, s[8:11], s17 offen lds
    s_add_u32 m0, s18, 106496
    s_add_u32 s17, s19, 3407872
    buffer_load_dwordx4 v13, s[8:11], s17 offen lds
    s_add_u32 m0, s18, 110592
    s_add_u32 s17, s19, 3538944
    buffer_load_dwordx4 v13, s[8:11], s17 offen lds
    s_add_u32 m0, s18, 114688
    s_add_u32 s17, s19, 3670016
    buffer_load_dwordx4 v13, s[8:11], s17 offen lds
    s_add_u32 m0, s18, 118784
    s_add_u32 s17, s19, 3801088
    buffer_load_dwordx4 v13, s[8:11], s17 offen lds
    s_add_u32 m0, s18, 122880
    s_add_u32 s17, s19, 3932160
    buffer_load_dwordx4 v13, s[8:11], s17 offen lds
    s_add_u32 m0, s18, 126976
    s_add_u32 s17, s19, 4063232
    buffer_load_dwordx4 v13, s[8:11], s17 offen lds
    s_add_u32 m0, s18, 131072
    s_add_u32 s17, s19, 4194304
    buffer_load_dwordx4 v13, s[8:11], s17 offen lds
    s_add_u32 m0, s18, 135168
    s_add_u32 s17, s19, 4325376
    buffer_load_dwordx4 v13, s[8:11], s17 offen lds
    s_add_u32 m0, s18, 139264
    s_add_u32 s17, s19, 4456448
    buffer_load_dwordx4 v13, s[8:11], s17 offen lds
    s_add_u32 m0, s18, 143360
    s_add_u32 s17, s19, 4587520
    buffer_load_dwordx4 v13, s[8:11], s17 offen lds
    v_lshrrev_b32 v14, 5, v1
    v_bfe_u32 v2, v1, 2, 2
    v_lshl_add_u32 v14, v14, 3, v2
    v_mul_u32_u24 v14, 256, v14
    v_bfe_u32 v2, v1, 4, 1
    v_mul_u32_u24 v2, 32, v2
    v_add_u32 v14, v14, v2
    v_and_b32 v2, 1, v1
    v_lshl_add_u32 v14, v2, 4, v14
    v_bfe_u32 v2, v1, 1, 1
    v_lshl_add_u32 v14, v2, 3, v14
    s_lshl_b32 s16, s13, 6
    v_add_u32 v14, s16, v14
    v_lshrrev_b32 v15, 5, v1
    v_lshlrev_b32 v15, 11, v15
    v_and_b32 v2, 15, v1
    v_lshl_add_u32 v15, v2, 2, v15
    v_add_u32 v15, s16, v15
    v_bfe_u32 v3, v1, 4, 1
    v_mul_u32_u24 v3, 0x0202, v3
    v_lshl_or_b32 v3, v3, 16, v3
    v_add_u32 v3, 0x05040100, v3
    s_waitcnt vmcnt(27)
    s_waitcnt lgkmcnt(0)
    s_barrier
    ds_read_b64_tr_b16 a[0:1], v14 offset:0
    ds_read_b64_tr_b16 a[2:3], v14 offset:1024
    ds_read_b64_tr_b16 a[4:5], v14 offset:4096
    ds_read_b64_tr_b16 a[6:7], v14 offset:5120
    ds_read_b64_tr_b16 a[8:9], v14 offset:8192
    ds_read_b64_tr_b16 a[10:11], v14 offset:9216
    ds_read_b64_tr_b16 a[12:13], v14 offset:12288
    ds_read_b64_tr_b16 a[14:15], v14 offset:13312
    ds_read_b64_tr_b16 a[16:17], v14 offset:16384
    ds_read_b64_tr_b16 a[18:19], v14 offset:17408
    ds_read_b64_tr_b16 a[20:21], v14 offset:20480
    ds_read_b64_tr_b16 a[22:23], v14 offset:21504
    ds_read_b64_tr_b16 a[24:25], v14 offset:24576
    ds_read_b64_tr_b16 a[26:27], v14 offset:25600
    ds_read_b64_tr_b16 a[28:29], v14 offset:28672
    ds_read_b64_tr_b16 a[30:31], v14 offset:29696
    ds_read_b64_tr_b16 a[32:33], v14 offset:32768
    ds_read_b64_tr_b16 a[34:35], v14 offset:33792
    v_add_u32 v14, 36864, v14
    s_waitcnt vmcnt(18)
    s_waitcnt lgkmcnt(0)
    s_barrier
    s_add_u32 m0, s18, 0
    s_add_u32 s17, s19, 0
    buffer_load_dwordx4 v13, s[52:55], s17 offen lds
    s_add_u32 m0, s18, 4096
    s_add_u32 s17, s19, 131072
    buffer_load_dwordx4 v13, s[52:55], s17 offen lds
    s_add_u32 m0, s18, 8192
    s_add_u32 s17, s19, 262144
    buffer_load_dwordx4 v13, s[52:55], s17 offen lds
    s_add_u32 m0, s18, 12288
    s_add_u32 s17, s19, 393216
    buffer_load_dwordx4 v13, s[52:55], s17 offen lds
    s_add_u32 m0, s18, 16384
    s_add_u32 s17, s19, 524288
    buffer_load_dwordx4 v13, s[52:55], s17 offen lds
    s_add_u32 m0, s18, 20480
    s_add_u32 s17, s19, 655360
    buffer_load_dwordx4 v13, s[52:55], s17 offen lds
    s_add_u32 m0, s18, 24576
    s_add_u32 s17, s19, 786432
    buffer_load_dwordx4 v13, s[52:55], s17 offen lds
    s_add_u32 m0, s18, 28672
    s_add_u32 s17, s19, 917504
    buffer_load_dwordx4 v13, s[52:55], s17 offen lds
    s_add_u32 m0, s18, 32768
    s_add_u32 s17, s19, 1048576
    buffer_load_dwordx4 v13, s[52:55], s17 offen lds
    ds_read_b64_tr_b16 a[36:37], v14 offset:0
    ds_read_b64_tr_b16 a[38:39], v14 offset:1024
    ds_read_b64_tr_b16 a[40:41], v14 offset:4096
    ds_read_b64_tr_b16 a[42:43], v14 offset:5120
    ds_read_b64_tr_b16 a[44:45], v14 offset:8192
    ds_read_b64_tr_b16 a[46:47], v14 offset:9216
    ds_read_b64_tr_b16 a[48:49], v14 offset:12288
    ds_read_b64_tr_b16 a[50:51], v14 offset:13312
    ds_read_b64_tr_b16 a[52:53], v14 offset:16384
    ds_read_b64_tr_b16 a[54:55], v14 offset:17408
    ds_read_b64_tr_b16 a[56:57], v14 offset:20480
    ds_read_b64_tr_b16 a[58:59], v14 offset:21504
    ds_read_b64_tr_b16 a[60:61], v14 offset:24576
    ds_read_b64_tr_b16 a[62:63], v14 offset:25600
    ds_read_b64_tr_b16 a[64:65], v14 offset:28672
    ds_read_b64_tr_b16 a[66:67], v14 offset:29696
    ds_read_b64_tr_b16 a[68:69], v14 offset:32768
    ds_read_b64_tr_b16 a[70:71], v14 offset:33792
    v_add_u32 v14, 36864, v14
    s_waitcnt vmcnt(18)
    s_waitcnt lgkmcnt(0)
    s_barrier
    s_add_u32 m0, s18, 36864
    s_add_u32 s17, s19, 1179648
    buffer_load_dwordx4 v13, s[52:55], s17 offen lds
    s_add_u32 m0, s18, 40960
    s_add_u32 s17, s19, 1310720
    buffer_load_dwordx4 v13, s[52:55], s17 offen lds
    s_add_u32 m0, s18, 45056
    s_add_u32 s17, s19, 1441792
    buffer_load_dwordx4 v13, s[52:55], s17 offen lds
    s_add_u32 m0, s18, 49152
    s_add_u32 s17, s19, 1572864
    buffer_load_dwordx4 v13, s[52:55], s17 offen lds
    s_add_u32 m0, s18, 53248
    s_add_u32 s17, s19, 1703936
    buffer_load_dwordx4 v13, s[52:55], s17 offen lds
    s_add_u32 m0, s18, 57344
    s_add_u32 s17, s19, 1835008
    buffer_load_dwordx4 v13, s[52:55], s17 offen lds
    s_add_u32 m0, s18, 61440
    s_add_u32 s17, s19, 1966080
    buffer_load_dwordx4 v13, s[52:55], s17 offen lds
    s_add_u32 m0, s18, 65536
    s_add_u32 s17, s19, 2097152
    buffer_load_dwordx4 v13, s[52:55], s17 offen lds
    s_add_u32 m0, s18, 69632
    s_add_u32 s17, s19, 2228224
    buffer_load_dwordx4 v13, s[52:55], s17 offen lds
    ds_read_b64_tr_b16 a[72:73], v14 offset:0
    ds_read_b64_tr_b16 a[74:75], v14 offset:1024
    ds_read_b64_tr_b16 a[76:77], v14 offset:4096
    ds_read_b64_tr_b16 a[78:79], v14 offset:5120
    ds_read_b64_tr_b16 a[80:81], v14 offset:8192
    ds_read_b64_tr_b16 a[82:83], v14 offset:9216
    ds_read_b64_tr_b16 a[84:85], v14 offset:12288
    ds_read_b64_tr_b16 a[86:87], v14 offset:13312
    ds_read_b64_tr_b16 a[88:89], v14 offset:16384
    ds_read_b64_tr_b16 a[90:91], v14 offset:17408
    ds_read_b64_tr_b16 a[92:93], v14 offset:20480
    ds_read_b64_tr_b16 a[94:95], v14 offset:21504
    ds_read_b64_tr_b16 a[96:97], v14 offset:24576
    ds_read_b64_tr_b16 a[98:99], v14 offset:25600
    ds_read_b64_tr_b16 a[100:101], v14 offset:28672
    ds_read_b64_tr_b16 a[102:103], v14 offset:29696
    ds_read_b64_tr_b16 a[104:105], v14 offset:32768
    ds_read_b64_tr_b16 a[106:107], v14 offset:33792
    v_add_u32 v14, 36864, v14
    s_waitcnt vmcnt(18)
    s_waitcnt lgkmcnt(0)
    s_barrier
    s_add_u32 m0, s18, 73728
    s_add_u32 s17, s19, 2359296
    buffer_load_dwordx4 v13, s[52:55], s17 offen lds
    s_add_u32 m0, s18, 77824
    s_add_u32 s17, s19, 2490368
    buffer_load_dwordx4 v13, s[52:55], s17 offen lds
    s_add_u32 m0, s18, 81920
    s_add_u32 s17, s19, 2621440
    buffer_load_dwordx4 v13, s[52:55], s17 offen lds
    s_add_u32 m0, s18, 86016
    s_add_u32 s17, s19, 2752512
    buffer_load_dwordx4 v13, s[52:55], s17 offen lds
    s_add_u32 m0, s18, 90112
    s_add_u32 s17, s19, 2883584
    buffer_load_dwordx4 v13, s[52:55], s17 offen lds
    s_add_u32 m0, s18, 94208
    s_add_u32 s17, s19, 3014656
    buffer_load_dwordx4 v13, s[52:55], s17 offen lds
    s_add_u32 m0, s18, 98304
    s_add_u32 s17, s19, 3145728
    buffer_load_dwordx4 v13, s[52:55], s17 offen lds
    s_add_u32 m0, s18, 102400
    s_add_u32 s17, s19, 3276800
    buffer_load_dwordx4 v13, s[52:55], s17 offen lds
    s_add_u32 m0, s18, 106496
    s_add_u32 s17, s19, 3407872
    buffer_load_dwordx4 v13, s[52:55], s17 offen lds
    ds_read_b64_tr_b16 a[108:109], v14 offset:0
    ds_read_b64_tr_b16 a[110:111], v14 offset:1024
    ds_read_b64_tr_b16 a[112:113], v14 offset:4096
    ds_read_b64_tr_b16 a[114:115], v14 offset:5120
    ds_read_b64_tr_b16 a[116:117], v14 offset:8192
    ds_read_b64_tr_b16 a[118:119], v14 offset:9216
    ds_read_b64_tr_b16 a[120:121], v14 offset:12288
    ds_read_b64_tr_b16 a[122:123], v14 offset:13312
    ds_read_b64_tr_b16 a[124:125], v14 offset:16384
    ds_read_b64_tr_b16 a[126:127], v14 offset:17408
    ds_read_b64_tr_b16 a[128:129], v14 offset:20480
    ds_read_b64_tr_b16 a[130:131], v14 offset:21504
    ds_read_b64_tr_b16 a[132:133], v14 offset:24576
    ds_read_b64_tr_b16 a[134:135], v14 offset:25600
    ds_read_b64_tr_b16 a[136:137], v14 offset:28672
    ds_read_b64_tr_b16 a[138:139], v14 offset:29696
    ds_read_b64_tr_b16 a[140:141], v14 offset:32768
    ds_read_b64_tr_b16 a[142:143], v14 offset:33792
    v_add_u32 v14, 36864, v14
    s_waitcnt vmcnt(18)
    s_waitcnt lgkmcnt(0)
    s_barrier
    s_add_u32 m0, s18, 110592
    s_add_u32 s17, s19, 3538944
    buffer_load_dwordx4 v13, s[52:55], s17 offen lds
    s_add_u32 m0, s18, 114688
    s_add_u32 s17, s19, 3670016
    buffer_load_dwordx4 v13, s[52:55], s17 offen lds
    s_add_u32 m0, s18, 118784
    s_add_u32 s17, s19, 3801088
    buffer_load_dwordx4 v13, s[52:55], s17 offen lds
    s_add_u32 m0, s18, 122880
    s_add_u32 s17, s19, 3932160
    buffer_load_dwordx4 v13, s[52:55], s17 offen lds
    s_add_u32 m0, s18, 126976
    s_add_u32 s17, s19, 4063232
    buffer_load_dwordx4 v13, s[52:55], s17 offen lds
    s_add_u32 m0, s18, 131072
    s_add_u32 s17, s19, 4194304
    buffer_load_dwordx4 v13, s[52:55], s17 offen lds
    s_add_u32 m0, s18, 135168
    s_add_u32 s17, s19, 4325376
    buffer_load_dwordx4 v13, s[52:55], s17 offen lds
    s_add_u32 m0, s18, 139264
    s_add_u32 s17, s19, 4456448
    buffer_load_dwordx4 v13, s[52:55], s17 offen lds
    s_add_u32 m0, s18, 143360
    s_add_u32 s17, s19, 4587520
    buffer_load_dwordx4 v13, s[52:55], s17 offen lds
    ds_read2st64_b32 v[64:65], v15 offset0:0 offset1:1
    ds_read2st64_b32 v[66:67], v15 offset0:2 offset1:3
    ds_read2st64_b32 v[68:69], v15 offset0:4 offset1:5
    ds_read2st64_b32 v[70:71], v15 offset0:6 offset1:7
    ds_read2st64_b32 v[72:73], v15 offset0:16 offset1:17
    ds_read2st64_b32 v[74:75], v15 offset0:18 offset1:19
    ds_read2st64_b32 v[76:77], v15 offset0:20 offset1:21
    ds_read2st64_b32 v[78:79], v15 offset0:22 offset1:23
    ds_read2st64_b32 v[80:81], v15 offset0:32 offset1:33
    ds_read2st64_b32 v[82:83], v15 offset0:34 offset1:35
    ds_read2st64_b32 v[84:85], v15 offset0:36 offset1:37
    ds_read2st64_b32 v[86:87], v15 offset0:38 offset1:39
    ds_read2st64_b32 v[88:89], v15 offset0:48 offset1:49
    ds_read2st64_b32 v[90:91], v15 offset0:50 offset1:51
    ds_read2st64_b32 v[92:93], v15 offset0:52 offset1:53
    ds_read2st64_b32 v[94:95], v15 offset0:54 offset1:55
    ds_read2st64_b32 v[96:97], v15 offset0:64 offset1:65
    ds_read2st64_b32 v[98:99], v15 offset0:66 offset1:67
    ds_read2st64_b32 v[100:101], v15 offset0:68 offset1:69
    ds_read2st64_b32 v[102:103], v15 offset0:70 offset1:71
    ds_read2st64_b32 v[104:105], v15 offset0:80 offset1:81
    ds_read2st64_b32 v[106:107], v15 offset0:82 offset1:83
    ds_read2st64_b32 v[108:109], v15 offset0:84 offset1:85
    ds_read2st64_b32 v[110:111], v15 offset0:86 offset1:87
    ds_read2st64_b32 v[112:113], v15 offset0:96 offset1:97
    ds_read2st64_b32 v[114:115], v15 offset0:98 offset1:99
    ds_read2st64_b32 v[116:117], v15 offset0:100 offset1:101
    ds_read2st64_b32 v[118:119], v15 offset0:102 offset1:103
    ds_read2st64_b32 v[120:121], v15 offset0:112 offset1:113
    ds_read2st64_b32 v[122:123], v15 offset0:114 offset1:115
    ds_read2st64_b32 v[124:125], v15 offset0:116 offset1:117
    ds_read2st64_b32 v[126:127], v15 offset0:118 offset1:119
    ds_read2st64_b32 v[128:129], v15 offset0:128 offset1:129
    ds_read2st64_b32 v[130:131], v15 offset0:130 offset1:131
    ds_read2st64_b32 v[132:133], v15 offset0:132 offset1:133
    ds_read2st64_b32 v[134:135], v15 offset0:134 offset1:135
    v_add_u32 v15, 36864, v15
    s_waitcnt lgkmcnt(15)
    v_perm_b32 v64, v65, v64, v3
    v_accvgpr_write_b32 a144, v64
    v_perm_b32 v66, v67, v66, v3
    v_accvgpr_write_b32 a145, v66
    v_perm_b32 v68, v69, v68, v3
    v_accvgpr_write_b32 a146, v68
    v_perm_b32 v70, v71, v70, v3
    v_accvgpr_write_b32 a147, v70
    v_perm_b32 v72, v73, v72, v3
    v_accvgpr_write_b32 a148, v72
    v_perm_b32 v74, v75, v74, v3
    v_accvgpr_write_b32 a149, v74
    v_perm_b32 v76, v77, v76, v3
    v_accvgpr_write_b32 a150, v76
    v_perm_b32 v78, v79, v78, v3
    v_accvgpr_write_b32 a151, v78
    v_perm_b32 v80, v81, v80, v3
    v_accvgpr_write_b32 a152, v80
    v_perm_b32 v82, v83, v82, v3
    v_accvgpr_write_b32 a153, v82
    v_perm_b32 v84, v85, v84, v3
    v_accvgpr_write_b32 a154, v84
    v_perm_b32 v86, v87, v86, v3
    v_accvgpr_write_b32 a155, v86
    v_perm_b32 v88, v89, v88, v3
    v_accvgpr_write_b32 a156, v88
    v_perm_b32 v90, v91, v90, v3
    v_accvgpr_write_b32 a157, v90
    v_perm_b32 v92, v93, v92, v3
    v_accvgpr_write_b32 a158, v92
    v_perm_b32 v94, v95, v94, v3
    v_accvgpr_write_b32 a159, v94
    v_perm_b32 v96, v97, v96, v3
    v_accvgpr_write_b32 a160, v96
    v_perm_b32 v98, v99, v98, v3
    v_accvgpr_write_b32 a161, v98
    v_perm_b32 v100, v101, v100, v3
    v_accvgpr_write_b32 a162, v100
    v_perm_b32 v102, v103, v102, v3
    v_accvgpr_write_b32 a163, v102
    s_waitcnt lgkmcnt(12)
    v_perm_b32 v104, v105, v104, v3
    v_accvgpr_write_b32 a164, v104
    v_perm_b32 v106, v107, v106, v3
    v_accvgpr_write_b32 a165, v106
    v_perm_b32 v108, v109, v108, v3
    v_accvgpr_write_b32 a166, v108
    v_perm_b32 v110, v111, v110, v3
    v_accvgpr_write_b32 a167, v110
    s_waitcnt lgkmcnt(8)
    v_perm_b32 v112, v113, v112, v3
    v_accvgpr_write_b32 a168, v112
    v_perm_b32 v114, v115, v114, v3
    v_accvgpr_write_b32 a169, v114
    v_perm_b32 v116, v117, v116, v3
    v_accvgpr_write_b32 a170, v116
    v_perm_b32 v118, v119, v118, v3
    v_accvgpr_write_b32 a171, v118
    s_waitcnt lgkmcnt(4)
    v_perm_b32 v120, v121, v120, v3
    v_accvgpr_write_b32 a172, v120
    v_perm_b32 v122, v123, v122, v3
    v_accvgpr_write_b32 a173, v122
    v_perm_b32 v124, v125, v124, v3
    v_accvgpr_write_b32 a174, v124
    v_perm_b32 v126, v127, v126, v3
    v_accvgpr_write_b32 a175, v126
    s_waitcnt lgkmcnt(0)
    v_perm_b32 v128, v129, v128, v3
    v_accvgpr_write_b32 a176, v128
    v_perm_b32 v130, v131, v130, v3
    v_accvgpr_write_b32 a177, v130
    v_perm_b32 v132, v133, v132, v3
    v_accvgpr_write_b32 a178, v132
    v_perm_b32 v134, v135, v134, v3
    v_accvgpr_write_b32 a179, v134
    s_waitcnt vmcnt(18)
    s_waitcnt lgkmcnt(0)
    s_barrier
    ds_read2st64_b32 v[64:65], v15 offset0:0 offset1:1
    ds_read2st64_b32 v[66:67], v15 offset0:2 offset1:3
    ds_read2st64_b32 v[68:69], v15 offset0:4 offset1:5
    ds_read2st64_b32 v[70:71], v15 offset0:6 offset1:7
    ds_read2st64_b32 v[72:73], v15 offset0:16 offset1:17
    ds_read2st64_b32 v[74:75], v15 offset0:18 offset1:19
    ds_read2st64_b32 v[76:77], v15 offset0:20 offset1:21
    ds_read2st64_b32 v[78:79], v15 offset0:22 offset1:23
    ds_read2st64_b32 v[80:81], v15 offset0:32 offset1:33
    ds_read2st64_b32 v[82:83], v15 offset0:34 offset1:35
    ds_read2st64_b32 v[84:85], v15 offset0:36 offset1:37
    ds_read2st64_b32 v[86:87], v15 offset0:38 offset1:39
    ds_read2st64_b32 v[88:89], v15 offset0:48 offset1:49
    ds_read2st64_b32 v[90:91], v15 offset0:50 offset1:51
    ds_read2st64_b32 v[92:93], v15 offset0:52 offset1:53
    ds_read2st64_b32 v[94:95], v15 offset0:54 offset1:55
    ds_read2st64_b32 v[96:97], v15 offset0:64 offset1:65
    ds_read2st64_b32 v[98:99], v15 offset0:66 offset1:67
    ds_read2st64_b32 v[100:101], v15 offset0:68 offset1:69
    ds_read2st64_b32 v[102:103], v15 offset0:70 offset1:71
    ds_read2st64_b32 v[104:105], v15 offset0:80 offset1:81
    ds_read2st64_b32 v[106:107], v15 offset0:82 offset1:83
    ds_read2st64_b32 v[108:109], v15 offset0:84 offset1:85
    ds_read2st64_b32 v[110:111], v15 offset0:86 offset1:87
    ds_read2st64_b32 v[112:113], v15 offset0:96 offset1:97
    ds_read2st64_b32 v[114:115], v15 offset0:98 offset1:99
    ds_read2st64_b32 v[116:117], v15 offset0:100 offset1:101
    ds_read2st64_b32 v[118:119], v15 offset0:102 offset1:103
    ds_read2st64_b32 v[120:121], v15 offset0:112 offset1:113
    ds_read2st64_b32 v[122:123], v15 offset0:114 offset1:115
    ds_read2st64_b32 v[124:125], v15 offset0:116 offset1:117
    ds_read2st64_b32 v[126:127], v15 offset0:118 offset1:119
    ds_read2st64_b32 v[128:129], v15 offset0:128 offset1:129
    ds_read2st64_b32 v[130:131], v15 offset0:130 offset1:131
    ds_read2st64_b32 v[132:133], v15 offset0:132 offset1:133
    ds_read2st64_b32 v[134:135], v15 offset0:134 offset1:135
    v_add_u32 v15, 36864, v15
    s_waitcnt lgkmcnt(15)
    v_perm_b32 v64, v65, v64, v3
    v_accvgpr_write_b32 a180, v64
    v_perm_b32 v66, v67, v66, v3
    v_accvgpr_write_b32 a181, v66
    v_perm_b32 v68, v69, v68, v3
    v_accvgpr_write_b32 a182, v68
    v_perm_b32 v70, v71, v70, v3
    v_accvgpr_write_b32 a183, v70
    v_perm_b32 v72, v73, v72, v3
    v_accvgpr_write_b32 a184, v72
    v_perm_b32 v74, v75, v74, v3
    v_accvgpr_write_b32 a185, v74
    v_perm_b32 v76, v77, v76, v3
    v_accvgpr_write_b32 a186, v76
    v_perm_b32 v78, v79, v78, v3
    v_accvgpr_write_b32 a187, v78
    v_perm_b32 v80, v81, v80, v3
    v_accvgpr_write_b32 a188, v80
    v_perm_b32 v82, v83, v82, v3
    v_accvgpr_write_b32 a189, v82
    v_perm_b32 v84, v85, v84, v3
    v_accvgpr_write_b32 a190, v84
    v_perm_b32 v86, v87, v86, v3
    v_accvgpr_write_b32 a191, v86
    v_perm_b32 v88, v89, v88, v3
    v_accvgpr_write_b32 a192, v88
    v_perm_b32 v90, v91, v90, v3
    v_accvgpr_write_b32 a193, v90
    v_perm_b32 v92, v93, v92, v3
    v_accvgpr_write_b32 a194, v92
    v_perm_b32 v94, v95, v94, v3
    v_accvgpr_write_b32 a195, v94
    v_perm_b32 v96, v97, v96, v3
    v_accvgpr_write_b32 a196, v96
    v_perm_b32 v98, v99, v98, v3
    v_accvgpr_write_b32 a197, v98
    v_perm_b32 v100, v101, v100, v3
    v_accvgpr_write_b32 a198, v100
    v_perm_b32 v102, v103, v102, v3
    v_accvgpr_write_b32 a199, v102
    s_waitcnt lgkmcnt(12)
    v_perm_b32 v104, v105, v104, v3
    v_accvgpr_write_b32 a200, v104
    v_perm_b32 v106, v107, v106, v3
    v_accvgpr_write_b32 a201, v106
    v_perm_b32 v108, v109, v108, v3
    v_accvgpr_write_b32 a202, v108
    v_perm_b32 v110, v111, v110, v3
    v_accvgpr_write_b32 a203, v110
    s_waitcnt lgkmcnt(8)
    v_perm_b32 v112, v113, v112, v3
    v_accvgpr_write_b32 a204, v112
    v_perm_b32 v114, v115, v114, v3
    v_accvgpr_write_b32 a205, v114
    v_perm_b32 v116, v117, v116, v3
    v_accvgpr_write_b32 a206, v116
    v_perm_b32 v118, v119, v118, v3
    v_accvgpr_write_b32 a207, v118
    s_waitcnt lgkmcnt(4)
    v_perm_b32 v120, v121, v120, v3
    v_accvgpr_write_b32 a208, v120
    v_perm_b32 v122, v123, v122, v3
    v_accvgpr_write_b32 a209, v122
    v_perm_b32 v124, v125, v124, v3
    v_accvgpr_write_b32 a210, v124
    v_perm_b32 v126, v127, v126, v3
    v_accvgpr_write_b32 a211, v126
    s_waitcnt lgkmcnt(0)
    v_perm_b32 v128, v129, v128, v3
    v_accvgpr_write_b32 a212, v128
    v_perm_b32 v130, v131, v130, v3
    v_accvgpr_write_b32 a213, v130
    v_perm_b32 v132, v133, v132, v3
    v_accvgpr_write_b32 a214, v132
    v_perm_b32 v134, v135, v134, v3
    v_accvgpr_write_b32 a215, v134
    s_waitcnt vmcnt(9)
    s_waitcnt lgkmcnt(0)
    s_barrier
    ds_read2st64_b32 v[64:65], v15 offset0:0 offset1:1
    ds_read2st64_b32 v[66:67], v15 offset0:2 offset1:3
    ds_read2st64_b32 v[68:69], v15 offset0:4 offset1:5
    ds_read2st64_b32 v[70:71], v15 offset0:6 offset1:7
    ds_read2st64_b32 v[72:73], v15 offset0:16 offset1:17
    ds_read2st64_b32 v[74:75], v15 offset0:18 offset1:19
    ds_read2st64_b32 v[76:77], v15 offset0:20 offset1:21
    ds_read2st64_b32 v[78:79], v15 offset0:22 offset1:23
    ds_read2st64_b32 v[80:81], v15 offset0:32 offset1:33
    ds_read2st64_b32 v[82:83], v15 offset0:34 offset1:35
    ds_read2st64_b32 v[84:85], v15 offset0:36 offset1:37
    ds_read2st64_b32 v[86:87], v15 offset0:38 offset1:39
    ds_read2st64_b32 v[88:89], v15 offset0:48 offset1:49
    ds_read2st64_b32 v[90:91], v15 offset0:50 offset1:51
    ds_read2st64_b32 v[92:93], v15 offset0:52 offset1:53
    ds_read2st64_b32 v[94:95], v15 offset0:54 offset1:55
    ds_read2st64_b32 v[96:97], v15 offset0:64 offset1:65
    ds_read2st64_b32 v[98:99], v15 offset0:66 offset1:67
    ds_read2st64_b32 v[100:101], v15 offset0:68 offset1:69
    ds_read2st64_b32 v[102:103], v15 offset0:70 offset1:71
    ds_read2st64_b32 v[104:105], v15 offset0:80 offset1:81
    ds_read2st64_b32 v[106:107], v15 offset0:82 offset1:83
    ds_read2st64_b32 v[108:109], v15 offset0:84 offset1:85
    ds_read2st64_b32 v[110:111], v15 offset0:86 offset1:87
    ds_read2st64_b32 v[112:113], v15 offset0:96 offset1:97
    ds_read2st64_b32 v[114:115], v15 offset0:98 offset1:99
    ds_read2st64_b32 v[116:117], v15 offset0:100 offset1:101
    ds_read2st64_b32 v[118:119], v15 offset0:102 offset1:103
    ds_read2st64_b32 v[120:121], v15 offset0:112 offset1:113
    ds_read2st64_b32 v[122:123], v15 offset0:114 offset1:115
    ds_read2st64_b32 v[124:125], v15 offset0:116 offset1:117
    ds_read2st64_b32 v[126:127], v15 offset0:118 offset1:119
    ds_read2st64_b32 v[128:129], v15 offset0:128 offset1:129
    ds_read2st64_b32 v[130:131], v15 offset0:130 offset1:131
    ds_read2st64_b32 v[132:133], v15 offset0:132 offset1:133
    ds_read2st64_b32 v[134:135], v15 offset0:134 offset1:135
    v_add_u32 v15, 36864, v15
    s_waitcnt lgkmcnt(15)
    v_perm_b32 v64, v65, v64, v3
    v_accvgpr_write_b32 a216, v64
    v_perm_b32 v66, v67, v66, v3
    v_accvgpr_write_b32 a217, v66
    v_perm_b32 v68, v69, v68, v3
    v_accvgpr_write_b32 a218, v68
    v_perm_b32 v70, v71, v70, v3
    v_accvgpr_write_b32 a219, v70
    v_perm_b32 v72, v73, v72, v3
    v_accvgpr_write_b32 a220, v72
    v_perm_b32 v74, v75, v74, v3
    v_accvgpr_write_b32 a221, v74
    v_perm_b32 v76, v77, v76, v3
    v_accvgpr_write_b32 a222, v76
    v_perm_b32 v78, v79, v78, v3
    v_accvgpr_write_b32 a223, v78
    v_perm_b32 v80, v81, v80, v3
    v_accvgpr_write_b32 a224, v80
    v_perm_b32 v82, v83, v82, v3
    v_accvgpr_write_b32 a225, v82
    v_perm_b32 v84, v85, v84, v3
    v_accvgpr_write_b32 a226, v84
    v_perm_b32 v86, v87, v86, v3
    v_accvgpr_write_b32 a227, v86
    v_perm_b32 v88, v89, v88, v3
    v_accvgpr_write_b32 a228, v88
    v_perm_b32 v90, v91, v90, v3
    v_accvgpr_write_b32 a229, v90
    v_perm_b32 v92, v93, v92, v3
    v_accvgpr_write_b32 a230, v92
    v_perm_b32 v94, v95, v94, v3
    v_accvgpr_write_b32 a231, v94
    v_perm_b32 v96, v97, v96, v3
    v_accvgpr_write_b32 a232, v96
    v_perm_b32 v98, v99, v98, v3
    v_accvgpr_write_b32 a233, v98
    v_perm_b32 v100, v101, v100, v3
    v_accvgpr_write_b32 a234, v100
    v_perm_b32 v102, v103, v102, v3
    v_accvgpr_write_b32 a235, v102
    s_waitcnt lgkmcnt(12)
    v_perm_b32 v104, v105, v104, v3
    v_accvgpr_write_b32 a236, v104
    v_perm_b32 v106, v107, v106, v3
    v_accvgpr_write_b32 a237, v106
    v_perm_b32 v108, v109, v108, v3
    v_accvgpr_write_b32 a238, v108
    v_perm_b32 v110, v111, v110, v3
    v_accvgpr_write_b32 a239, v110
    s_waitcnt lgkmcnt(8)
    v_perm_b32 v112, v113, v112, v3
    v_accvgpr_write_b32 a240, v112
    v_perm_b32 v114, v115, v114, v3
    v_accvgpr_write_b32 a241, v114
    v_perm_b32 v116, v117, v116, v3
    v_accvgpr_write_b32 a242, v116
    v_perm_b32 v118, v119, v118, v3
    v_accvgpr_write_b32 a243, v118
    s_waitcnt lgkmcnt(4)
    v_perm_b32 v120, v121, v120, v3
    v_accvgpr_write_b32 a244, v120
    v_perm_b32 v122, v123, v122, v3
    v_accvgpr_write_b32 a245, v122
    v_perm_b32 v124, v125, v124, v3
    v_accvgpr_write_b32 a246, v124
    v_perm_b32 v126, v127, v126, v3
    v_accvgpr_write_b32 a247, v126
    s_waitcnt lgkmcnt(0)
    v_perm_b32 v128, v129, v128, v3
    v_accvgpr_write_b32 a248, v128
    v_perm_b32 v130, v131, v130, v3
    v_accvgpr_write_b32 a249, v130
    v_perm_b32 v132, v133, v132, v3
    v_accvgpr_write_b32 a250, v132
    v_perm_b32 v134, v135, v134, v3
    v_accvgpr_write_b32 a251, v134
    s_waitcnt vmcnt(0)
    s_waitcnt lgkmcnt(0)
    s_barrier
    ds_read2st64_b32 v[64:65], v15 offset0:0 offset1:1
    ds_read2st64_b32 v[66:67], v15 offset0:2 offset1:3
    ds_read2st64_b32 v[68:69], v15 offset0:4 offset1:5
    ds_read2st64_b32 v[70:71], v15 offset0:6 offset1:7
    ds_read2st64_b32 v[72:73], v15 offset0:16 offset1:17
    ds_read2st64_b32 v[74:75], v15 offset0:18 offset1:19
    ds_read2st64_b32 v[76:77], v15 offset0:20 offset1:21
    ds_read2st64_b32 v[78:79], v15 offset0:22 offset1:23
    ds_read2st64_b32 v[80:81], v15 offset0:32 offset1:33
    ds_read2st64_b32 v[82:83], v15 offset0:34 offset1:35
    ds_read2st64_b32 v[84:85], v15 offset0:36 offset1:37
    ds_read2st64_b32 v[86:87], v15 offset0:38 offset1:39
    ds_read2st64_b32 v[88:89], v15 offset0:48 offset1:49
    ds_read2st64_b32 v[90:91], v15 offset0:50 offset1:51
    ds_read2st64_b32 v[92:93], v15 offset0:52 offset1:53
    ds_read2st64_b32 v[94:95], v15 offset0:54 offset1:55
    ds_read2st64_b32 v[96:97], v15 offset0:64 offset1:65
    ds_read2st64_b32 v[98:99], v15 offset0:66 offset1:67
    ds_read2st64_b32 v[100:101], v15 offset0:68 offset1:69
    ds_read2st64_b32 v[102:103], v15 offset0:70 offset1:71
    ds_read2st64_b32 v[104:105], v15 offset0:80 offset1:81
    ds_read2st64_b32 v[106:107], v15 offset0:82 offset1:83
    ds_read2st64_b32 v[108:109], v15 offset0:84 offset1:85
    ds_read2st64_b32 v[110:111], v15 offset0:86 offset1:87
    ds_read2st64_b32 v[112:113], v15 offset0:96 offset1:97
    ds_read2st64_b32 v[114:115], v15 offset0:98 offset1:99
    ds_read2st64_b32 v[116:117], v15 offset0:100 offset1:101
    ds_read2st64_b32 v[118:119], v15 offset0:102 offset1:103
    ds_read2st64_b32 v[120:121], v15 offset0:112 offset1:113
    ds_read2st64_b32 v[122:123], v15 offset0:114 offset1:115
    ds_read2st64_b32 v[124:125], v15 offset0:116 offset1:117
    ds_read2st64_b32 v[126:127], v15 offset0:118 offset1:119
    ds_read2st64_b32 v[128:129], v15 offset0:128 offset1:129
    ds_read2st64_b32 v[130:131], v15 offset0:130 offset1:131
    ds_read2st64_b32 v[132:133], v15 offset0:132 offset1:133
    ds_read2st64_b32 v[134:135], v15 offset0:134 offset1:135
    v_add_u32 v15, 36864, v15
    s_waitcnt lgkmcnt(15)
    v_perm_b32 v64, v65, v64, v3
    v_accvgpr_write_b32 a252, v64
    v_perm_b32 v66, v67, v66, v3
    v_accvgpr_write_b32 a253, v66
    v_perm_b32 v68, v69, v68, v3
    v_accvgpr_write_b32 a254, v68
    v_perm_b32 v70, v71, v70, v3
    v_accvgpr_write_b32 a255, v70
    v_perm_b32 v224, v73, v72, v3
    v_perm_b32 v225, v75, v74, v3
    v_perm_b32 v226, v77, v76, v3
    v_perm_b32 v227, v79, v78, v3
    v_perm_b32 v228, v81, v80, v3
    v_perm_b32 v229, v83, v82, v3
    v_perm_b32 v230, v85, v84, v3
    v_perm_b32 v231, v87, v86, v3
    v_perm_b32 v232, v89, v88, v3
    v_perm_b32 v233, v91, v90, v3
    v_perm_b32 v234, v93, v92, v3
    v_perm_b32 v235, v95, v94, v3
    v_perm_b32 v236, v97, v96, v3
    v_perm_b32 v237, v99, v98, v3
    v_perm_b32 v238, v101, v100, v3
    v_perm_b32 v239, v103, v102, v3
    s_waitcnt lgkmcnt(12)
    v_perm_b32 v240, v105, v104, v3
    v_perm_b32 v241, v107, v106, v3
    v_perm_b32 v242, v109, v108, v3
    v_perm_b32 v243, v111, v110, v3
    s_waitcnt lgkmcnt(8)
    v_perm_b32 v244, v113, v112, v3
    v_perm_b32 v245, v115, v114, v3
    v_perm_b32 v246, v117, v116, v3
    v_perm_b32 v247, v119, v118, v3
    s_waitcnt lgkmcnt(4)
    v_perm_b32 v248, v121, v120, v3
    v_perm_b32 v249, v123, v122, v3
    v_perm_b32 v250, v125, v124, v3
    v_perm_b32 v251, v127, v126, v3
    s_waitcnt lgkmcnt(0)
    v_perm_b32 v252, v129, v128, v3
    v_perm_b32 v253, v131, v130, v3
    v_perm_b32 v254, v133, v132, v3
    v_perm_b32 v255, v135, v134, v3
    v_lshrrev_b32 v2, 3, v1
    s_lshl_b32 s16, s13, 3
    v_add_u32 v2, s16, v2
    v_mul_u32_u24 v4, 1152, v2
    v_bfe_u32 v2, v2, 1, 3
    v_and_b32 v3, 7, v1
    v_xor_b32 v2, v2, v3
    v_lshl_add_u32 v4, v2, 4, v4
    v_bfe_u32 v2, v1, 3, 2
    v_mul_u32_u24 v5, 9216, v2
    v_lshl_add_u32 v5, v3, 7, v5
    v_bfe_u32 v2, v1, 1, 3
    v_lshrrev_b32 v3, 5, v1
    v_xor_b32 v2, v2, v3
    v_lshl_add_u32 v5, v2, 4, v5
    v_xor_b32 v6, 32, v5
    v_xor_b32 v7, 64, v5
    v_xor_b32 v8, 96, v5
    v_bfe_u32 v9, v1, 3, 1
    v_lshlrev_b32 v9, 10, v9
    v_bfe_u32 v2, v1, 4, 1
    v_lshl_add_u32 v9, v2, 7, v9
    v_lshlrev_b32 v10, 10, v2
    v_and_b32 v2, 7, v1
    v_lshl_add_u32 v9, v2, 4, v9
    v_and_b32 v2, 15, v1
    v_lshl_add_u32 v10, v2, 4, v10
    v_lshrrev_b32 v2, 5, v1
    v_lshl_add_u32 v9, v2, 8, v9
    v_lshl_add_u32 v10, v2, 8, v10
    v_add_u32 v10, 8192, v10
    v_lshlrev_b32 v11, 1, v1
    s_mov_b32 s20, 0
    s_mov_b32 s21, 2097152
    s_mov_b32 s22, 0
    s_lshl_b32 s23, s12, 14
    s_lshl_b32 s16, s13, 11
    s_add_u32 s23, s23, s16
    s_add_u32 s23, s23, 33554432
    s_lshl_b32 s25, s12, 7
    s_mov_b32 s14, 0
    s_mov_b32 s24, 1
    v_mbcnt_lo_u32_b32 v2, -1, 0
    v_mbcnt_hi_u32_b32 v2, -1, v2
    v_and_b32 v2, 31, v2
    v_lshlrev_b32 v2, 2, v2
    s_mov_b32 s45, 131072
L_ver_29:
    buffer_load_dword v3, v2, s[84:87], 0 offen sc1
    s_sub_u32 s45, s45, 1
    s_cbranch_scc1 ABORT
    s_waitcnt vmcnt(0)
L_verchk_31:
    v_readlane_b32 s66, v3, 0
    v_readlane_b32 s67, v3, 4
    v_readlane_b32 s68, v3, 8
    v_readlane_b32 s69, v3, 12
    v_readlane_b32 s70, v3, 16
    v_readlane_b32 s71, v3, 20
    v_readlane_b32 s72, v3, 24
    v_readlane_b32 s73, v3, 28
    v_readlane_b32 s74, v3, 1
    s_add_u32 s75, s66, s67
    s_add_u32 s75, s75, s68
    s_add_u32 s75, s75, s69
    s_add_u32 s75, s75, s70
    s_add_u32 s75, s75, s71
    s_add_u32 s75, s75, s72
    s_add_u32 s75, s75, s73
    s_add_u32 s75, s75, s74
    s_cmp_ge_u32 s75, 267
    s_cbranch_scc1 L_ver_29_d
    s_sleep 16
    s_branch L_ver_29
L_ver_29_d:
    s_cmp_eq_u32 s93, 1
    s_cbranch_scc1 L_verok_30
    s_or_b32 s75, s66, s67
    s_or_b32 s75, s75, s68
    s_or_b32 s75, s75, s69
    s_or_b32 s75, s75, s70
    s_or_b32 s75, s75, s71
    s_or_b32 s75, s75, s72
    s_or_b32 s75, s75, s73
    s_cmp_lg_u32 s75, 32
    s_cbranch_scc1 REROLE
L_verok_30:
    s_barrier
    s_cmp_ge_u32 s20, s24
    s_cbranch_scc1 L_xok_33
    s_mov_b32 s45, 131072
L_xw_32:
    buffer_load_ushort v12, v11, s[84:87], 0 offen offset:128 sc1
    s_sub_u32 s45, s45, 1
    s_cbranch_scc1 ABORT
    s_waitcnt vmcnt(0)
    v_cmp_eq_u32 vcc, 0x101, v12
    s_nop 0
    s_ff0_i32_b64 s20, vcc
    s_cmp_ge_u32 s20, s24
    s_cbranch_scc1 L_xok_33
    s_sleep 8
    s_branch L_xw_32
L_xok_33:
    s_mul_i32 s16, s13, 9216
    s_add_u32 m0, s16, s22
    s_nop 0
    buffer_load_dwordx4 v4, s[4:7], s21 offen offset:0 sc1 lds
    s_add_u32 m0, m0, 896
    s_nop 0
    buffer_load_dwordx4 v4, s[4:7], s21 offen offset:128 sc1 lds
    s_add_u32 m0, m0, 896
    s_nop 0
    buffer_load_dwordx4 v4, s[4:7], s21 offen offset:256 sc1 lds
    s_add_u32 m0, m0, 896
    s_nop 0
    buffer_load_dwordx4 v4, s[4:7], s21 offen offset:384 sc1 lds
    s_add_u32 m0, m0, 896
    s_nop 0
    buffer_load_dwordx4 v4, s[4:7], s21 offen offset:512 sc1 lds
    s_add_u32 m0, m0, 896
    s_nop 0
    buffer_load_dwordx4 v4, s[4:7], s21 offen offset:640 sc1 lds
    s_add_u32 m0, m0, 896
    s_nop 0
    buffer_load_dwordx4 v4, s[4:7], s21 offen offset:768 sc1 lds
    s_add_u32 m0, m0, 896
    s_nop 0
    buffer_load_dwordx4 v4, s[4:7], s21 offen offset:896 sc1 lds
    s_add_u32 m0, m0, 896
    s_nop 0
    buffer_load_dwordx4 v4, s[4:7], s21 offen offset:1024 sc1 lds
    s_waitcnt vmcnt(0)
    s_barrier
L_kvloop_34:
    ds_read_b128 v[16:19], v5 offset:0
    ds_read_b128 v[20:23], v6 offset:0
    ds_read_b128 v[24:27], v7 offset:0
    s_add_u32 s24, s14, 2
    s_min_u32 s24, s24, 64
    s_xor_b32 s22, s22, 36864
    s_cmp_eq_u32 s14, 63
    s_cselect_b32 s16, 0, 36864
    s_add_u32 s21, s21, s16
    s_cmp_ge_u32 s20, s24
    s_cbranch_scc1 L_xok_37
    s_mov_b32 s45, 131072
L_xw_36:
    buffer_load_ushort v12, v11, s[84:87], 0 offen offset:128 sc1
    s_sub_u32 s45, s45, 1
    s_cbranch_scc1 ABORT
    s_waitcnt vmcnt(0)
    v_cmp_eq_u32 vcc, 0x101, v12
    s_nop 0
    s_ff0_i32_b64 s20, vcc
    s_cmp_ge_u32 s20, s24
    s_cbranch_scc1 L_xok_37
    s_sleep 8
    s_branch L_xw_36
L_xok_37:
    s_mul_i32 s16, s13, 9216
    s_add_u32 m0, s16, s22
    ds_read_b128 v[28:31], v8 offset:0
    s_waitcnt lgkmcnt(3)
    v_mfma_f32_32x32x16_bf16 v[32:47], a[0:3], v[16:19], 0
    buffer_load_dwordx4 v4, s[4:7], s21 offen offset:0 sc1 lds
    s_add_u32 m0, m0, 896
    v_mfma_f32_32x32x16_bf16 v[48:63], v[16:19], a[144:147], 0
    ds_read_b128 v[16:19], v5 offset:1024
    s_waitcnt lgkmcnt(3)
    v_mfma_f32_32x32x16_bf16 v[32:47], a[4:7], v[20:23], v[32:47]
    buffer_load_dwordx4 v4, s[4:7], s21 offen offset:128 sc1 lds
    s_add_u32 m0, m0, 896
    v_mfma_f32_32x32x16_bf16 v[48:63], v[20:23], a[148:151], v[48:63]
    ds_read_b128 v[20:23], v6 offset:1024
    s_waitcnt lgkmcnt(3)
    v_mfma_f32_32x32x16_bf16 v[32:47], a[8:11], v[24:27], v[32:47]
    buffer_load_dwordx4 v4, s[4:7], s21 offen offset:256 sc1 lds
    s_add_u32 m0, m0, 896
    v_mfma_f32_32x32x16_bf16 v[48:63], v[24:27], a[152:155], v[48:63]
    ds_read_b128 v[24:27], v7 offset:1024
    s_waitcnt lgkmcnt(3)
    v_mfma_f32_32x32x16_bf16 v[32:47], a[12:15], v[28:31], v[32:47]
    buffer_load_dwordx4 v4, s[4:7], s21 offen offset:384 sc1 lds
    s_add_u32 m0, m0, 896
    v_mfma_f32_32x32x16_bf16 v[48:63], v[28:31], a[156:159], v[48:63]
    ds_read_b128 v[28:31], v8 offset:1024
    s_waitcnt lgkmcnt(3)
    v_mfma_f32_32x32x16_bf16 v[32:47], a[16:19], v[16:19], v[32:47]
    buffer_load_dwordx4 v4, s[4:7], s21 offen offset:512 sc1 lds
    s_add_u32 m0, m0, 896
    v_mfma_f32_32x32x16_bf16 v[48:63], v[16:19], a[160:163], v[48:63]
    ds_read_b128 v[16:19], v5 offset:2048
    s_waitcnt lgkmcnt(3)
    v_mfma_f32_32x32x16_bf16 v[32:47], a[20:23], v[20:23], v[32:47]
    buffer_load_dwordx4 v4, s[4:7], s21 offen offset:640 sc1 lds
    s_add_u32 m0, m0, 896
    v_mfma_f32_32x32x16_bf16 v[48:63], v[20:23], a[164:167], v[48:63]
    ds_read_b128 v[20:23], v6 offset:2048
    s_waitcnt lgkmcnt(3)
    v_mfma_f32_32x32x16_bf16 v[32:47], a[24:27], v[24:27], v[32:47]
    buffer_load_dwordx4 v4, s[4:7], s21 offen offset:768 sc1 lds
    s_add_u32 m0, m0, 896
    v_mfma_f32_32x32x16_bf16 v[48:63], v[24:27], a[168:171], v[48:63]
    ds_read_b128 v[24:27], v7 offset:2048
    s_waitcnt lgkmcnt(3)
    v_mfma_f32_32x32x16_bf16 v[32:47], a[28:31], v[28:31], v[32:47]
    buffer_load_dwordx4 v4, s[4:7], s21 offen offset:896 sc1 lds
    s_add_u32 m0, m0, 896
    v_mfma_f32_32x32x16_bf16 v[48:63], v[28:31], a[172:175], v[48:63]
    ds_read_b128 v[28:31], v8 offset:2048
    s_waitcnt lgkmcnt(3)
    v_mfma_f32_32x32x16_bf16 v[32:47], a[32:35], v[16:19], v[32:47]
    buffer_load_dwordx4 v4, s[4:7], s21 offen offset:1024 sc1 lds
    s_add_u32 m0, m0, 896
    v_mfma_f32_32x32x16_bf16 v[48:63], v[16:19], a[176:179], v[48:63]
    ds_read_b128 v[16:19], v5 offset:3072
    s_waitcnt lgkmcnt(3)
    v_mfma_f32_32x32x16_bf16 v[32:47], a[36:39], v[20:23], v[32:47]
    v_mfma_f32_32x32x16_bf16 v[48:63], v[20:23], a[180:183], v[48:63]
    ds_read_b128 v[20:23], v6 offset:3072
    s_waitcnt lgkmcnt(3)
    v_mfma_f32_32x32x16_bf16 v[32:47], a[40:43], v[24:27], v[32:47]
    v_mfma_f32_32x32x16_bf16 v[48:63], v[24:27], a[184:187], v[48:63]
    ds_read_b128 v[24:27], v7 offset:3072
    s_waitcnt lgkmcnt(3)
    v_mfma_f32_32x32x16_bf16 v[32:47], a[44:47], v[28:31], v[32:47]
    v_mfma_f32_32x32x16_bf16 v[48:63], v[28:31], a[188:191], v[48:63]
    ds_read_b128 v[28:31], v8 offset:3072
    s_waitcnt lgkmcnt(3)
    v_mfma_f32_32x32x16_bf16 v[32:47], a[48:51], v[16:19], v[32:47]
    v_mfma_f32_32x32x16_bf16 v[48:63], v[16:19], a[192:195], v[48:63]
    ds_read_b128 v[16:19], v5 offset:4096
    s_waitcnt lgkmcnt(3)
    v_mfma_f32_32x32x16_bf16 v[32:47], a[52:55], v[20:23], v[32:47]
    v_mfma_f32_32x32x16_bf16 v[48:63], v[20:23], a[196:199], v[48:63]
    ds_read_b128 v[20:23], v6 offset:4096
    s_waitcnt lgkmcnt(3)
    v_mfma_f32_32x32x16_bf16 v[32:47], a[56:59], v[24:27], v[32:47]
    v_mfma_f32_32x32x16_bf16 v[48:63], v[24:27], a[200:203], v[48:63]
    ds_read_b128 v[24:27], v7 offset:4096
    s_waitcnt lgkmcnt(3)
    v_mfma_f32_32x32x16_bf16 v[32:47], a[60:63], v[28:31], v[32:47]
    v_mfma_f32_32x32x16_bf16 v[48:63], v[28:31], a[204:207], v[48:63]
    ds_read_b128 v[28:31], v8 offset:4096
    s_waitcnt lgkmcnt(3)
    v_mfma_f32_32x32x16_bf16 v[32:47], a[64:67], v[16:19], v[32:47]
    v_mfma_f32_32x32x16_bf16 v[48:63], v[16:19], a[208:211], v[48:63]
    ds_read_b128 v[16:19], v5 offset:5120
    s_waitcnt lgkmcnt(3)
    v_mfma_f32_32x32x16_bf16 v[32:47], a[68:71], v[20:23], v[32:47]
    v_mfma_f32_32x32x16_bf16 v[48:63], v[20:23], a[212:215], v[48:63]
    ds_read_b128 v[20:23], v6 offset:5120
    s_waitcnt lgkmcnt(3)
    v_mfma_f32_32x32x16_bf16 v[32:47], a[72:75], v[24:27], v[32:47]
    v_mfma_f32_32x32x16_bf16 v[48:63], v[24:27], a[216:219], v[48:63]
    ds_read_b128 v[24:27], v7 offset:5120
    s_waitcnt lgkmcnt(3)
    v_mfma_f32_32x32x16_bf16 v[32:47], a[76:79], v[28:31], v[32:47]
    v_mfma_f32_32x32x16_bf16 v[48:63], v[28:31], a[220:223], v[48:63]
    ds_read_b128 v[28:31], v8 offset:5120
    s_waitcnt lgkmcnt(3)
    v_mfma_f32_32x32x16_bf16 v[32:47], a[80:83], v[16:19], v[32:47]
    v_mfma_f32_32x32x16_bf16 v[48:63], v[16:19], a[224:227], v[48:63]
    ds_read_b128 v[16:19], v5 offset:6144
    s_waitcnt lgkmcnt(3)
    v_mfma_f32_32x32x16_bf16 v[32:47], a[84:87], v[20:23], v[32:47]
    v_mfma_f32_32x32x16_bf16 v[48:63], v[20:23], a[228:231], v[48:63]
    ds_read_b128 v[20:23], v6 offset:6144
    s_waitcnt lgkmcnt(3)
    v_mfma_f32_32x32x16_bf16 v[32:47], a[88:91], v[24:27], v[32:47]
    v_mfma_f32_32x32x16_bf16 v[48:63], v[24:27], a[232:235], v[48:63]
    ds_read_b128 v[24:27], v7 offset:6144
    s_waitcnt lgkmcnt(3)
    v_mfma_f32_32x32x16_bf16 v[32:47], a[92:95], v[28:31], v[32:47]
    v_mfma_f32_32x32x16_bf16 v[48:63], v[28:31], a[236:239], v[48:63]
    ds_read_b128 v[28:31], v8 offset:6144
    s_waitcnt lgkmcnt(3)
    v_mfma_f32_32x32x16_bf16 v[32:47], a[96:99], v[16:19], v[32:47]
    v_mfma_f32_32x32x16_bf16 v[48:63], v[16:19], a[240:243], v[48:63]
    ds_read_b128 v[16:19], v5 offset:7168
    s_waitcnt lgkmcnt(3)
    v_mfma_f32_32x32x16_bf16 v[32:47], a[100:103], v[20:23], v[32:47]
    v_mfma_f32_32x32x16_bf16 v[48:63], v[20:23], a[244:247], v[48:63]
    ds_read_b128 v[20:23], v6 offset:7168
    s_waitcnt lgkmcnt(3)
    v_mfma_f32_32x32x16_bf16 v[32:47], a[104:107], v[24:27], v[32:47]
    v_mfma_f32_32x32x16_bf16 v[48:63], v[24:27], a[248:251], v[48:63]
    ds_read_b128 v[24:27], v7 offset:7168
    s_waitcnt lgkmcnt(3)
    v_mfma_f32_32x32x16_bf16 v[32:47], a[108:111], v[28:31], v[32:47]
    v_mfma_f32_32x32x16_bf16 v[48:63], v[28:31], a[252:255], v[48:63]
    ds_read_b128 v[28:31], v8 offset:7168
    s_waitcnt lgkmcnt(3)
    v_mfma_f32_32x32x16_bf16 v[32:47], a[112:115], v[16:19], v[32:47]
    v_mfma_f32_32x32x16_bf16 v[48:63], v[16:19], v[224:227], v[48:63]
    ds_read_b128 v[16:19], v5 offset:8192
    s_waitcnt lgkmcnt(3)
    v_mfma_f32_32x32x16_bf16 v[32:47], a[116:119], v[20:23], v[32:47]
    v_mfma_f32_32x32x16_bf16 v[48:63], v[20:23], v[228:231], v[48:63]
    ds_read_b128 v[20:23], v6 offset:8192
    s_waitcnt lgkmcnt(3)
    v_mfma_f32_32x32x16_bf16 v[32:47], a[120:123], v[24:27], v[32:47]
    v_mfma_f32_32x32x16_bf16 v[48:63], v[24:27], v[232:235], v[48:63]
    ds_read_b128 v[24:27], v7 offset:8192
    s_waitcnt lgkmcnt(3)
    v_mfma_f32_32x32x16_bf16 v[32:47], a[124:127], v[28:31], v[32:47]
    v_mfma_f32_32x32x16_bf16 v[48:63], v[28:31], v[236:239], v[48:63]
    ds_read_b128 v[28:31], v8 offset:8192
    s_waitcnt lgkmcnt(3)
    v_mfma_f32_32x32x16_bf16 v[32:47], a[128:131], v[16:19], v[32:47]
    v_mfma_f32_32x32x16_bf16 v[48:63], v[16:19], v[240:243], v[48:63]
    s_waitcnt lgkmcnt(2)
    v_mfma_f32_32x32x16_bf16 v[32:47], a[132:135], v[20:23], v[32:47]
    v_mfma_f32_32x32x16_bf16 v[48:63], v[20:23], v[244:247], v[48:63]
    s_waitcnt lgkmcnt(1)
    v_mfma_f32_32x32x16_bf16 v[32:47], a[136:139], v[24:27], v[32:47]
    v_mfma_f32_32x32x16_bf16 v[48:63], v[24:27], v[248:251], v[48:63]
    s_waitcnt lgkmcnt(0)
    v_mfma_f32_32x32x16_bf16 v[32:47], a[140:143], v[28:31], v[32:47]
    v_mfma_f32_32x32x16_bf16 v[48:63], v[28:31], v[252:255], v[48:63]
    s_lshl_b32 s16, s22, 1
    s_sub_u32 s16, s16, 36864
    v_add_u32 v5, s16, v5
    v_add_u32 v6, s16, v6
    v_add_u32 v7, s16, v7
    v_add_u32 v8, s16, v8
    s_nop 4
    v_cvt_pk_bf16_f32 v32, v32, v33
    v_cvt_pk_bf16_f32 v33, v34, v35
    v_cvt_pk_bf16_f32 v34, v36, v37
    v_cvt_pk_bf16_f32 v35, v38, v39
    v_cvt_pk_bf16_f32 v36, v40, v41
    v_cvt_pk_bf16_f32 v37, v42, v43
    v_cvt_pk_bf16_f32 v38, v44, v45
    v_cvt_pk_bf16_f32 v39, v46, v47
    buffer_store_dwordx4 v[32:35], v9, s[4:7], s23 offen offset:0 sc1
    buffer_store_dwordx4 v[36:39], v9, s[4:7], s23 offen offset:512 sc1
    v_cvt_pk_bf16_f32 v48, v48, v49
    v_cvt_pk_bf16_f32 v49, v50, v51
    v_cvt_pk_bf16_f32 v50, v52, v53
    v_cvt_pk_bf16_f32 v51, v54, v55
    v_cvt_pk_bf16_f32 v52, v56, v57
    v_cvt_pk_bf16_f32 v53, v58, v59
    v_cvt_pk_bf16_f32 v54, v60, v61
    v_cvt_pk_bf16_f32 v55, v62, v63
    buffer_store_dwordx4 v[48:51], v10, s[4:7], s23 offen offset:0 sc1
    buffer_store_dwordx4 v[52:55], v10, s[4:7], s23 offen offset:512 sc1
    s_add_u32 s23, s23, 524288
    s_mov_b32 s19, s14
    s_cmp_lg_u32 s14, 1
    s_cbranch_scc1 L_kveg_39
    s_waitcnt vmcnt(0)
    s_mov_b32 s19, 2
L_kveg_39:
    s_waitcnt vmcnt(4)
    s_barrier
    s_cmp_lg_u32 s13, 0
    s_cbranch_scc1 L_kvnf_38
    v_mov_b32 v12, s19
    s_mov_b64 exec, 1
    buffer_store_dword v12, off, s[4:7], s25 offset:0 sc1
    s_mov_b64 exec, -1
L_kvnf_38:
    s_add_u32 s14, s14, 1
    s_cmp_lt_u32 s14, 64
    s_cbranch_scc1 L_kvloop_34
    s_waitcnt vmcnt(0)
    s_barrier
    s_cmp_lg_u32 s13, 0
    s_cbranch_scc1 END
    v_mov_b32 v12, s14
    s_mov_b64 exec, 1
    buffer_store_dword v12, off, s[4:7], s25 offset:0 sc1
    s_mov_b64 exec, -1
    s_endpgm
ROLE_QA:
    v_mbcnt_lo_u32_b32 v1, -1, 0
    v_mbcnt_hi_u32_b32 v1, -1, v1
    s_load_dwordx2 s[8:9], s[0:1], 16
    s_mov_b32 s10, 4718592
    s_mov_b32 s11, 0x20000
    s_waitcnt lgkmcnt(0)
    s_lshl_b32 s16, s12, 8
    v_lshrrev_b32 v2, 4, v1
    v_mul_u32_u24 v2, 8192, v2
    v_and_b32 v3, 15, v1
    v_lshl_add_u32 v2, v3, 4, v2
    s_mul_i32 s17, s13, 32768
    s_add_u32 s17, s17, s16
    s_lshl_b32 s18, s13, 10
    s_add_u32 m0, s18, 0
    s_nop 0
    buffer_load_dwordx4 v2, s[8:11], s17 offen lds
    s_add_u32 s17, s17, 131072
    s_add_u32 m0, m0, 4096
    s_nop 0
    buffer_load_dwordx4 v2, s[8:11], s17 offen lds
    s_add_u32 s17, s17, 131072
    s_add_u32 m0, m0, 4096
    s_nop 0
    buffer_load_dwordx4 v2, s[8:11], s17 offen lds
    s_add_u32 s17, s17, 131072
    s_add_u32 m0, m0, 4096
    s_nop 0
    buffer_load_dwordx4 v2, s[8:11], s17 offen lds
    s_add_u32 s17, s17, 131072
    s_add_u32 m0, m0, 4096
    s_nop 0
    buffer_load_dwordx4 v2, s[8:11], s17 offen lds
    s_add_u32 s17, s17, 131072
    s_add_u32 m0, m0, 4096
    s_nop 0
    buffer_load_dwordx4 v2, s[8:11], s17 offen lds
    s_add_u32 s17, s17, 131072
    s_add_u32 m0, m0, 4096
    s_nop 0
    buffer_load_dwordx4 v2, s[8:11], s17 offen lds
    s_add_u32 s17, s17, 131072
    s_add_u32 m0, m0, 4096
    s_nop 0
    buffer_load_dwordx4 v2, s[8:11], s17 offen lds
    s_add_u32 s17, s17, 131072
    s_add_u32 m0, m0, 4096
    s_nop 0
    buffer_load_dwordx4 v2, s[8:11], s17 offen lds
    s_add_u32 s17, s17, 131072
    s_add_u32 m0, m0, 4096
    s_nop 0
    buffer_load_dwordx4 v2, s[8:11], s17 offen lds
    s_add_u32 s17, s17, 131072
    s_add_u32 m0, m0, 4096
    s_nop 0
    buffer_load_dwordx4 v2, s[8:11], s17 offen lds
    s_add_u32 s17, s17, 131072
    s_add_u32 m0, m0, 4096
    s_nop 0
    buffer_load_dwordx4 v2, s[8:11], s17 offen lds
    s_add_u32 s17, s17, 131072
    s_add_u32 m0, m0, 4096
    s_nop 0
    buffer_load_dwordx4 v2, s[8:11], s17 offen lds
    s_add_u32 s17, s17, 131072
    s_add_u32 m0, m0, 4096
    s_nop 0
    buffer_load_dwordx4 v2, s[8:11], s17 offen lds
    s_add_u32 s17, s17, 131072
    s_add_u32 m0, m0, 4096
    s_nop 0
    buffer_load_dwordx4 v2, s[8:11], s17 offen lds
    s_add_u32 s17, s17, 131072
    s_add_u32 m0, m0, 4096
    s_nop 0
    buffer_load_dwordx4 v2, s[8:11], s17 offen lds
    s_add_u32 s17, s17, 131072
    s_add_u32 m0, m0, 4096
    s_nop 0
    buffer_load_dwordx4 v2, s[8:11], s17 offen lds
    s_add_u32 s17, s17, 131072
    s_add_u32 m0, m0, 4096
    s_nop 0
    buffer_load_dwordx4 v2, s[8:11], s17 offen lds
    s_add_u32 s17, s17, 131072
    s_add_u32 m0, m0, 4096
    s_nop 0
    buffer_load_dwordx4 v2, s[8:11], s17 offen lds
    s_add_u32 s17, s17, 131072
    s_add_u32 m0, m0, 4096
    s_nop 0
    buffer_load_dwordx4 v2, s[8:11], s17 offen lds
    s_add_u32 s17, s17, 131072
    s_add_u32 m0, m0, 4096
    s_nop 0
    buffer_load_dwordx4 v2, s[8:11], s17 offen lds
    s_add_u32 s17, s17, 131072
    s_add_u32 m0, m0, 4096
    s_nop 0
    buffer_load_dwordx4 v2, s[8:11], s17 offen lds
    s_add_u32 s17, s17, 131072
    s_add_u32 m0, m0, 4096
    s_nop 0
    buffer_load_dwordx4 v2, s[8:11], s17 offen lds
    s_add_u32 s17, s17, 131072
    s_add_u32 m0, m0, 4096
    s_nop 0
    buffer_load_dwordx4 v2, s[8:11], s17 offen lds
    s_add_u32 s17, s17, 131072
    s_add_u32 m0, m0, 4096
    s_nop 0
    buffer_load_dwordx4 v2, s[8:11], s17 offen lds
    s_add_u32 s17, s17, 131072
    s_add_u32 m0, m0, 4096
    s_nop 0
    buffer_load_dwordx4 v2, s[8:11], s17 offen lds
    s_add_u32 s17, s17, 131072
    s_add_u32 m0, m0, 4096
    s_nop 0
    buffer_load_dwordx4 v2, s[8:11], s17 offen lds
    s_add_u32 s17, s17, 131072
    s_add_u32 m0, m0, 4096
    s_nop 0
    buffer_load_dwordx4 v2, s[8:11], s17 offen lds
    s_add_u32 s17, s17, 131072
    s_add_u32 m0, m0, 4096
    s_nop 0
    buffer_load_dwordx4 v2, s[8:11], s17 offen lds
    s_add_u32 s17, s17, 131072
    s_add_u32 m0, m0, 4096
    s_nop 0
    buffer_load_dwordx4 v2, s[8:11], s17 offen lds
    s_add_u32 s17, s17, 131072
    s_add_u32 m0, m0, 4096
    s_nop 0
    buffer_load_dwordx4 v2, s[8:11], s17 offen lds
    s_add_u32 s17, s17, 131072
    s_add_u32 m0, m0, 4096
    s_nop 0
    buffer_load_dwordx4 v2, s[8:11], s17 offen lds
    s_add_u32 s17, s17, 131072
    s_add_u32 m0, m0, 4096
    s_nop 0
    buffer_load_dwordx4 v2, s[8:11], s17 offen lds
    s_add_u32 s17, s17, 131072
    s_add_u32 m0, m0, 4096
    s_nop 0
    buffer_load_dwordx4 v2, s[8:11], s17 offen lds
    s_add_u32 s17, s17, 131072
    s_add_u32 m0, m0, 4096
    s_nop 0
    buffer_load_dwordx4 v2, s[8:11], s17 offen lds
    s_add_u32 s17, s17, 131072
    s_add_u32 m0, m0, 4096
    s_nop 0
    buffer_load_dwordx4 v2, s[8:11], s17 offen lds
    v_lshrrev_b32 v4, 5, v1
    v_bfe_u32 v2, v1, 2, 2
    v_lshl_add_u32 v4, v4, 3, v2
    v_mul_u32_u24 v4, 256, v4
    v_bfe_u32 v2, v1, 4, 1
    v_mul_u32_u24 v2, 32, v2
    v_add_u32 v4, v4, v2
    v_and_b32 v2, 1, v1
    v_lshl_add_u32 v4, v2, 4, v4
    v_bfe_u32 v2, v1, 1, 1
    v_lshl_add_u32 v4, v2, 3, v4
    s_lshl_b32 s16, s13, 6
    v_add_u32 v4, s16, v4
    s_waitcnt vmcnt(0)
    s_barrier
    ds_read_b64_tr_b16 a[0:1], v4 offset:0
    ds_read_b64_tr_b16 a[2:3], v4 offset:1024
    ds_read_b64_tr_b16 a[4:5], v4 offset:4096
    ds_read_b64_tr_b16 a[6:7], v4 offset:5120
    ds_read_b64_tr_b16 a[8:9], v4 offset:8192
    ds_read_b64_tr_b16 a[10:11], v4 offset:9216
    ds_read_b64_tr_b16 a[12:13], v4 offset:12288
    ds_read_b64_tr_b16 a[14:15], v4 offset:13312
    ds_read_b64_tr_b16 a[16:17], v4 offset:16384
    ds_read_b64_tr_b16 a[18:19], v4 offset:17408
    ds_read_b64_tr_b16 a[20:21], v4 offset:20480
    ds_read_b64_tr_b16 a[22:23], v4 offset:21504
    ds_read_b64_tr_b16 a[24:25], v4 offset:24576
    ds_read_b64_tr_b16 a[26:27], v4 offset:25600
    ds_read_b64_tr_b16 a[28:29], v4 offset:28672
    ds_read_b64_tr_b16 a[30:31], v4 offset:29696
    ds_read_b64_tr_b16 a[32:33], v4 offset:32768
    ds_read_b64_tr_b16 a[34:35], v4 offset:33792
    ds_read_b64_tr_b16 a[36:37], v4 offset:36864
    ds_read_b64_tr_b16 a[38:39], v4 offset:37888
    ds_read_b64_tr_b16 a[40:41], v4 offset:40960
    ds_read_b64_tr_b16 a[42:43], v4 offset:41984
    ds_read_b64_tr_b16 a[44:45], v4 offset:45056
    ds_read_b64_tr_b16 a[46:47], v4 offset:46080
    ds_read_b64_tr_b16 a[48:49], v4 offset:49152
    ds_read_b64_tr_b16 a[50:51], v4 offset:50176
    ds_read_b64_tr_b16 a[52:53], v4 offset:53248
    ds_read_b64_tr_b16 a[54:55], v4 offset:54272
    ds_read_b64_tr_b16 a[56:57], v4 offset:57344
    ds_read_b64_tr_b16 a[58:59], v4 offset:58368
    ds_read_b64_tr_b16 a[60:61], v4 offset:61440
    ds_read_b64_tr_b16 a[62:63], v4 offset:62464
    v_add_u32 v4, 65536, v4
    ds_read_b64_tr_b16 a[64:65], v4 offset:0
    ds_read_b64_tr_b16 a[66:67], v4 offset:1024
    ds_read_b64_tr_b16 a[68:69], v4 offset:4096
    ds_read_b64_tr_b16 a[70:71], v4 offset:5120
    ds_read_b64_tr_b16 a[72:73], v4 offset:8192
    ds_read_b64_tr_b16 a[74:75], v4 offset:9216
    ds_read_b64_tr_b16 a[76:77], v4 offset:12288
    ds_read_b64_tr_b16 a[78:79], v4 offset:13312
    ds_read_b64_tr_b16 a[80:81], v4 offset:16384
    ds_read_b64_tr_b16 a[82:83], v4 offset:17408
    ds_read_b64_tr_b16 a[84:85], v4 offset:20480
    ds_read_b64_tr_b16 a[86:87], v4 offset:21504
    ds_read_b64_tr_b16 a[88:89], v4 offset:24576
    ds_read_b64_tr_b16 a[90:91], v4 offset:25600
    ds_read_b64_tr_b16 a[92:93], v4 offset:28672
    ds_read_b64_tr_b16 a[94:95], v4 offset:29696
    ds_read_b64_tr_b16 a[96:97], v4 offset:32768
    ds_read_b64_tr_b16 a[98:99], v4 offset:33792
    ds_read_b64_tr_b16 a[100:101], v4 offset:36864
    ds_read_b64_tr_b16 a[102:103], v4 offset:37888
    ds_read_b64_tr_b16 a[104:105], v4 offset:40960
    ds_read_b64_tr_b16 a[106:107], v4 offset:41984
    ds_read_b64_tr_b16 a[108:109], v4 offset:45056
    ds_read_b64_tr_b16 a[110:111], v4 offset:46080
    ds_read_b64_tr_b16 a[112:113], v4 offset:49152
    ds_read_b64_tr_b16 a[114:115], v4 offset:50176
    ds_read_b64_tr_b16 a[116:117], v4 offset:53248
    ds_read_b64_tr_b16 a[118:119], v4 offset:54272
    ds_read_b64_tr_b16 a[120:121], v4 offset:57344
    ds_read_b64_tr_b16 a[122:123], v4 offset:58368
    ds_read_b64_tr_b16 a[124:125], v4 offset:61440
    ds_read_b64_tr_b16 a[126:127], v4 offset:62464
    v_add_u32 v4, 65536, v4
    ds_read_b64_tr_b16 a[128:129], v4 offset:0
    ds_read_b64_tr_b16 a[130:131], v4 offset:1024
    ds_read_b64_tr_b16 a[132:133], v4 offset:4096
    ds_read_b64_tr_b16 a[134:135], v4 offset:5120
    ds_read_b64_tr_b16 a[136:137], v4 offset:8192
    ds_read_b64_tr_b16 a[138:139], v4 offset:9216
    ds_read_b64_tr_b16 a[140:141], v4 offset:12288
    ds_read_b64_tr_b16 a[142:143], v4 offset:13312
    v_lshrrev_b32 v2, 3, v1
    s_lshl_b32 s16, s13, 3
    v_add_u32 v2, s16, v2
    v_mul_u32_u24 v4, 1152, v2
    v_bfe_u32 v2, v2, 1, 3
    v_and_b32 v3, 7, v1
    v_xor_b32 v2, v2, v3
    v_lshl_add_u32 v4, v2, 4, v4
    v_bfe_u32 v2, v1, 3, 2
    v_mul_u32_u24 v5, 9216, v2
    v_lshl_add_u32 v5, v3, 7, v5
    v_bfe_u32 v2, v1, 1, 3
    v_lshrrev_b32 v3, 5, v1
    v_xor_b32 v2, v2, v3
    v_lshl_add_u32 v5, v2, 4, v5
    v_xor_b32 v6, 32, v5
    v_xor_b32 v7, 64, v5
    v_xor_b32 v8, 96, v5
    v_lshlrev_b32 v9, 1, v1
    v_lshlrev_b32 v11, 4, v1
    v_add_u32 v19, 98304, v11
    s_lshl_b32 s16, s13, 11
    s_add_u32 s16, s16, 73728
    v_add_u32 v12, s16, v11
    v_lshrrev_b32 v2, 4, v1
    v_and_b32 v3, 15, v1
    v_lshlrev_b32 v16, 9, v2
    v_lshl_add_u32 v16, v3, 4, v16
    s_and_b32 s16, s13, 1
    s_lshl_b32 s16, s16, 8
    v_add_u32 v16, s16, v16
    v_add_u32 v13, 73728, v16
    v_lshrrev_b32 v14, 1, v2
    v_lshlrev_b32 v14, 4, v14
    v_lshl_add_u32 v14, v3, 3, v14
    v_lshl_add_u32 v14, v2, 7, v14
    s_mul_i32 s16, s13, 2176
    s_add_u32 s16, s16, 81920
    v_add_u32 v14, s16, v14
    v_bfe_u32 v15, v1, 2, 1
    v_mul_u32_u24 v15, 272, v15
    v_bfe_u32 v10, v1, 3, 1
    v_lshl_add_u32 v10, v2, 2, v10
    v_lshl_add_u32 v15, v10, 3, v15
    v_and_b32 v10, 1, v1
    v_lshl_add_u32 v15, v10, 7, v15
    v_add_u32 v15, s16, v15
    s_and_b32 s16, s13, 1
    s_lshl_b32 s16, s16, 4
    v_add_u32 v3, s16, v3
    v_lshrrev_b32 v10, 1, v2
    v_lshlrev_b32 v10, 4, v10
    v_and_b32 v2, 1, v2
    v_lshl_add_u32 v10, v2, 2, v10
    v_sub_u32 v10, v3, v10
    v_cmp_le_i32 s[50:51], 0, v10
    v_cmp_le_i32 s[52:53], 1, v10
    v_cmp_le_i32 s[54:55], 2, v10
    v_cmp_le_i32 s[56:57], 3, v10
    v_cmp_le_i32 s[58:59], 8, v10
    v_cmp_le_i32 s[60:61], 9, v10
    v_cmp_le_i32 s[62:63], 10, v10
    v_cmp_le_i32 s[64:65], 11, v10
    v_cmp_gt_u32 vcc, 32, v1
    s_lshl_b32 s25, s12, 7
    v_mov_b32 v17, 0
    v_mov_b32 v10, 4096
    v_cndmask_b32 v17, v17, v10, vcc
    v_add_u32 v17, s25, v17
    s_add_u32 s38, s25, 4096
    s_lshl_b32 s25, s25, 2
    s_lshl_b32 s16, s13, 7
    s_add_u32 s25, s25, s16
    s_add_u32 s25, s25, 66560
    v_mov_b32 v180, 0xff800000
    s_mov_b32 s30, -1
    s_mov_b32 s31, 0
    s_mov_b32 s28, 0x3e0293ee
    s_mov_b32 s29, 0
    s_mov_b32 s20, 0
    s_mov_b32 s21, 2097152
    s_mov_b32 s22, 0
    s_mov_b32 s33, 0
    s_mov_b32 s32, 0
    s_lshl_b32 s23, s12, 14
    s_lshl_b32 s16, s13, 12
    s_add_u32 s23, s23, s16
    s_add_u32 s23, s23, 33554432
    s_lshl_b32 s26, s12, 12
    s_add_u32 s26, s26, 16777216
    s_lshr_b32 s16, s13, 1
    s_lshl_b32 s17, s16, 11
    s_xor_b32 s34, s17, 2048
    s_add_u32 s34, s34, s26
    s_add_u32 s26, s26, s17
    s_lshl_b32 s27, s12, 13
    s_lshl_b32 s17, s16, 12
    s_add_u32 s27, s27, s17
    s_add_u32 s27, s27, 67108864
    v_add_u32 v13, s17, v13
    v_add_u32 v19, s17, v19
    s_mov_b32 s14, 0
    s_mov_b32 s24, 1
    s_waitcnt lgkmcnt(0)
    v_mov_b32 v156, 0x3f803f80
    v_mov_b32 v157, 0x3f803f80
    v_mov_b32 v158, 0x3f803f80
    v_mov_b32 v159, 0x3f803f80
    v_mbcnt_lo_u32_b32 v2, -1, 0
    v_mbcnt_hi_u32_b32 v2, -1, v2
    v_and_b32 v2, 31, v2
    v_lshlrev_b32 v2, 2, v2
    s_mov_b32 s45, 131072
L_ver_40:
    buffer_load_dword v3, v2, s[84:87], 0 offen sc1
    s_sub_u32 s45, s45, 1
    s_cbranch_scc1 ABORT
    s_waitcnt vmcnt(0)
L_verchk_42:
    v_readlane_b32 s66, v3, 0
    v_readlane_b32 s67, v3, 4
    v_readlane_b32 s68, v3, 8
    v_readlane_b32 s69, v3, 12
    v_readlane_b32 s70, v3, 16
    v_readlane_b32 s71, v3, 20
    v_readlane_b32 s72, v3, 24
    v_readlane_b32 s73, v3, 28
    v_readlane_b32 s74, v3, 1
    s_add_u32 s75, s66, s67
    s_add_u32 s75, s75, s68
    s_add_u32 s75, s75, s69
    s_add_u32 s75, s75, s70
    s_add_u32 s75, s75, s71
    s_add_u32 s75, s75, s72
    s_add_u32 s75, s75, s73
    s_add_u32 s75, s75, s74
    s_cmp_ge_u32 s75, 267
    s_cbranch_scc1 L_ver_40_d
    s_sleep 16
    s_branch L_ver_40
L_ver_40_d:
    s_cmp_eq_u32 s93, 1
    s_cbranch_scc1 L_verok_41
    s_or_b32 s75, s66, s67
    s_or_b32 s75, s75, s68
    s_or_b32 s75, s75, s69
    s_or_b32 s75, s75, s70
    s_or_b32 s75, s75, s71
    s_or_b32 s75, s75, s72
    s_or_b32 s75, s75, s73
    s_cmp_lg_u32 s75, 32
    s_cbranch_scc1 REROLE
L_verok_41:
    v_mov_b32 v184, -1
    v_mov_b32 v185, -1
    v_mov_b32 v186, -1
    v_mov_b32 v187, -1
    s_lshl_b32 s16, s12, 12
    s_lshl_b32 s17, s13, 10
    s_add_u32 s16, s16, s17
    s_add_u32 s16, s16, 16777216
    s_mov_b32 s17, 0
L_qap_43:
    buffer_store_dwordx4 v[184:187], v11, s[4:7], s16 offen sc1
    s_add_u32 s16, s16, 131072
    s_add_u32 s17, s17, 1
    s_waitcnt vmcnt(40)
    s_cmp_lt_u32 s17, 64
    s_cbranch_scc1 L_qap_43
    s_waitcnt vmcnt(0)
    s_barrier
    s_cmp_lg_u32 s13, 0
    s_cbranch_scc1 L_qapn_44
    s_mov_b32 s16, s38
    v_mov_b32 v10, 1
    s_mov_b64 exec, 1
    buffer_store_dword v10, off, s[4:7], s16 sc1
    s_mov_b64 exec, -1
L_qapn_44:
    s_mov_b32 s24, 64
    s_mov_b32 s21, 4087808
    s_mul_i32 s37, s12, 131072
    s_lshl_b32 s16, s13, 11
    s_add_u32 s37, s37, s16
    s_add_u32 s37, s37, 10485760
    s_mov_b32 s14, 54
    s_cmp_ge_u32 s20, s24
    s_cbranch_scc1 L_xok_46
    s_mov_b32 s45, 131072
L_xw_45:
    buffer_load_ushort v10, v9, s[84:87], 0 offen offset:128 sc1
    s_sub_u32 s45, s45, 1
    s_cbranch_scc1 ABORT
    s_waitcnt vmcnt(0)
    v_cmp_eq_u32 vcc, 0x101, v10
    s_nop 0
    s_ff0_i32_b64 s20, vcc
    s_cmp_ge_u32 s20, s24
    s_cbranch_scc1 L_xok_46
    s_sleep 8
    s_branch L_xw_45
L_xok_46:
    s_mul_i32 s16, s13, 9216
    s_add_u32 m0, s16, s22
    s_nop 0
    buffer_load_dwordx4 v4, s[4:7], s21 offen offset:0 sc1 lds
    s_add_u32 m0, m0, 896
    s_nop 0
    buffer_load_dwordx4 v4, s[4:7], s21 offen offset:128 sc1 lds
    s_add_u32 m0, m0, 896
    s_nop 0
    buffer_load_dwordx4 v4, s[4:7], s21 offen offset:256 sc1 lds
    s_add_u32 m0, m0, 896
    s_nop 0
    buffer_load_dwordx4 v4, s[4:7], s21 offen offset:384 sc1 lds
    s_add_u32 m0, m0, 896
    s_nop 0
    buffer_load_dwordx4 v4, s[4:7], s21 offen offset:512 sc1 lds
    s_add_u32 m0, m0, 896
    s_nop 0
    buffer_load_dwordx4 v4, s[4:7], s21 offen offset:640 sc1 lds
    s_add_u32 m0, m0, 896
    s_nop 0
    buffer_load_dwordx4 v4, s[4:7], s21 offen offset:768 sc1 lds
    s_add_u32 m0, m0, 896
    s_nop 0
    buffer_load_dwordx4 v4, s[4:7], s21 offen offset:896 sc1 lds
    s_add_u32 m0, m0, 896
    s_nop 0
    buffer_load_dwordx4 v4, s[4:7], s21 offen offset:1024 sc1 lds
    s_waitcnt vmcnt(0)
    s_barrier
L_qap1_47:
    ds_read_b128 v[20:23], v5 offset:0
    ds_read_b128 v[24:27], v6 offset:0
    ds_read_b128 v[28:31], v7 offset:0
    s_xor_b32 s22, s22, 36864
    s_add_u32 s21, s21, 36864
    s_cmp_eq_u32 s14, 63
    s_cselect_b32 s21, 2097152, s21
    s_mul_i32 s16, s13, 9216
    s_add_u32 m0, s16, s22
    ds_read_b128 v[32:35], v8 offset:0
    s_waitcnt lgkmcnt(3)
    v_mfma_f32_32x32x16_bf16 v[36:51], a[0:3], v[20:23], 0
    buffer_load_dwordx4 v4, s[4:7], s21 offen offset:0 sc1 lds
    s_add_u32 m0, m0, 896
    ds_read_b128 v[20:23], v5 offset:1024
    s_waitcnt lgkmcnt(3)
    v_mfma_f32_32x32x16_bf16 v[36:51], a[4:7], v[24:27], v[36:51]
    ds_read_b128 v[24:27], v6 offset:1024
    s_waitcnt lgkmcnt(3)
    v_mfma_f32_32x32x16_bf16 v[36:51], a[8:11], v[28:31], v[36:51]
    buffer_load_dwordx4 v4, s[4:7], s21 offen offset:128 sc1 lds
    s_add_u32 m0, m0, 896
    ds_read_b128 v[28:31], v7 offset:1024
    s_waitcnt lgkmcnt(3)
    v_mfma_f32_32x32x16_bf16 v[36:51], a[12:15], v[32:35], v[36:51]
    ds_read_b128 v[32:35], v8 offset:1024
    s_waitcnt lgkmcnt(3)
    v_mfma_f32_32x32x16_bf16 v[36:51], a[16:19], v[20:23], v[36:51]
    buffer_load_dwordx4 v4, s[4:7], s21 offen offset:256 sc1 lds
    s_add_u32 m0, m0, 896
    ds_read_b128 v[20:23], v5 offset:2048
    s_waitcnt lgkmcnt(3)
    v_mfma_f32_32x32x16_bf16 v[36:51], a[20:23], v[24:27], v[36:51]
    ds_read_b128 v[24:27], v6 offset:2048
    s_waitcnt lgkmcnt(3)
    v_mfma_f32_32x32x16_bf16 v[36:51], a[24:27], v[28:31], v[36:51]
    buffer_load_dwordx4 v4, s[4:7], s21 offen offset:384 sc1 lds
    s_add_u32 m0, m0, 896
    ds_read_b128 v[28:31], v7 offset:2048
    s_waitcnt lgkmcnt(3)
    v_mfma_f32_32x32x16_bf16 v[36:51], a[28:31], v[32:35], v[36:51]
    ds_read_b128 v[32:35], v8 offset:2048
    s_waitcnt lgkmcnt(3)
    v_mfma_f32_32x32x16_bf16 v[36:51], a[32:35], v[20:23], v[36:51]
    buffer_load_dwordx4 v4, s[4:7], s21 offen offset:512 sc1 lds
    s_add_u32 m0, m0, 896
    ds_read_b128 v[20:23], v5 offset:3072
    s_waitcnt lgkmcnt(3)
    v_mfma_f32_32x32x16_bf16 v[36:51], a[36:39], v[24:27], v[36:51]
    ds_read_b128 v[24:27], v6 offset:3072
    s_waitcnt lgkmcnt(3)
    v_mfma_f32_32x32x16_bf16 v[36:51], a[40:43], v[28:31], v[36:51]
    buffer_load_dwordx4 v4, s[4:7], s21 offen offset:640 sc1 lds
    s_add_u32 m0, m0, 896
    ds_read_b128 v[28:31], v7 offset:3072
    s_waitcnt lgkmcnt(3)
    v_mfma_f32_32x32x16_bf16 v[36:51], a[44:47], v[32:35], v[36:51]
    ds_read_b128 v[32:35], v8 offset:3072
    s_waitcnt lgkmcnt(3)
    v_mfma_f32_32x32x16_bf16 v[36:51], a[48:51], v[20:23], v[36:51]
    buffer_load_dwordx4 v4, s[4:7], s21 offen offset:768 sc1 lds
    s_add_u32 m0, m0, 896
    ds_read_b128 v[20:23], v5 offset:4096
    s_waitcnt lgkmcnt(3)
    v_mfma_f32_32x32x16_bf16 v[36:51], a[52:55], v[24:27], v[36:51]
    ds_read_b128 v[24:27], v6 offset:4096
    s_waitcnt lgkmcnt(3)
    v_mfma_f32_32x32x16_bf16 v[36:51], a[56:59], v[28:31], v[36:51]
    buffer_load_dwordx4 v4, s[4:7], s21 offen offset:896 sc1 lds
    s_add_u32 m0, m0, 896
    ds_read_b128 v[28:31], v7 offset:4096
    s_waitcnt lgkmcnt(3)
    v_mfma_f32_32x32x16_bf16 v[36:51], a[60:63], v[32:35], v[36:51]
    ds_read_b128 v[32:35], v8 offset:4096
    s_waitcnt lgkmcnt(3)
    v_mfma_f32_32x32x16_bf16 v[36:51], a[64:67], v[20:23], v[36:51]
    buffer_load_dwordx4 v4, s[4:7], s21 offen offset:1024 sc1 lds
    s_add_u32 m0, m0, 896
    ds_read_b128 v[20:23], v5 offset:5120
    s_waitcnt lgkmcnt(3)
    v_mfma_f32_32x32x16_bf16 v[36:51], a[68:71], v[24:27], v[36:51]
    ds_read_b128 v[24:27], v6 offset:5120
    s_waitcnt lgkmcnt(3)
    v_mfma_f32_32x32x16_bf16 v[36:51], a[72:75], v[28:31], v[36:51]
    ds_read_b128 v[28:31], v7 offset:5120
    s_waitcnt lgkmcnt(3)
    v_mfma_f32_32x32x16_bf16 v[36:51], a[76:79], v[32:35], v[36:51]
    ds_read_b128 v[32:35], v8 offset:5120
    s_waitcnt lgkmcnt(3)
    v_mfma_f32_32x32x16_bf16 v[36:51], a[80:83], v[20:23], v[36:51]
    ds_read_b128 v[20:23], v5 offset:6144
    s_waitcnt lgkmcnt(3)
    v_mfma_f32_32x32x16_bf16 v[36:51], a[84:87], v[24:27], v[36:51]
    ds_read_b128 v[24:27], v6 offset:6144
    s_waitcnt lgkmcnt(3)
    v_mfma_f32_32x32x16_bf16 v[36:51], a[88:91], v[28:31], v[36:51]
    ds_read_b128 v[28:31], v7 offset:6144
    s_waitcnt lgkmcnt(3)
    v_mfma_f32_32x32x16_bf16 v[36:51], a[92:95], v[32:35], v[36:51]
    ds_read_b128 v[32:35], v8 offset:6144
    s_waitcnt lgkmcnt(3)
    v_mfma_f32_32x32x16_bf16 v[36:51], a[96:99], v[20:23], v[36:51]
    ds_read_b128 v[20:23], v5 offset:7168
    s_waitcnt lgkmcnt(3)
    v_mfma_f32_32x32x16_bf16 v[36:51], a[100:103], v[24:27], v[36:51]
    ds_read_b128 v[24:27], v6 offset:7168
    s_waitcnt lgkmcnt(3)
    v_mfma_f32_32x32x16_bf16 v[36:51], a[104:107], v[28:31], v[36:51]
    ds_read_b128 v[28:31], v7 offset:7168
    s_waitcnt lgkmcnt(3)
    v_mfma_f32_32x32x16_bf16 v[36:51], a[108:111], v[32:35], v[36:51]
    ds_read_b128 v[32:35], v8 offset:7168
    s_waitcnt lgkmcnt(3)
    v_mfma_f32_32x32x16_bf16 v[36:51], a[112:115], v[20:23], v[36:51]
    ds_read_b128 v[20:23], v5 offset:8192
    s_waitcnt lgkmcnt(3)
    v_mfma_f32_32x32x16_bf16 v[36:51], a[116:119], v[24:27], v[36:51]
    ds_read_b128 v[24:27], v6 offset:8192
    s_waitcnt lgkmcnt(3)
    v_mfma_f32_32x32x16_bf16 v[36:51], a[120:123], v[28:31], v[36:51]
    ds_read_b128 v[28:31], v7 offset:8192
    s_waitcnt lgkmcnt(3)
    v_mfma_f32_32x32x16_bf16 v[36:51], a[124:127], v[32:35], v[36:51]
    ds_read_b128 v[32:35], v8 offset:8192
    s_waitcnt lgkmcnt(3)
    v_mfma_f32_32x32x16_bf16 v[36:51], a[128:131], v[20:23], v[36:51]
    s_waitcnt lgkmcnt(2)
    v_mfma_f32_32x32x16_bf16 v[36:51], a[132:135], v[24:27], v[36:51]
    s_waitcnt lgkmcnt(1)
    v_mfma_f32_32x32x16_bf16 v[36:51], a[136:139], v[28:31], v[36:51]
    s_waitcnt lgkmcnt(0)
    v_mfma_f32_32x32x16_bf16 v[36:51], a[140:143], v[32:35], v[36:51]
    s_lshl_b32 s16, s22, 1
    s_sub_u32 s16, s16, 36864
    v_add_u32 v5, s16, v5
    v_add_u32 v6, s16, v6
    v_add_u32 v7, s16, v7
    v_add_u32 v8, s16, v8
    s_nop 1
    v_mov_b32 v2, v2
    s_nop 1
    v_mov_b32 v2, v2
    v_cvt_pk_bf16_f32 v36, v36, v37
    v_cvt_pk_bf16_f32 v37, v38, v39
    v_cvt_pk_bf16_f32 v38, v40, v41
    v_cvt_pk_bf16_f32 v39, v42, v43
    v_cvt_pk_bf16_f32 v40, v44, v45
    v_cvt_pk_bf16_f32 v41, v46, v47
    v_cvt_pk_bf16_f32 v42, v48, v49
    v_cvt_pk_bf16_f32 v43, v50, v51
    buffer_store_dwordx4 v[36:39], v11, s[4:7], s37 offen
    buffer_store_dwordx4 v[40:43], v11, s[4:7], s37 offen offset:1024
    s_add_u32 s37, s37, 8192
    s_add_u32 s14, s14, 1
    s_waitcnt vmcnt(2)
    s_barrier
    s_cmp_lt_u32 s14, 64
    s_cbranch_scc1 L_qap1_47
    s_sub_u32 s37, s37, 81920
    s_mov_b32 s14, 0
    s_mov_b32 s24, 1
    s_cmp_ge_u32 s32, s24
    s_cbranch_scc1 L_qakvok_49
    s_mov_b32 s45, 131072
L_qakv_48:
    s_sleep 2
    buffer_load_dword v10, v17, s[4:7], 0 offen sc1
    s_sub_u32 s45, s45, 1
    s_cbranch_scc1 ABORT
    s_waitcnt vmcnt(0)
    v_readlane_b32 s32, v10, 63
    s_nop 0
    s_cmp_ge_u32 s32, s24
    s_cbranch_scc0 L_qakv_48
L_qakvok_49:
    s_lshl_b32 s16, s13, 12
    s_add_u32 m0, s16, 98304
    s_nop 0
    buffer_load_dwordx4 v11, s[4:7], s23 offen offset:0 sc1 lds
    buffer_load_dwordx4 v11, s[4:7], s23 offen offset:1024 sc1 lds
    buffer_load_dwordx4 v11, s[4:7], s23 offen offset:2048 sc1 lds
    buffer_load_dwordx4 v11, s[4:7], s23 offen offset:3072 sc1 lds
    s_waitcnt vmcnt(0)
    s_barrier
L_qaloop_50:
    ds_read_b128 v[20:23], v5 offset:0
    ds_read_b128 v[24:27], v6 offset:0
    ds_read_b128 v[28:31], v7 offset:0
    s_add_u32 s24, s14, 2
    s_min_u32 s24, s24, 64
    s_xor_b32 s33, s33, 16384
    s_cmp_eq_u32 s14, 63
    s_cselect_b32 s17, 0, 524288
    s_add_u32 s23, s23, s17
    s_and_b32 s36, s26, 0xfffff000
    s_cmp_ge_u32 s32, s24
    s_cbranch_scc1 L_qakvok_52
    s_mov_b32 s45, 131072
L_qakv_51:
    s_sleep 2
    buffer_load_dword v10, v17, s[4:7], 0 offen sc1
    s_sub_u32 s45, s45, 1
    s_cbranch_scc1 ABORT
    s_waitcnt vmcnt(0)
    v_readlane_b32 s32, v10, 63
    s_nop 0
    s_cmp_ge_u32 s32, s24
    s_cbranch_scc0 L_qakv_51
L_qakvok_52:
    s_lshl_b32 s16, s13, 12
    s_add_u32 s16, s16, s33
    s_add_u32 m0, s16, 98304
    s_xor_b32 s22, s22, 36864
    s_add_u32 s21, s21, 36864
    s_mul_i32 s18, s13, 9216
    s_add_u32 s18, s18, s22
    ds_read_b128 v[32:35], v8 offset:0
    s_waitcnt lgkmcnt(3)
    v_mfma_f32_32x32x16_bf16 v[36:51], a[0:3], v[20:23], 0
    buffer_load_dword v181, off, s[4:7], s36 offset:4080 sc1
    ds_read_b128 v[20:23], v5 offset:1024
    s_waitcnt lgkmcnt(3)
    v_mfma_f32_32x32x16_bf16 v[36:51], a[4:7], v[24:27], v[36:51]
    ds_read_b128 v[24:27], v6 offset:1024
    s_waitcnt lgkmcnt(3)
    v_mfma_f32_32x32x16_bf16 v[36:51], a[8:11], v[28:31], v[36:51]
    buffer_load_dwordx4 v11, s[4:7], s23 offen offset:0 sc1 lds
    ds_read_b128 v[28:31], v7 offset:1024
    s_waitcnt lgkmcnt(3)
    v_mfma_f32_32x32x16_bf16 v[36:51], a[12:15], v[32:35], v[36:51]
    ds_read_b128 v[32:35], v8 offset:1024
    s_waitcnt lgkmcnt(3)
    v_mfma_f32_32x32x16_bf16 v[36:51], a[16:19], v[20:23], v[36:51]
    buffer_load_dwordx4 v11, s[4:7], s23 offen offset:1024 sc1 lds
    ds_read_b128 v[20:23], v5 offset:2048
    s_waitcnt lgkmcnt(3)
    v_mfma_f32_32x32x16_bf16 v[36:51], a[20:23], v[24:27], v[36:51]
    ds_read_b128 v[24:27], v6 offset:2048
    s_waitcnt lgkmcnt(3)
    v_mfma_f32_32x32x16_bf16 v[36:51], a[24:27], v[28:31], v[36:51]
    buffer_load_dwordx4 v11, s[4:7], s23 offen offset:2048 sc1 lds
    ds_read_b128 v[28:31], v7 offset:2048
    s_waitcnt lgkmcnt(3)
    v_mfma_f32_32x32x16_bf16 v[36:51], a[28:31], v[32:35], v[36:51]
    ds_read_b128 v[32:35], v8 offset:2048
    s_waitcnt lgkmcnt(3)
    v_mfma_f32_32x32x16_bf16 v[36:51], a[32:35], v[20:23], v[36:51]
    buffer_load_dwordx4 v11, s[4:7], s23 offen offset:3072 sc1 lds
    s_mov_b32 m0, s18
    ds_read_b128 v[20:23], v5 offset:3072
    s_waitcnt lgkmcnt(3)
    v_mfma_f32_32x32x16_bf16 v[36:51], a[36:39], v[24:27], v[36:51]
    ds_read_b128 v[24:27], v6 offset:3072
    s_waitcnt lgkmcnt(3)
    v_mfma_f32_32x32x16_bf16 v[36:51], a[40:43], v[28:31], v[36:51]
    buffer_load_dwordx4 v4, s[4:7], s21 offen offset:0 sc1 lds
    s_add_u32 m0, m0, 896
    ds_read_b128 v[28:31], v7 offset:3072
    s_waitcnt lgkmcnt(3)
    v_mfma_f32_32x32x16_bf16 v[36:51], a[44:47], v[32:35], v[36:51]
    ds_read_b128 v[32:35], v8 offset:3072
    s_waitcnt lgkmcnt(3)
    v_mfma_f32_32x32x16_bf16 v[36:51], a[48:51], v[20:23], v[36:51]
    buffer_load_dwordx4 v4, s[4:7], s21 offen offset:128 sc1 lds
    s_add_u32 m0, m0, 896
    ds_read_b128 v[20:23], v5 offset:4096
    s_waitcnt lgkmcnt(3)
    v_mfma_f32_32x32x16_bf16 v[36:51], a[52:55], v[24:27], v[36:51]
    ds_read_b128 v[24:27], v6 offset:4096
    s_waitcnt lgkmcnt(3)
    v_mfma_f32_32x32x16_bf16 v[36:51], a[56:59], v[28:31], v[36:51]
    buffer_load_dwordx4 v4, s[4:7], s21 offen offset:256 sc1 lds
    s_add_u32 m0, m0, 896
    ds_read_b128 v[28:31], v7 offset:4096
    s_waitcnt lgkmcnt(3)
    v_mfma_f32_32x32x16_bf16 v[36:51], a[60:63], v[32:35], v[36:51]
    ds_read_b128 v[32:35], v8 offset:4096
    s_waitcnt lgkmcnt(3)
    v_mfma_f32_32x32x16_bf16 v[36:51], a[64:67], v[20:23], v[36:51]
    buffer_load_dwordx4 v4, s[4:7], s21 offen offset:384 sc1 lds
    s_add_u32 m0, m0, 896
    ds_read_b128 v[20:23], v5 offset:5120
    s_waitcnt lgkmcnt(3)
    v_mfma_f32_32x32x16_bf16 v[36:51], a[68:71], v[24:27], v[36:51]
    ds_read_b128 v[24:27], v6 offset:5120
    s_waitcnt lgkmcnt(3)
    v_mfma_f32_32x32x16_bf16 v[36:51], a[72:75], v[28:31], v[36:51]
    buffer_load_dwordx4 v4, s[4:7], s21 offen offset:512 sc1 lds
    s_add_u32 m0, m0, 896
    ds_read_b128 v[28:31], v7 offset:5120
    s_waitcnt lgkmcnt(3)
    v_mfma_f32_32x32x16_bf16 v[36:51], a[76:79], v[32:35], v[36:51]
    ds_read_b128 v[32:35], v8 offset:5120
    s_waitcnt lgkmcnt(3)
    v_mfma_f32_32x32x16_bf16 v[36:51], a[80:83], v[20:23], v[36:51]
    buffer_load_dwordx4 v4, s[4:7], s21 offen offset:640 sc1 lds
    s_add_u32 m0, m0, 896
    ds_read_b128 v[20:23], v5 offset:6144
    s_waitcnt lgkmcnt(3)
    v_mfma_f32_32x32x16_bf16 v[36:51], a[84:87], v[24:27], v[36:51]
    ds_read_b128 v[24:27], v6 offset:6144
    s_waitcnt lgkmcnt(3)
    v_mfma_f32_32x32x16_bf16 v[36:51], a[88:91], v[28:31], v[36:51]
    buffer_load_dwordx4 v4, s[4:7], s21 offen offset:768 sc1 lds
    s_add_u32 m0, m0, 896
    ds_read_b128 v[28:31], v7 offset:6144
    s_waitcnt lgkmcnt(3)
    v_mfma_f32_32x32x16_bf16 v[36:51], a[92:95], v[32:35], v[36:51]
    ds_read_b128 v[32:35], v8 offset:6144
    s_waitcnt lgkmcnt(3)
    v_mfma_f32_32x32x16_bf16 v[36:51], a[96:99], v[20:23], v[36:51]
    buffer_load_dwordx4 v4, s[4:7], s21 offen offset:896 sc1 lds
    s_add_u32 m0, m0, 896
    ds_read_b128 v[20:23], v5 offset:7168
    s_waitcnt lgkmcnt(3)
    v_mfma_f32_32x32x16_bf16 v[36:51], a[100:103], v[24:27], v[36:51]
    ds_read_b128 v[24:27], v6 offset:7168
    s_waitcnt lgkmcnt(3)
    v_mfma_f32_32x32x16_bf16 v[36:51], a[104:107], v[28:31], v[36:51]
    buffer_load_dwordx4 v4, s[4:7], s21 offen offset:1024 sc1 lds
    s_add_u32 m0, m0, 896
    ds_read_b128 v[28:31], v7 offset:7168
    s_waitcnt lgkmcnt(3)
    v_mfma_f32_32x32x16_bf16 v[36:51], a[108:111], v[32:35], v[36:51]
    ds_read_b128 v[32:35], v8 offset:7168
    s_waitcnt lgkmcnt(3)
    v_mfma_f32_32x32x16_bf16 v[36:51], a[112:115], v[20:23], v[36:51]
    buffer_load_dword v18, v17, s[4:7], 0 offen sc1
    ds_read_b128 v[20:23], v5 offset:8192
    s_waitcnt lgkmcnt(3)
    v_mfma_f32_32x32x16_bf16 v[36:51], a[116:119], v[24:27], v[36:51]
    s_waitcnt vmcnt(14)
    v_mov_b32 v10, s14
    s_mov_b64 exec, 1
    buffer_store_dword v10, off, s[4:7], s25 offset:0 sc1
    s_mov_b64 exec, -1
    ds_read_b128 v[24:27], v6 offset:8192
    s_waitcnt lgkmcnt(3)
    v_mfma_f32_32x32x16_bf16 v[36:51], a[120:123], v[28:31], v[36:51]
    ds_read_b128 v[28:31], v7 offset:8192
    s_waitcnt lgkmcnt(3)
    v_mfma_f32_32x32x16_bf16 v[36:51], a[124:127], v[32:35], v[36:51]
    ds_read_b128 v[32:35], v8 offset:8192
    s_waitcnt lgkmcnt(3)
    v_mfma_f32_32x32x16_bf16 v[36:51], a[128:131], v[20:23], v[36:51]
    s_waitcnt lgkmcnt(2)
    v_mfma_f32_32x32x16_bf16 v[36:51], a[132:135], v[24:27], v[36:51]
    s_waitcnt lgkmcnt(1)
    v_mfma_f32_32x32x16_bf16 v[36:51], a[136:139], v[28:31], v[36:51]
    s_waitcnt lgkmcnt(0)
    v_mfma_f32_32x32x16_bf16 v[36:51], a[140:143], v[32:35], v[36:51]
    v_readfirstlane_b32 s35, v181
    s_nop 0
    s_cmp_eq_u32 s35, -1
    s_cbranch_scc1 L_qnq_53
    buffer_load_dwordx4 v[184:187], v11, s[4:7], s26 offen offset:0 sc1
    buffer_load_dwordx4 v[188:191], v11, s[4:7], s26 offen offset:1024 sc1
    buffer_load_dwordx4 v[192:195], v11, s[4:7], s34 offen offset:0 sc1
    buffer_load_dwordx4 v[196:199], v11, s[4:7], s34 offen offset:1024 sc1
L_qnq_53:
    v_mov_b32 v2, v2
    s_nop 2
    s_lshl_b32 s16, s22, 1
    s_sub_u32 s16, s16, 36864
    v_add_u32 v5, s16, v5
    v_add_u32 v6, s16, v6
    v_add_u32 v7, s16, v7
    v_add_u32 v8, s16, v8
    v_cvt_pk_bf16_f32 v36, v36, v37
    v_cvt_pk_bf16_f32 v37, v38, v39
    v_cvt_pk_bf16_f32 v38, v40, v41
    v_cvt_pk_bf16_f32 v39, v42, v43
    v_cvt_pk_bf16_f32 v40, v44, v45
    v_cvt_pk_bf16_f32 v41, v46, v47
    v_cvt_pk_bf16_f32 v42, v48, v49
    v_cvt_pk_bf16_f32 v43, v50, v51
    ds_write_b128 v12, v[36:39]
    ds_write_b128 v12, v[40:43] offset:1024
    s_waitcnt lgkmcnt(0)
    s_barrier
    v_xor_b32 v2, 4096, v13
    v_xor_b32 v3, 4096, v19
    ds_read_b128 v[108:111], v13 offset:0
    ds_read_b128 v[52:55], v19 offset:0
    ds_read_b128 v[56:59], v19 offset:1024
    ds_read_b128 v[112:115], v13 offset:2048
    ds_read_b128 v[60:63], v19 offset:2048
    ds_read_b128 v[64:67], v19 offset:3072
    ds_read_b128 v[116:119], v2 offset:0
    ds_read_b128 v[68:71], v3 offset:0
    ds_read_b128 v[72:75], v3 offset:1024
    ds_read_b128 v[120:123], v2 offset:2048
    ds_read_b128 v[76:79], v3 offset:2048
    ds_read_b128 v[80:83], v3 offset:3072
    s_waitcnt lgkmcnt(9)
    v_mfma_f32_16x16x32_bf16 v[144:147], v[52:55], v[108:111], 0
    v_mfma_f32_16x16x32_bf16 v[148:151], v[56:59], v[108:111], 0
    ds_read_b128 v[84:87], v19 offset:8192
    s_waitcnt lgkmcnt(7)
    v_mfma_f32_16x16x32_bf16 v[144:147], v[60:63], v[112:115], v[144:147]
    v_mfma_f32_16x16x32_bf16 v[148:151], v[64:67], v[112:115], v[148:151]
    ds_read_b128 v[88:91], v19 offset:9216
    s_waitcnt lgkmcnt(5)
    v_mfma_f32_16x16x32_bf16 v[144:147], v[68:71], v[116:119], v[144:147]
    v_mfma_f32_16x16x32_bf16 v[148:151], v[72:75], v[116:119], v[148:151]
    ds_read_b128 v[92:95], v19 offset:10240
    s_waitcnt lgkmcnt(3)
    v_mfma_f32_16x16x32_bf16 v[144:147], v[76:79], v[120:123], v[144:147]
    v_mfma_f32_16x16x32_bf16 v[148:151], v[80:83], v[120:123], v[148:151]
    ds_read_b128 v[96:99], v19 offset:11264
    v_xor_b32 v19, 16384, v19
    s_nop 1
    v_mov_b32 v2, v2
    s_nop 0
    v_mov_b32 v2, v2
    v_cndmask_b32 v144, v180, v144, s[50:51]
    v_cndmask_b32 v145, v180, v145, s[52:53]
    v_cndmask_b32 v146, v180, v146, s[54:55]
    v_cndmask_b32 v147, v180, v147, s[56:57]
    v_cndmask_b32 v148, v180, v148, s[58:59]
    v_cndmask_b32 v149, v180, v149, s[60:61]
    v_cndmask_b32 v150, v180, v150, s[62:63]
    v_cndmask_b32 v151, v180, v151, s[64:65]
    v_max3_f32 v152, v144, v145, v146
    v_max3_f32 v153, v147, v148, v149
    v_max3_f32 v152, v152, v150, v151
    s_mov_b32 s45, 131072
    s_cmp_lg_u32 s35, -1
    s_cbranch_scc1 L_qkc_55
L_qcl_56:
    buffer_load_dword v181, off, s[4:7], s36 offset:4080 sc1
    s_sub_u32 s45, s45, 1
    s_cbranch_scc1 ABORT
    s_waitcnt vmcnt(0)
    v_cmp_eq_u32 vcc, -1, v181
    s_cbranch_vccnz L_qcl_56
L_qkl_54:
    buffer_load_dwordx4 v[184:187], v11, s[4:7], s26 offen offset:0 sc1
    buffer_load_dwordx4 v[188:191], v11, s[4:7], s26 offen offset:1024 sc1
    buffer_load_dwordx4 v[192:195], v11, s[4:7], s34 offen offset:0 sc1
    buffer_load_dwordx4 v[196:199], v11, s[4:7], s34 offen offset:1024 sc1
    s_sub_u32 s45, s45, 1
    s_cbranch_scc1 ABORT
L_qkc_55:
    s_waitcnt vmcnt(3)
    ds_write_b64 v14, v[186:187] offset:0
    v_max_u32 v10, v184, v185
    s_waitcnt vmcnt(2)
    ds_write_b64 v14, v[190:191] offset:544
    v_max3_u32 v10, v10, v188, v189
    s_waitcnt vmcnt(1)
    ds_write_b64 v14, v[194:195] offset:1088
    v_max3_u32 v10, v10, v192, v193
    s_waitcnt vmcnt(0)
    ds_write_b64 v14, v[198:199] offset:1632
    v_max3_u32 v10, v10, v196, v197
    v_cmp_eq_u32 vcc, -1, v10
    s_cbranch_vccnz L_qkl_54
    v_readlane_b32 s32, v18, 63
    ds_read_b64_tr_b16 v[124:125], v15 offset:0
    ds_read_b64_tr_b16 v[126:127], v15 offset:16
    ds_read_b64_tr_b16 v[128:129], v15 offset:544
    ds_read_b64_tr_b16 v[130:131], v15 offset:560
    ds_read_b64_tr_b16 v[132:133], v15 offset:1088
    ds_read_b64_tr_b16 v[134:135], v15 offset:1104
    ds_read_b64_tr_b16 v[136:137], v15 offset:1632
    ds_read_b64_tr_b16 v[138:139], v15 offset:1648
    s_waitcnt lgkmcnt(6)
    v_mfma_f32_16x16x32_bf16 v[140:143], v[124:127], v[108:111], 0
    s_waitcnt lgkmcnt(4)
    v_mfma_f32_16x16x32_bf16 v[140:143], v[128:131], v[112:115], v[140:143]
    s_waitcnt lgkmcnt(2)
    v_mfma_f32_16x16x32_bf16 v[140:143], v[132:135], v[116:119], v[140:143]
    s_waitcnt lgkmcnt(0)
    v_mfma_f32_16x16x32_bf16 v[140:143], v[136:139], v[120:123], v[140:143]
    s_nop 1
    v_mov_b32 v2, v2
    s_nop 1
    v_mov_b32 v2, v2
    s_nop 0
    v_mov_b32 v2, v2
    v_max3_f32 v153, v153, v140, v141
    v_max3_f32 v152, v152, v142, v143
    v_max_f32 v154, v152, v153
    v_max_f32 v155, v152, v153
    s_nop 1
    v_permlane32_swap_b32 v154, v155
    v_max_f32 v152, v154, v155
    v_max_f32 v153, v154, v155
    s_nop 1
    v_permlane16_swap_b32 v152, v153
    v_max_f32 v152, v152, v153
    v_mul_f32 v152, s28, v152
    v_pk_fma_f32 v[140:141], v[140:141], s[28:29], v[152:153] op_sel_hi:[1,0,0] neg_lo:[0,0,1] neg_hi:[0,0,1]
    v_pk_fma_f32 v[142:143], v[142:143], s[28:29], v[152:153] op_sel_hi:[1,0,0] neg_lo:[0,0,1] neg_hi:[0,0,1]
    v_pk_fma_f32 v[144:145], v[144:145], s[28:29], v[152:153] op_sel_hi:[1,0,0] neg_lo:[0,0,1] neg_hi:[0,0,1]
    v_pk_fma_f32 v[146:147], v[146:147], s[28:29], v[152:153] op_sel_hi:[1,0,0] neg_lo:[0,0,1] neg_hi:[0,0,1]
    v_pk_fma_f32 v[148:149], v[148:149], s[28:29], v[152:153] op_sel_hi:[1,0,0] neg_lo:[0,0,1] neg_hi:[0,0,1]
    v_pk_fma_f32 v[150:151], v[150:151], s[28:29], v[152:153] op_sel_hi:[1,0,0] neg_lo:[0,0,1] neg_hi:[0,0,1]
    v_exp_f32 v144, v144
    v_exp_f32 v145, v145
    v_exp_f32 v146, v146
    v_exp_f32 v147, v147
    v_exp_f32 v148, v148
    v_exp_f32 v149, v149
    v_exp_f32 v150, v150
    v_exp_f32 v151, v151
    v_cvt_pk_bf16_f32 v144, v144, v145
    v_cvt_pk_bf16_f32 v145, v146, v147
    v_cvt_pk_bf16_f32 v146, v148, v149
    v_cvt_pk_bf16_f32 v147, v150, v151
    v_exp_f32 v140, v140
    v_exp_f32 v141, v141
    v_mfma_f32_16x16x32_bf16 v[160:163], v[156:159], v[144:147], 0
    v_exp_f32 v142, v142
    v_mfma_f32_16x16x32_bf16 v[164:167], v[84:87], v[144:147], 0
    v_exp_f32 v143, v143
    v_mfma_f32_16x16x32_bf16 v[168:171], v[88:91], v[144:147], 0
    v_cvt_pk_bf16_f32 v140, v140, v141
    v_cvt_pk_bf16_f32 v141, v142, v143
    v_mfma_f32_16x16x32_bf16 v[172:175], v[92:95], v[144:147], 0
    v_cndmask_b32 v148, 0, v140, s[30:31]
    v_cndmask_b32 v149, 0, v141, s[30:31]
    v_mfma_f32_16x16x32_bf16 v[176:179], v[96:99], v[144:147], 0
    v_cndmask_b32 v150, v140, 0, s[30:31]
    v_cndmask_b32 v151, v141, 0, s[30:31]
    v_mfma_f32_16x16x16_bf16 v[160:163], v[156:157], v[148:149], v[160:163]
    v_mfma_f32_16x16x16_bf16 v[164:167], v[184:185], v[148:149], v[164:167]
    v_mfma_f32_16x16x16_bf16 v[168:171], v[184:185], v[150:151], v[168:171]
    v_mfma_f32_16x16x16_bf16 v[172:175], v[188:189], v[148:149], v[172:175]
    v_mfma_f32_16x16x16_bf16 v[176:179], v[188:189], v[150:151], v[176:179]
    s_nop 1
    v_mov_b32 v2, v2
    v_mov_b32 v2, v2
    v_rcp_f32 v160, v160
    s_nop 0
    v_pk_mul_f32 v[164:165], v[164:165], v[160:161] op_sel_hi:[1,0]
    v_pk_mul_f32 v[166:167], v[166:167], v[160:161] op_sel_hi:[1,0]
    v_pk_mul_f32 v[168:169], v[168:169], v[160:161] op_sel_hi:[1,0]
    v_pk_mul_f32 v[170:171], v[170:171], v[160:161] op_sel_hi:[1,0]
    v_cvt_pk_bf16_f32 v124, v164, v168
    v_cvt_pk_bf16_f32 v125, v165, v169
    v_cvt_pk_bf16_f32 v126, v166, v170
    v_cvt_pk_bf16_f32 v127, v167, v171
    buffer_store_dwordx4 v[124:127], v16, s[4:7], s27 offen offset:0 sc1
    v_pk_mul_f32 v[172:173], v[172:173], v[160:161] op_sel_hi:[1,0]
    v_pk_mul_f32 v[174:175], v[174:175], v[160:161] op_sel_hi:[1,0]
    v_pk_mul_f32 v[176:177], v[176:177], v[160:161] op_sel_hi:[1,0]
    v_pk_mul_f32 v[178:179], v[178:179], v[160:161] op_sel_hi:[1,0]
    v_cvt_pk_bf16_f32 v128, v172, v176
    v_cvt_pk_bf16_f32 v129, v173, v177
    v_cvt_pk_bf16_f32 v130, v174, v178
    v_cvt_pk_bf16_f32 v131, v175, v179
    buffer_store_dwordx4 v[128:131], v16, s[4:7], s27 offen offset:2048 sc1
    s_barrier
    s_add_u32 s26, s26, 131072
    s_add_u32 s34, s34, 131072
    s_add_u32 s27, s27, 262144
    s_add_u32 s14, s14, 1
    s_cmp_lt_u32 s14, 54
    s_cbranch_scc1 L_qaloop_50
    s_and_b32 s36, s26, 0xfffff000
    buffer_load_dwordx4 v[36:39], v11, s[4:7], s37 offen sc1
    buffer_load_dwordx4 v[40:43], v11, s[4:7], s37 offen offset:1024 sc1
    s_add_u32 s37, s37, 8192
    buffer_load_dword v181, off, s[4:7], s36 offset:4080 sc1
    s_waitcnt vmcnt(0)
L_qap3_57:
    v_readfirstlane_b32 s35, v181
    s_nop 0
    s_cmp_eq_u32 s35, -1
    s_cbranch_scc1 L_qnq_58
    buffer_load_dwordx4 v[184:187], v11, s[4:7], s26 offen offset:0 sc1
    buffer_load_dwordx4 v[188:191], v11, s[4:7], s26 offen offset:1024 sc1
    buffer_load_dwordx4 v[192:195], v11, s[4:7], s34 offen offset:0 sc1
    buffer_load_dwordx4 v[196:199], v11, s[4:7], s34 offen offset:1024 sc1
L_qnq_58:
    s_barrier
    ds_write_b128 v12, v[36:39]
    ds_write_b128 v12, v[40:43] offset:1024
    s_waitcnt lgkmcnt(0)
    s_barrier
    v_xor_b32 v2, 4096, v13
    v_xor_b32 v3, 4096, v19
    ds_read_b128 v[108:111], v13 offset:0
    ds_read_b128 v[52:55], v19 offset:0
    ds_read_b128 v[56:59], v19 offset:1024
    ds_read_b128 v[112:115], v13 offset:2048
    ds_read_b128 v[60:63], v19 offset:2048
    ds_read_b128 v[64:67], v19 offset:3072
    ds_read_b128 v[116:119], v2 offset:0
    ds_read_b128 v[68:71], v3 offset:0
    ds_read_b128 v[72:75], v3 offset:1024
    ds_read_b128 v[120:123], v2 offset:2048
    ds_read_b128 v[76:79], v3 offset:2048
    ds_read_b128 v[80:83], v3 offset:3072
    s_waitcnt lgkmcnt(9)
    v_mfma_f32_16x16x32_bf16 v[144:147], v[52:55], v[108:111], 0
    v_mfma_f32_16x16x32_bf16 v[148:151], v[56:59], v[108:111], 0
    ds_read_b128 v[84:87], v19 offset:8192
    s_waitcnt lgkmcnt(7)
    v_mfma_f32_16x16x32_bf16 v[144:147], v[60:63], v[112:115], v[144:147]
    v_mfma_f32_16x16x32_bf16 v[148:151], v[64:67], v[112:115], v[148:151]
    ds_read_b128 v[88:91], v19 offset:9216
    s_waitcnt lgkmcnt(5)
    v_mfma_f32_16x16x32_bf16 v[144:147], v[68:71], v[116:119], v[144:147]
    v_mfma_f32_16x16x32_bf16 v[148:151], v[72:75], v[116:119], v[148:151]
    ds_read_b128 v[92:95], v19 offset:10240
    s_waitcnt lgkmcnt(3)
    v_mfma_f32_16x16x32_bf16 v[144:147], v[76:79], v[120:123], v[144:147]
    v_mfma_f32_16x16x32_bf16 v[148:151], v[80:83], v[120:123], v[148:151]
    ds_read_b128 v[96:99], v19 offset:11264
    v_xor_b32 v19, 16384, v19
    s_nop 1
    v_mov_b32 v2, v2
    s_nop 0
    v_mov_b32 v2, v2
    v_cndmask_b32 v144, v180, v144, s[50:51]
    v_cndmask_b32 v145, v180, v145, s[52:53]
    v_cndmask_b32 v146, v180, v146, s[54:55]
    v_cndmask_b32 v147, v180, v147, s[56:57]
    v_cndmask_b32 v148, v180, v148, s[58:59]
    v_cndmask_b32 v149, v180, v149, s[60:61]
    v_cndmask_b32 v150, v180, v150, s[62:63]
    v_cndmask_b32 v151, v180, v151, s[64:65]
    v_max3_f32 v152, v144, v145, v146
    v_max3_f32 v153, v147, v148, v149
    v_max3_f32 v152, v152, v150, v151
    s_mov_b32 s45, 131072
    s_cmp_lg_u32 s35, -1
    s_cbranch_scc1 L_qkc_60
    s_waitcnt vmcnt(0)
    v_mov_b32 v10, s14
    s_mov_b64 exec, 1
    buffer_store_dword v10, off, s[4:7], s25 offset:0 sc1
    s_mov_b64 exec, -1
L_qcl_61:
    buffer_load_dword v181, off, s[4:7], s36 offset:4080 sc1
    s_sub_u32 s45, s45, 1
    s_cbranch_scc1 ABORT
    s_waitcnt vmcnt(0)
    v_cmp_eq_u32 vcc, -1, v181
    s_cbranch_vccnz L_qcl_61
L_qkl_59:
    buffer_load_dwordx4 v[184:187], v11, s[4:7], s26 offen offset:0 sc1
    buffer_load_dwordx4 v[188:191], v11, s[4:7], s26 offen offset:1024 sc1
    buffer_load_dwordx4 v[192:195], v11, s[4:7], s34 offen offset:0 sc1
    buffer_load_dwordx4 v[196:199], v11, s[4:7], s34 offen offset:1024 sc1
    s_sub_u32 s45, s45, 1
    s_cbranch_scc1 ABORT
L_qkc_60:
    s_waitcnt vmcnt(3)
    ds_write_b64 v14, v[186:187] offset:0
    v_max_u32 v10, v184, v185
    s_waitcnt vmcnt(2)
    ds_write_b64 v14, v[190:191] offset:544
    v_max3_u32 v10, v10, v188, v189
    s_waitcnt vmcnt(1)
    ds_write_b64 v14, v[194:195] offset:1088
    v_max3_u32 v10, v10, v192, v193
    s_waitcnt vmcnt(0)
    ds_write_b64 v14, v[198:199] offset:1632
    v_max3_u32 v10, v10, v196, v197
    v_cmp_eq_u32 vcc, -1, v10
    s_cbranch_vccnz L_qkl_59
    v_readlane_b32 s32, v18, 63
    s_cmp_eq_u32 s35, -1
    s_cbranch_scc1 L_qpb_62
    v_mov_b32 v10, s14
    s_mov_b64 exec, 1
    buffer_store_dword v10, off, s[4:7], s25 offset:0 sc1
    s_mov_b64 exec, -1
L_qpb_62:
    s_cmp_eq_u32 s14, 63
    s_cbranch_scc1 L_qn3_63
    s_add_u32 s24, s14, 2
    s_min_u32 s24, s24, 64
    s_xor_b32 s33, s33, 16384
    s_cmp_eq_u32 s14, 63
    s_cselect_b32 s17, 0, 524288
    s_add_u32 s23, s23, s17
    s_and_b32 s36, s26, 0xfffff000
    s_cmp_ge_u32 s32, s24
    s_cbranch_scc1 L_qakvok_65
    s_mov_b32 s45, 131072
L_qakv_64:
    s_sleep 2
    buffer_load_dword v10, v17, s[4:7], 0 offen sc1
    s_sub_u32 s45, s45, 1
    s_cbranch_scc1 ABORT
    s_waitcnt vmcnt(0)
    v_readlane_b32 s32, v10, 63
    s_nop 0
    s_cmp_ge_u32 s32, s24
    s_cbranch_scc0 L_qakv_64
L_qakvok_65:
    s_lshl_b32 s16, s13, 12
    s_add_u32 s16, s16, s33
    s_add_u32 m0, s16, 98304
    s_add_u32 s36, s36, 131072
    buffer_load_dwordx4 v[36:39], v11, s[4:7], s37 offen sc1
    buffer_load_dwordx4 v[40:43], v11, s[4:7], s37 offen offset:1024 sc1
    s_add_u32 s37, s37, 8192
    buffer_load_dwordx4 v11, s[4:7], s23 offen offset:0 sc1 lds
    buffer_load_dwordx4 v11, s[4:7], s23 offen offset:1024 sc1 lds
    buffer_load_dwordx4 v11, s[4:7], s23 offen offset:2048 sc1 lds
    buffer_load_dwordx4 v11, s[4:7], s23 offen offset:3072 sc1 lds
    buffer_load_dword v18, v17, s[4:7], 0 offen sc1
    buffer_load_dword v181, off, s[4:7], s36 offset:4080 sc1
L_qn3_63:
    ds_read_b64_tr_b16 v[124:125], v15 offset:0
    ds_read_b64_tr_b16 v[126:127], v15 offset:16
    ds_read_b64_tr_b16 v[128:129], v15 offset:544
    ds_read_b64_tr_b16 v[130:131], v15 offset:560
    ds_read_b64_tr_b16 v[132:133], v15 offset:1088
    ds_read_b64_tr_b16 v[134:135], v15 offset:1104
    ds_read_b64_tr_b16 v[136:137], v15 offset:1632
    ds_read_b64_tr_b16 v[138:139], v15 offset:1648
    s_waitcnt lgkmcnt(6)
    v_mfma_f32_16x16x32_bf16 v[140:143], v[124:127], v[108:111], 0
    s_waitcnt lgkmcnt(4)
    v_mfma_f32_16x16x32_bf16 v[140:143], v[128:131], v[112:115], v[140:143]
    s_waitcnt lgkmcnt(2)
    v_mfma_f32_16x16x32_bf16 v[140:143], v[132:135], v[116:119], v[140:143]
    s_waitcnt lgkmcnt(0)
    v_mfma_f32_16x16x32_bf16 v[140:143], v[136:139], v[120:123], v[140:143]
    s_nop 1
    v_mov_b32 v2, v2
    s_nop 1
    v_mov_b32 v2, v2
    s_nop 0
    v_mov_b32 v2, v2
    v_max3_f32 v153, v153, v140, v141
    v_max3_f32 v152, v152, v142, v143
    v_max_f32 v154, v152, v153
    v_max_f32 v155, v152, v153
    s_nop 1
    v_permlane32_swap_b32 v154, v155
    v_max_f32 v152, v154, v155
    v_max_f32 v153, v154, v155
    s_nop 1
    v_permlane16_swap_b32 v152, v153
    v_max_f32 v152, v152, v153
    v_mul_f32 v152, s28, v152
    v_pk_fma_f32 v[140:141], v[140:141], s[28:29], v[152:153] op_sel_hi:[1,0,0] neg_lo:[0,0,1] neg_hi:[0,0,1]
    v_pk_fma_f32 v[142:143], v[142:143], s[28:29], v[152:153] op_sel_hi:[1,0,0] neg_lo:[0,0,1] neg_hi:[0,0,1]
    v_pk_fma_f32 v[144:145], v[144:145], s[28:29], v[152:153] op_sel_hi:[1,0,0] neg_lo:[0,0,1] neg_hi:[0,0,1]
    v_pk_fma_f32 v[146:147], v[146:147], s[28:29], v[152:153] op_sel_hi:[1,0,0] neg_lo:[0,0,1] neg_hi:[0,0,1]
    v_pk_fma_f32 v[148:149], v[148:149], s[28:29], v[152:153] op_sel_hi:[1,0,0] neg_lo:[0,0,1] neg_hi:[0,0,1]
    v_pk_fma_f32 v[150:151], v[150:151], s[28:29], v[152:153] op_sel_hi:[1,0,0] neg_lo:[0,0,1] neg_hi:[0,0,1]
    v_exp_f32 v144, v144
    v_exp_f32 v145, v145
    v_exp_f32 v146, v146
    v_exp_f32 v147, v147
    v_exp_f32 v148, v148
    v_exp_f32 v149, v149
    v_exp_f32 v150, v150
    v_exp_f32 v151, v151
    v_cvt_pk_bf16_f32 v144, v144, v145
    v_cvt_pk_bf16_f32 v145, v146, v147
    v_cvt_pk_bf16_f32 v146, v148, v149
    v_cvt_pk_bf16_f32 v147, v150, v151
    v_exp_f32 v140, v140
    v_exp_f32 v141, v141
    v_mfma_f32_16x16x32_bf16 v[160:163], v[156:159], v[144:147], 0
    v_exp_f32 v142, v142
    v_mfma_f32_16x16x32_bf16 v[164:167], v[84:87], v[144:147], 0
    v_exp_f32 v143, v143
    v_mfma_f32_16x16x32_bf16 v[168:171], v[88:91], v[144:147], 0
    v_cvt_pk_bf16_f32 v140, v140, v141
    v_cvt_pk_bf16_f32 v141, v142, v143
    v_mfma_f32_16x16x32_bf16 v[172:175], v[92:95], v[144:147], 0
    v_cndmask_b32 v148, 0, v140, s[30:31]
    v_cndmask_b32 v149, 0, v141, s[30:31]
    v_mfma_f32_16x16x32_bf16 v[176:179], v[96:99], v[144:147], 0
    v_cndmask_b32 v150, v140, 0, s[30:31]
    v_cndmask_b32 v151, v141, 0, s[30:31]
    v_mfma_f32_16x16x16_bf16 v[160:163], v[156:157], v[148:149], v[160:163]
    v_mfma_f32_16x16x16_bf16 v[164:167], v[184:185], v[148:149], v[164:167]
    v_mfma_f32_16x16x16_bf16 v[168:171], v[184:185], v[150:151], v[168:171]
    v_mfma_f32_16x16x16_bf16 v[172:175], v[188:189], v[148:149], v[172:175]
    v_mfma_f32_16x16x16_bf16 v[176:179], v[188:189], v[150:151], v[176:179]
    s_nop 1
    v_mov_b32 v2, v2
    v_mov_b32 v2, v2
    v_rcp_f32 v160, v160
    s_nop 0
    v_pk_mul_f32 v[164:165], v[164:165], v[160:161] op_sel_hi:[1,0]
    v_pk_mul_f32 v[166:167], v[166:167], v[160:161] op_sel_hi:[1,0]
    v_pk_mul_f32 v[168:169], v[168:169], v[160:161] op_sel_hi:[1,0]
    v_pk_mul_f32 v[170:171], v[170:171], v[160:161] op_sel_hi:[1,0]
    v_cvt_pk_bf16_f32 v124, v164, v168
    v_cvt_pk_bf16_f32 v125, v165, v169
    v_cvt_pk_bf16_f32 v126, v166, v170
    v_cvt_pk_bf16_f32 v127, v167, v171
    buffer_store_dwordx4 v[124:127], v16, s[4:7], s27 offen offset:0 sc1
    v_pk_mul_f32 v[172:173], v[172:173], v[160:161] op_sel_hi:[1,0]
    v_pk_mul_f32 v[174:175], v[174:175], v[160:161] op_sel_hi:[1,0]
    v_pk_mul_f32 v[176:177], v[176:177], v[160:161] op_sel_hi:[1,0]
    v_pk_mul_f32 v[178:179], v[178:179], v[160:161] op_sel_hi:[1,0]
    v_cvt_pk_bf16_f32 v128, v172, v176
    v_cvt_pk_bf16_f32 v129, v173, v177
    v_cvt_pk_bf16_f32 v130, v174, v178
    v_cvt_pk_bf16_f32 v131, v175, v179
    buffer_store_dwordx4 v[128:131], v16, s[4:7], s27 offen offset:2048 sc1
    s_add_u32 s26, s26, 131072
    s_add_u32 s34, s34, 131072
    s_add_u32 s27, s27, 262144
    s_add_u32 s14, s14, 1
    s_waitcnt vmcnt(2)
    s_cmp_lt_u32 s14, 64
    s_cbranch_scc1 L_qap3_57
    s_waitcnt vmcnt(0)
    v_mov_b32 v10, s14
    s_mov_b64 exec, 1
    buffer_store_dword v10, off, s[4:7], s25 offset:0 sc1
    s_mov_b64 exec, -1
    s_endpgm
ROLE_OP:
    v_mbcnt_lo_u32_b32 v1, -1, 0
    v_mbcnt_hi_u32_b32 v1, -1, v1
    s_load_dwordx2 s[8:9], s[0:1], 40
    s_mov_b32 s10, 4718592
    s_mov_b32 s11, 0x20000
    s_waitcnt lgkmcnt(0)
    s_mul_i32 s20, s12, 7282
    s_lshr_b32 s20, s20, 16
    s_mul_i32 s16, s20, 9
    s_sub_u32 s21, s12, s16
    s_mul_i32 s16, s20, 1179648
    s_lshl_b32 s19, s21, 7
    s_add_u32 s16, s16, s19
    v_lshrrev_b32 v2, 3, v1
    v_mul_u32_u24 v2, 1152, v2
    v_and_b32 v3, 7, v1
    v_lshl_add_u32 v2, v3, 4, v2
    s_mul_i32 s17, s13, 9216
    s_add_u32 s17, s17, s16
    s_lshl_b32 s18, s13, 10
    s_add_u32 m0, s18, 0
    s_nop 0
    buffer_load_dwordx4 v2, s[8:11], s17 offen lds
    s_add_u32 s17, s17, 36864
    s_add_u32 m0, m0, 4096
    s_nop 0
    buffer_load_dwordx4 v2, s[8:11], s17 offen lds
    s_add_u32 s17, s17, 36864
    s_add_u32 m0, m0, 4096
    s_nop 0
    buffer_load_dwordx4 v2, s[8:11], s17 offen lds
    s_add_u32 s17, s17, 36864
    s_add_u32 m0, m0, 4096
    s_nop 0
    buffer_load_dwordx4 v2, s[8:11], s17 offen lds
    s_add_u32 s17, s17, 36864
    s_add_u32 m0, m0, 4096
    s_nop 0
    buffer_load_dwordx4 v2, s[8:11], s17 offen lds
    s_add_u32 s17, s17, 36864
    s_add_u32 m0, m0, 4096
    s_nop 0
    buffer_load_dwordx4 v2, s[8:11], s17 offen lds
    s_add_u32 s17, s17, 36864
    s_add_u32 m0, m0, 4096
    s_nop 0
    buffer_load_dwordx4 v2, s[8:11], s17 offen lds
    s_add_u32 s17, s17, 36864
    s_add_u32 m0, m0, 4096
    s_nop 0
    buffer_load_dwordx4 v2, s[8:11], s17 offen lds
    s_add_u32 s17, s17, 36864
    s_add_u32 m0, m0, 4096
    s_nop 0
    buffer_load_dwordx4 v2, s[8:11], s17 offen lds
    s_add_u32 s17, s17, 36864
    s_add_u32 m0, m0, 4096
    s_nop 0
    buffer_load_dwordx4 v2, s[8:11], s17 offen lds
    s_add_u32 s17, s17, 36864
    s_add_u32 m0, m0, 4096
    s_nop 0
    buffer_load_dwordx4 v2, s[8:11], s17 offen lds
    s_add_u32 s17, s17, 36864
    s_add_u32 m0, m0, 4096
    s_nop 0
    buffer_load_dwordx4 v2, s[8:11], s17 offen lds
    s_add_u32 s17, s17, 36864
    s_add_u32 m0, m0, 4096
    s_nop 0
    buffer_load_dwordx4 v2, s[8:11], s17 offen lds
    s_add_u32 s17, s17, 36864
    s_add_u32 m0, m0, 4096
    s_nop 0
    buffer_load_dwordx4 v2, s[8:11], s17 offen lds
    s_add_u32 s17, s17, 36864
    s_add_u32 m0, m0, 4096
    s_nop 0
    buffer_load_dwordx4 v2, s[8:11], s17 offen lds
    s_add_u32 s17, s17, 36864
    s_add_u32 m0, m0, 4096
    s_nop 0
    buffer_load_dwordx4 v2, s[8:11], s17 offen lds
    s_add_u32 s17, s17, 36864
    s_add_u32 m0, m0, 4096
    s_nop 0
    buffer_load_dwordx4 v2, s[8:11], s17 offen lds
    s_add_u32 s17, s17, 36864
    s_add_u32 m0, m0, 4096
    s_nop 0
    buffer_load_dwordx4 v2, s[8:11], s17 offen lds
    s_add_u32 s17, s17, 36864
    s_add_u32 m0, m0, 4096
    s_nop 0
    buffer_load_dwordx4 v2, s[8:11], s17 offen lds
    s_add_u32 s17, s17, 36864
    s_add_u32 m0, m0, 4096
    s_nop 0
    buffer_load_dwordx4 v2, s[8:11], s17 offen lds
    s_add_u32 s17, s17, 36864
    s_add_u32 m0, m0, 4096
    s_nop 0
    buffer_load_dwordx4 v2, s[8:11], s17 offen lds
    s_add_u32 s17, s17, 36864
    s_add_u32 m0, m0, 4096
    s_nop 0
    buffer_load_dwordx4 v2, s[8:11], s17 offen lds
    s_add_u32 s17, s17, 36864
    s_add_u32 m0, m0, 4096
    s_nop 0
    buffer_load_dwordx4 v2, s[8:11], s17 offen lds
    s_add_u32 s17, s17, 36864
    s_add_u32 m0, m0, 4096
    s_nop 0
    buffer_load_dwordx4 v2, s[8:11], s17 offen lds
    s_add_u32 s17, s17, 36864
    s_add_u32 m0, m0, 4096
    s_nop 0
    buffer_load_dwordx4 v2, s[8:11], s17 offen lds
    s_add_u32 s17, s17, 36864
    s_add_u32 m0, m0, 4096
    s_nop 0
    buffer_load_dwordx4 v2, s[8:11], s17 offen lds
    s_add_u32 s17, s17, 36864
    s_add_u32 m0, m0, 4096
    s_nop 0
    buffer_load_dwordx4 v2, s[8:11], s17 offen lds
    s_add_u32 s17, s17, 36864
    s_add_u32 m0, m0, 4096
    s_nop 0
    buffer_load_dwordx4 v2, s[8:11], s17 offen lds
    s_add_u32 s17, s17, 36864
    s_add_u32 m0, m0, 4096
    s_nop 0
    buffer_load_dwordx4 v2, s[8:11], s17 offen lds
    s_add_u32 s17, s17, 36864
    s_add_u32 m0, m0, 4096
    s_nop 0
    buffer_load_dwordx4 v2, s[8:11], s17 offen lds
    s_add_u32 s17, s17, 36864
    s_add_u32 m0, m0, 4096
    s_nop 0
    buffer_load_dwordx4 v2, s[8:11], s17 offen lds
    s_add_u32 s17, s17, 36864
    s_add_u32 m0, m0, 4096
    s_nop 0
    buffer_load_dwordx4 v2, s[8:11], s17 offen lds
    v_lshrrev_b32 v4, 5, v1
    v_bfe_u32 v2, v1, 2, 2
    v_lshl_add_u32 v4, v4, 3, v2
    v_mul_u32_u24 v4, 128, v4
    v_bfe_u32 v2, v1, 4, 1
    v_mul_u32_u24 v2, 32, v2
    v_add_u32 v4, v4, v2
    v_and_b32 v2, 3, v1
    v_lshl_add_u32 v4, v2, 3, v4
    s_mul_i32 s16, s13, 32768
    v_add_u32 v4, s16, v4
    v_add_u32 v5, 64, v4
    s_waitcnt vmcnt(0)
    s_barrier
    ds_read_b64_tr_b16 a[0:1], v4 offset:0
    ds_read_b64_tr_b16 a[2:3], v4 offset:512
    ds_read_b64_tr_b16 a[4:5], v4 offset:2048
    ds_read_b64_tr_b16 a[6:7], v4 offset:2560
    ds_read_b64_tr_b16 a[8:9], v4 offset:4096
    ds_read_b64_tr_b16 a[10:11], v4 offset:4608
    ds_read_b64_tr_b16 a[12:13], v4 offset:6144
    ds_read_b64_tr_b16 a[14:15], v4 offset:6656
    ds_read_b64_tr_b16 a[16:17], v4 offset:8192
    ds_read_b64_tr_b16 a[18:19], v4 offset:8704
    ds_read_b64_tr_b16 a[20:21], v4 offset:10240
    ds_read_b64_tr_b16 a[22:23], v4 offset:10752
    ds_read_b64_tr_b16 a[24:25], v4 offset:12288
    ds_read_b64_tr_b16 a[26:27], v4 offset:12800
    ds_read_b64_tr_b16 a[28:29], v4 offset:14336
    ds_read_b64_tr_b16 a[30:31], v4 offset:14848
    ds_read_b64_tr_b16 a[32:33], v4 offset:16384
    ds_read_b64_tr_b16 a[34:35], v4 offset:16896
    ds_read_b64_tr_b16 a[36:37], v4 offset:18432
    ds_read_b64_tr_b16 a[38:39], v4 offset:18944
    ds_read_b64_tr_b16 a[40:41], v4 offset:20480
    ds_read_b64_tr_b16 a[42:43], v4 offset:20992
    ds_read_b64_tr_b16 a[44:45], v4 offset:22528
    ds_read_b64_tr_b16 a[46:47], v4 offset:23040
    ds_read_b64_tr_b16 a[48:49], v4 offset:24576
    ds_read_b64_tr_b16 a[50:51], v4 offset:25088
    ds_read_b64_tr_b16 a[52:53], v4 offset:26624
    ds_read_b64_tr_b16 a[54:55], v4 offset:27136
    ds_read_b64_tr_b16 a[56:57], v4 offset:28672
    ds_read_b64_tr_b16 a[58:59], v4 offset:29184
    ds_read_b64_tr_b16 a[60:61], v4 offset:30720
    ds_read_b64_tr_b16 a[62:63], v4 offset:31232
    ds_read_b64_tr_b16 a[64:65], v5 offset:0
    ds_read_b64_tr_b16 a[66:67], v5 offset:512
    ds_read_b64_tr_b16 a[68:69], v5 offset:2048
    ds_read_b64_tr_b16 a[70:71], v5 offset:2560
    ds_read_b64_tr_b16 a[72:73], v5 offset:4096
    ds_read_b64_tr_b16 a[74:75], v5 offset:4608
    ds_read_b64_tr_b16 a[76:77], v5 offset:6144
    ds_read_b64_tr_b16 a[78:79], v5 offset:6656
    ds_read_b64_tr_b16 a[80:81], v5 offset:8192
    ds_read_b64_tr_b16 a[82:83], v5 offset:8704
    ds_read_b64_tr_b16 a[84:85], v5 offset:10240
    ds_read_b64_tr_b16 a[86:87], v5 offset:10752
    ds_read_b64_tr_b16 a[88:89], v5 offset:12288
    ds_read_b64_tr_b16 a[90:91], v5 offset:12800
    ds_read_b64_tr_b16 a[92:93], v5 offset:14336
    ds_read_b64_tr_b16 a[94:95], v5 offset:14848
    ds_read_b64_tr_b16 a[96:97], v5 offset:16384
    ds_read_b64_tr_b16 a[98:99], v5 offset:16896
    ds_read_b64_tr_b16 a[100:101], v5 offset:18432
    ds_read_b64_tr_b16 a[102:103], v5 offset:18944
    ds_read_b64_tr_b16 a[104:105], v5 offset:20480
    ds_read_b64_tr_b16 a[106:107], v5 offset:20992
    ds_read_b64_tr_b16 a[108:109], v5 offset:22528
    ds_read_b64_tr_b16 a[110:111], v5 offset:23040
    ds_read_b64_tr_b16 a[112:113], v5 offset:24576
    ds_read_b64_tr_b16 a[114:115], v5 offset:25088
    ds_read_b64_tr_b16 a[116:117], v5 offset:26624
    ds_read_b64_tr_b16 a[118:119], v5 offset:27136
    ds_read_b64_tr_b16 a[120:121], v5 offset:28672
    ds_read_b64_tr_b16 a[122:123], v5 offset:29184
    ds_read_b64_tr_b16 a[124:125], v5 offset:30720
    ds_read_b64_tr_b16 a[126:127], v5 offset:31232
    v_lshlrev_b32 v5, 4, v1
    s_lshl_b32 s16, s20, 2
    s_add_u32 s16, s16, s13
    s_mul_i32 s22, s16, 16384
    s_add_u32 s22, s22, 67108864
    s_mul_i32 s16, s16, 1024
    s_add_u32 s16, s16, 66560
    v_min_u32 v6, 7, v1
    v_lshl_add_u32 v6, v6, 7, s16
    v_and_b32 v2, 31, v1
    v_mul_u32_u24 v8, 272, v2
    v_lshrrev_b32 v2, 5, v1
    v_lshl_add_u32 v8, v2, 4, v8
    s_mul_i32 s16, s13, 8704
    v_add_u32 v8, s16, v8
    v_lshrrev_b32 v2, 4, v1
    s_lshl_b32 s16, s13, 3
    v_add_u32 v2, s16, v2
    v_and_b32 v3, 15, v1
    v_mul_u32_u24 v9, 272, v2
    v_lshl_add_u32 v9, v3, 4, v9
    v_mul_u32_u24 v10, 2304, v2
    v_lshl_add_u32 v10, v3, 4, v10
    s_mul_i32 s23, s20, 73728
    s_lshl_b32 s16, s21, 8
    s_add_u32 s23, s23, s16
    s_add_u32 s23, s23, 104857600
    s_lshl_b32 s25, s12, 7
    s_add_u32 s25, s25, 12288
    s_mov_b32 s14, 0
    s_mov_b32 s24, 1
    s_waitcnt lgkmcnt(0)
    v_mbcnt_lo_u32_b32 v2, -1, 0
    v_mbcnt_hi_u32_b32 v2, -1, v2
    v_and_b32 v2, 31, v2
    v_lshlrev_b32 v2, 2, v2
    s_mov_b32 s45, 131072
L_ver_66:
    buffer_load_dword v3, v2, s[84:87], 0 offen sc1
    s_sub_u32 s45, s45, 1
    s_cbranch_scc1 ABORT
    s_waitcnt vmcnt(0)
L_verchk_68:
    v_readlane_b32 s66, v3, 0
    v_readlane_b32 s67, v3, 4
    v_readlane_b32 s68, v3, 8
    v_readlane_b32 s69, v3, 12
    v_readlane_b32 s70, v3, 16
    v_readlane_b32 s71, v3, 20
    v_readlane_b32 s72, v3, 24
    v_readlane_b32 s73, v3, 28
    v_readlane_b32 s74, v3, 1
    s_add_u32 s75, s66, s67
    s_add_u32 s75, s75, s68
    s_add_u32 s75, s75, s69
    s_add_u32 s75, s75, s70
    s_add_u32 s75, s75, s71
    s_add_u32 s75, s75, s72
    s_add_u32 s75, s75, s73
    s_add_u32 s75, s75, s74
    s_cmp_ge_u32 s75, 267
    s_cbranch_scc1 L_ver_66_d
    s_sleep 16
    s_branch L_ver_66
L_ver_66_d:
    s_cmp_eq_u32 s93, 1
    s_cbranch_scc1 L_verok_67
    s_or_b32 s75, s66, s67
    s_or_b32 s75, s75, s68
    s_or_b32 s75, s75, s69
    s_or_b32 s75, s75, s70
    s_or_b32 s75, s75, s71
    s_or_b32 s75, s75, s72
    s_or_b32 s75, s75, s73
    s_cmp_lg_u32 s75, 32
    s_cbranch_scc1 REROLE
L_verok_67:
    s_barrier
    s_mov_b32 s45, 131072
L_wf_69:
    buffer_load_dword v7, v6, s[4:7], 0 offen sc1
    s_sub_u32 s45, s45, 1
    s_cbranch_scc1 ABORT
    s_waitcnt vmcnt(0)
    v_cmp_gt_u32 vcc, s24, v7
    s_cbranch_vccnz L_wf_69
L_wfok_70:
    v_mov_b32 v11, 0
L_OPlate_71:
    s_mov_b32 s17, s22
    s_add_u32 s22, s22, 262144
    buffer_load_dwordx4 v[16:19], v5, s[4:7], s17 offen offset:0 sc1
    buffer_load_dwordx4 v[20:23], v5, s[4:7], s17 offen offset:1024 sc1
    buffer_load_dwordx4 v[24:27], v5, s[4:7], s17 offen offset:2048 sc1
    buffer_load_dwordx4 v[28:31], v5, s[4:7], s17 offen offset:3072 sc1
    s_add_u32 s17, s17, 4096
    buffer_load_dwordx4 v[32:35], v5, s[4:7], s17 offen offset:0 sc1
    buffer_load_dwordx4 v[36:39], v5, s[4:7], s17 offen offset:1024 sc1
    buffer_load_dwordx4 v[40:43], v5, s[4:7], s17 offen offset:2048 sc1
    buffer_load_dwordx4 v[44:47], v5, s[4:7], s17 offen offset:3072 sc1
    s_add_u32 s17, s17, 4096
    buffer_load_dwordx4 v[48:51], v5, s[4:7], s17 offen offset:0 sc1
    buffer_load_dwordx4 v[52:55], v5, s[4:7], s17 offen offset:1024 sc1
    s_waitcnt vmcnt(9)
    v_mfma_f32_32x32x16_bf16 v[96:111], a[0:3], v[16:19], 0
    v_mfma_f32_32x32x16_bf16 v[112:127], a[64:67], v[16:19], 0
    buffer_load_dwordx4 v[56:59], v5, s[4:7], s17 offen offset:2048 sc1
    s_waitcnt vmcnt(9)
    v_mfma_f32_32x32x16_bf16 v[96:111], a[4:7], v[20:23], v[96:111]
    v_mfma_f32_32x32x16_bf16 v[112:127], a[68:71], v[20:23], v[112:127]
    buffer_load_dwordx4 v[60:63], v5, s[4:7], s17 offen offset:3072 sc1
    s_add_u32 s17, s17, 4096
    s_waitcnt vmcnt(9)
    v_mfma_f32_32x32x16_bf16 v[96:111], a[8:11], v[24:27], v[96:111]
    v_mfma_f32_32x32x16_bf16 v[112:127], a[72:75], v[24:27], v[112:127]
    buffer_load_dwordx4 v[64:67], v5, s[4:7], s17 offen offset:0 sc1
    s_waitcnt vmcnt(9)
    v_mfma_f32_32x32x16_bf16 v[96:111], a[12:15], v[28:31], v[96:111]
    v_mfma_f32_32x32x16_bf16 v[112:127], a[76:79], v[28:31], v[112:127]
    buffer_load_dwordx4 v[68:71], v5, s[4:7], s17 offen offset:1024 sc1
    s_waitcnt vmcnt(9)
    v_mfma_f32_32x32x16_bf16 v[96:111], a[16:19], v[32:35], v[96:111]
    v_mfma_f32_32x32x16_bf16 v[112:127], a[80:83], v[32:35], v[112:127]
    buffer_load_dwordx4 v[72:75], v5, s[4:7], s17 offen offset:2048 sc1
    s_waitcnt vmcnt(9)
    v_mfma_f32_32x32x16_bf16 v[96:111], a[20:23], v[36:39], v[96:111]
    v_mfma_f32_32x32x16_bf16 v[112:127], a[84:87], v[36:39], v[112:127]
    buffer_load_dwordx4 v[76:79], v5, s[4:7], s17 offen offset:3072 sc1
    s_add_u32 s17, s17, 4096
    s_waitcnt vmcnt(9)
    v_mfma_f32_32x32x16_bf16 v[96:111], a[24:27], v[40:43], v[96:111]
    v_mfma_f32_32x32x16_bf16 v[112:127], a[88:91], v[40:43], v[112:127]
    buffer_load_dword v11, v6, s[4:7], 0 offen sc1
    s_waitcnt vmcnt(9)
    v_mfma_f32_32x32x16_bf16 v[96:111], a[28:31], v[44:47], v[96:111]
    v_mfma_f32_32x32x16_bf16 v[112:127], a[92:95], v[44:47], v[112:127]
    s_waitcnt vmcnt(8)
    v_mfma_f32_32x32x16_bf16 v[96:111], a[32:35], v[48:51], v[96:111]
    v_mfma_f32_32x32x16_bf16 v[112:127], a[96:99], v[48:51], v[112:127]
    s_waitcnt vmcnt(7)
    v_mfma_f32_32x32x16_bf16 v[96:111], a[36:39], v[52:55], v[96:111]
    v_mfma_f32_32x32x16_bf16 v[112:127], a[100:103], v[52:55], v[112:127]
    s_waitcnt vmcnt(6)
    v_mfma_f32_32x32x16_bf16 v[96:111], a[40:43], v[56:59], v[96:111]
    v_mfma_f32_32x32x16_bf16 v[112:127], a[104:107], v[56:59], v[112:127]
    s_waitcnt vmcnt(5)
    v_mfma_f32_32x32x16_bf16 v[96:111], a[44:47], v[60:63], v[96:111]
    s_waitcnt vmcnt(4)
    v_mfma_f32_32x32x16_bf16 v[96:111], a[48:51], v[64:67], v[96:111]
    s_waitcnt vmcnt(3)
    v_mfma_f32_32x32x16_bf16 v[96:111], a[52:55], v[68:71], v[96:111]
    s_waitcnt vmcnt(2)
    v_mfma_f32_32x32x16_bf16 v[96:111], a[56:59], v[72:75], v[96:111]
    s_waitcnt vmcnt(1)
    v_mfma_f32_32x32x16_bf16 v[96:111], a[60:63], v[76:79], v[96:111]
    s_branch L_OPtail_75
L_OPlate2_72:
    s_mov_b32 s17, s22
    s_add_u32 s22, s22, 262144
    buffer_load_dwordx4 v[16:19], v5, s[4:7], s17 offen offset:0 sc1
    buffer_load_dwordx4 v[20:23], v5, s[4:7], s17 offen offset:1024 sc1
    buffer_load_dwordx4 v[24:27], v5, s[4:7], s17 offen offset:2048 sc1
    buffer_load_dwordx4 v[28:31], v5, s[4:7], s17 offen offset:3072 sc1
    s_add_u32 s17, s17, 4096
    buffer_load_dwordx4 v[32:35], v5, s[4:7], s17 offen offset:0 sc1
    buffer_load_dwordx4 v[36:39], v5, s[4:7], s17 offen offset:1024 sc1
    buffer_load_dwordx4 v[40:43], v5, s[4:7], s17 offen offset:2048 sc1
    buffer_load_dwordx4 v[44:47], v5, s[4:7], s17 offen offset:3072 sc1
    s_add_u32 s17, s17, 4096
    buffer_load_dwordx4 v[48:51], v5, s[4:7], s17 offen offset:0 sc1
    buffer_load_dwordx4 v[52:55], v5, s[4:7], s17 offen offset:1024 sc1
    s_waitcnt vmcnt(9)
    s_barrier
    s_cmp_lg_u32 s13, 0
    s_cbranch_scc1 L_pnf_77
    v_mov_b32 v2, s14
    s_mov_b64 exec, 1
    buffer_store_dword v2, off, s[4:7], s25 offset:0 sc1
    s_mov_b64 exec, -1
L_pnf_77:
    v_mfma_f32_32x32x16_bf16 v[96:111], a[0:3], v[16:19], 0
    v_mfma_f32_32x32x16_bf16 v[112:127], a[64:67], v[16:19], 0
    buffer_load_dwordx4 v[56:59], v5, s[4:7], s17 offen offset:2048 sc1
    s_waitcnt vmcnt(9)
    v_mfma_f32_32x32x16_bf16 v[96:111], a[4:7], v[20:23], v[96:111]
    v_mfma_f32_32x32x16_bf16 v[112:127], a[68:71], v[20:23], v[112:127]
    buffer_load_dwordx4 v[60:63], v5, s[4:7], s17 offen offset:3072 sc1
    s_add_u32 s17, s17, 4096
    s_waitcnt vmcnt(9)
    v_mfma_f32_32x32x16_bf16 v[96:111], a[8:11], v[24:27], v[96:111]
    v_mfma_f32_32x32x16_bf16 v[112:127], a[72:75], v[24:27], v[112:127]
    buffer_load_dwordx4 v[64:67], v5, s[4:7], s17 offen offset:0 sc1
    s_waitcnt vmcnt(9)
    v_mfma_f32_32x32x16_bf16 v[96:111], a[12:15], v[28:31], v[96:111]
    v_mfma_f32_32x32x16_bf16 v[112:127], a[76:79], v[28:31], v[112:127]
    buffer_load_dwordx4 v[68:71], v5, s[4:7], s17 offen offset:1024 sc1
    s_waitcnt vmcnt(9)
    v_mfma_f32_32x32x16_bf16 v[96:111], a[16:19], v[32:35], v[96:111]
    v_mfma_f32_32x32x16_bf16 v[112:127], a[80:83], v[32:35], v[112:127]
    buffer_load_dwordx4 v[72:75], v5, s[4:7], s17 offen offset:2048 sc1
    s_waitcnt vmcnt(9)
    v_mfma_f32_32x32x16_bf16 v[96:111], a[20:23], v[36:39], v[96:111]
    v_mfma_f32_32x32x16_bf16 v[112:127], a[84:87], v[36:39], v[112:127]
    buffer_load_dwordx4 v[76:79], v5, s[4:7], s17 offen offset:3072 sc1
    s_add_u32 s17, s17, 4096
    s_waitcnt vmcnt(9)
    v_mfma_f32_32x32x16_bf16 v[96:111], a[24:27], v[40:43], v[96:111]
    v_mfma_f32_32x32x16_bf16 v[112:127], a[88:91], v[40:43], v[112:127]
    buffer_load_dword v11, v6, s[4:7], 0 offen sc1
    s_waitcnt vmcnt(9)
    v_mfma_f32_32x32x16_bf16 v[96:111], a[28:31], v[44:47], v[96:111]
    v_mfma_f32_32x32x16_bf16 v[112:127], a[92:95], v[44:47], v[112:127]
    s_waitcnt vmcnt(8)
    v_mfma_f32_32x32x16_bf16 v[96:111], a[32:35], v[48:51], v[96:111]
    v_mfma_f32_32x32x16_bf16 v[112:127], a[96:99], v[48:51], v[112:127]
    s_waitcnt vmcnt(7)
    v_mfma_f32_32x32x16_bf16 v[96:111], a[36:39], v[52:55], v[96:111]
    v_mfma_f32_32x32x16_bf16 v[112:127], a[100:103], v[52:55], v[112:127]
    s_waitcnt vmcnt(6)
    v_mfma_f32_32x32x16_bf16 v[96:111], a[40:43], v[56:59], v[96:111]
    v_mfma_f32_32x32x16_bf16 v[112:127], a[104:107], v[56:59], v[112:127]
    s_waitcnt vmcnt(5)
    v_mfma_f32_32x32x16_bf16 v[96:111], a[44:47], v[60:63], v[96:111]
    s_waitcnt vmcnt(4)
    v_mfma_f32_32x32x16_bf16 v[96:111], a[48:51], v[64:67], v[96:111]
    s_waitcnt vmcnt(3)
    v_mfma_f32_32x32x16_bf16 v[96:111], a[52:55], v[68:71], v[96:111]
    s_waitcnt vmcnt(2)
    v_mfma_f32_32x32x16_bf16 v[96:111], a[56:59], v[72:75], v[96:111]
    s_waitcnt vmcnt(1)
    v_mfma_f32_32x32x16_bf16 v[96:111], a[60:63], v[76:79], v[96:111]
    s_branch L_OPtail_75
L_OPu_73:
    s_add_u32 s16, s24, 1
    s_waitcnt vmcnt(2)
    v_cmp_gt_u32 vcc, s16, v11
    s_cbranch_vccnz L_OPp0_74
    s_nop 1
    v_mov_b32 v12, v12
    s_nop 0
    v_mov_b32 v12, v12
    v_mfma_f32_32x32x16_bf16 v[96:111], a[0:3], v[16:19], 0
    v_mfma_f32_32x32x16_bf16 v[112:127], a[64:67], v[16:19], 0
    s_mov_b32 s17, s22
    s_add_u32 s22, s22, 262144
    buffer_load_dwordx4 v[16:19], v5, s[4:7], s17 offen offset:0 sc1
    v_mfma_f32_32x32x16_bf16 v[96:111], a[4:7], v[20:23], v[96:111]
    v_mfma_f32_32x32x16_bf16 v[112:127], a[68:71], v[20:23], v[112:127]
    buffer_load_dwordx4 v[20:23], v5, s[4:7], s17 offen offset:1024 sc1
    v_mfma_f32_32x32x16_bf16 v[96:111], a[8:11], v[24:27], v[96:111]
    v_mfma_f32_32x32x16_bf16 v[112:127], a[72:75], v[24:27], v[112:127]
    buffer_load_dwordx4 v[24:27], v5, s[4:7], s17 offen offset:2048 sc1
    v_mfma_f32_32x32x16_bf16 v[96:111], a[12:15], v[28:31], v[96:111]
    v_mfma_f32_32x32x16_bf16 v[112:127], a[76:79], v[28:31], v[112:127]
    buffer_load_dwordx4 v[28:31], v5, s[4:7], s17 offen offset:3072 sc1
    s_add_u32 s17, s17, 4096
    v_mfma_f32_32x32x16_bf16 v[96:111], a[16:19], v[32:35], v[96:111]
    v_mfma_f32_32x32x16_bf16 v[112:127], a[80:83], v[32:35], v[112:127]
    buffer_load_dwordx4 v[32:35], v5, s[4:7], s17 offen offset:0 sc1
    v_mfma_f32_32x32x16_bf16 v[96:111], a[20:23], v[36:39], v[96:111]
    v_mfma_f32_32x32x16_bf16 v[112:127], a[84:87], v[36:39], v[112:127]
    buffer_load_dwordx4 v[36:39], v5, s[4:7], s17 offen offset:1024 sc1
    v_mfma_f32_32x32x16_bf16 v[96:111], a[24:27], v[40:43], v[96:111]
    v_mfma_f32_32x32x16_bf16 v[112:127], a[88:91], v[40:43], v[112:127]
    buffer_load_dwordx4 v[40:43], v5, s[4:7], s17 offen offset:2048 sc1
    v_mfma_f32_32x32x16_bf16 v[96:111], a[28:31], v[44:47], v[96:111]
    v_mfma_f32_32x32x16_bf16 v[112:127], a[92:95], v[44:47], v[112:127]
    buffer_load_dwordx4 v[44:47], v5, s[4:7], s17 offen offset:3072 sc1
    s_add_u32 s17, s17, 4096
    v_mfma_f32_32x32x16_bf16 v[96:111], a[32:35], v[48:51], v[96:111]
    v_mfma_f32_32x32x16_bf16 v[112:127], a[96:99], v[48:51], v[112:127]
    buffer_load_dwordx4 v[48:51], v5, s[4:7], s17 offen offset:0 sc1
    s_waitcnt vmcnt(9)
    s_barrier
    s_cmp_lg_u32 s13, 0
    s_cbranch_scc1 L_pnf_78
    v_mov_b32 v2, s14
    s_mov_b64 exec, 1
    buffer_store_dword v2, off, s[4:7], s25 offset:0 sc1
    s_mov_b64 exec, -1
L_pnf_78:
    v_mfma_f32_32x32x16_bf16 v[96:111], a[36:39], v[52:55], v[96:111]
    v_mfma_f32_32x32x16_bf16 v[112:127], a[100:103], v[52:55], v[112:127]
    buffer_load_dwordx4 v[52:55], v5, s[4:7], s17 offen offset:1024 sc1
    v_mfma_f32_32x32x16_bf16 v[96:111], a[40:43], v[56:59], v[96:111]
    v_mfma_f32_32x32x16_bf16 v[112:127], a[104:107], v[56:59], v[112:127]
    buffer_load_dwordx4 v[56:59], v5, s[4:7], s17 offen offset:2048 sc1
    v_mfma_f32_32x32x16_bf16 v[96:111], a[44:47], v[60:63], v[96:111]
    v_mfma_f32_32x32x16_bf16 v[96:111], a[48:51], v[64:67], v[96:111]
    v_mfma_f32_32x32x16_bf16 v[96:111], a[52:55], v[68:71], v[96:111]
    v_mfma_f32_32x32x16_bf16 v[96:111], a[56:59], v[72:75], v[96:111]
    v_mfma_f32_32x32x16_bf16 v[96:111], a[60:63], v[76:79], v[96:111]
    v_mfma_f32_32x32x16_bf16 v[112:127], a[108:111], v[60:63], v[112:127]
    buffer_load_dwordx4 v[60:63], v5, s[4:7], s17 offen offset:3072 sc1
    s_add_u32 s17, s17, 4096
    s_add_u32 s14, s14, 1
    s_add_u32 s24, s14, 1
    s_mov_b32 s26, 1
    v_mfma_f32_32x32x16_bf16 v[112:127], a[112:115], v[64:67], v[112:127]
    buffer_load_dwordx4 v[64:67], v5, s[4:7], s17 offen offset:0 sc1
    s_nop 1
    v_mov_b32 v12, v12
    v_mov_b32 v12, v12
    ds_write_b128 v8, v[96:99] offset:0
    v_mfma_f32_32x32x16_bf16 v[112:127], a[116:119], v[68:71], v[112:127]
    buffer_load_dwordx4 v[68:71], v5, s[4:7], s17 offen offset:1024 sc1
    ds_write_b128 v8, v[100:103] offset:32
    v_mfma_f32_32x32x16_bf16 v[112:127], a[120:123], v[72:75], v[112:127]
    buffer_load_dwordx4 v[72:75], v5, s[4:7], s17 offen offset:2048 sc1
    ds_write_b128 v8, v[104:107] offset:64
    v_mfma_f32_32x32x16_bf16 v[112:127], a[124:127], v[76:79], v[112:127]
    buffer_load_dwordx4 v[76:79], v5, s[4:7], s17 offen offset:3072 sc1
    s_add_u32 s17, s17, 4096
    ds_write_b128 v8, v[108:111] offset:96
    s_nop 1
    v_mov_b32 v12, v12
    s_nop 1
    v_mov_b32 v12, v12
    s_nop 1
    v_mov_b32 v12, v12
    ds_write_b128 v8, v[112:115] offset:128
    ds_write_b128 v8, v[116:119] offset:160
    ds_write_b128 v8, v[120:123] offset:192
    ds_write_b128 v8, v[124:127] offset:224
    s_branch L_OPtail2_76
L_OPp0_74:
    v_mfma_f32_32x32x16_bf16 v[96:111], a[0:3], v[16:19], 0
    v_mfma_f32_32x32x16_bf16 v[112:127], a[64:67], v[16:19], 0
    v_mfma_f32_32x32x16_bf16 v[96:111], a[4:7], v[20:23], v[96:111]
    v_mfma_f32_32x32x16_bf16 v[112:127], a[68:71], v[20:23], v[112:127]
    v_mfma_f32_32x32x16_bf16 v[96:111], a[8:11], v[24:27], v[96:111]
    v_mfma_f32_32x32x16_bf16 v[112:127], a[72:75], v[24:27], v[112:127]
    v_mfma_f32_32x32x16_bf16 v[96:111], a[12:15], v[28:31], v[96:111]
    v_mfma_f32_32x32x16_bf16 v[112:127], a[76:79], v[28:31], v[112:127]
    v_mfma_f32_32x32x16_bf16 v[96:111], a[16:19], v[32:35], v[96:111]
    v_mfma_f32_32x32x16_bf16 v[112:127], a[80:83], v[32:35], v[112:127]
    v_mfma_f32_32x32x16_bf16 v[96:111], a[20:23], v[36:39], v[96:111]
    v_mfma_f32_32x32x16_bf16 v[112:127], a[84:87], v[36:39], v[112:127]
    v_mfma_f32_32x32x16_bf16 v[96:111], a[24:27], v[40:43], v[96:111]
    v_mfma_f32_32x32x16_bf16 v[112:127], a[88:91], v[40:43], v[112:127]
    v_mfma_f32_32x32x16_bf16 v[96:111], a[28:31], v[44:47], v[96:111]
    v_mfma_f32_32x32x16_bf16 v[112:127], a[92:95], v[44:47], v[112:127]
    v_mfma_f32_32x32x16_bf16 v[96:111], a[32:35], v[48:51], v[96:111]
    v_mfma_f32_32x32x16_bf16 v[112:127], a[96:99], v[48:51], v[112:127]
    s_waitcnt vmcnt(0)
    buffer_load_dword v11, v6, s[4:7], 0 offen sc1
    s_barrier
    s_cmp_lg_u32 s13, 0
    s_cbranch_scc1 L_pnf_79
    v_mov_b32 v2, s14
    s_mov_b64 exec, 1
    buffer_store_dword v2, off, s[4:7], s25 offset:0 sc1
    s_mov_b64 exec, -1
L_pnf_79:
    v_mfma_f32_32x32x16_bf16 v[96:111], a[36:39], v[52:55], v[96:111]
    v_mfma_f32_32x32x16_bf16 v[112:127], a[100:103], v[52:55], v[112:127]
    v_mfma_f32_32x32x16_bf16 v[96:111], a[40:43], v[56:59], v[96:111]
    v_mfma_f32_32x32x16_bf16 v[112:127], a[104:107], v[56:59], v[112:127]
    v_mfma_f32_32x32x16_bf16 v[96:111], a[44:47], v[60:63], v[96:111]
    v_mfma_f32_32x32x16_bf16 v[96:111], a[48:51], v[64:67], v[96:111]
    v_mfma_f32_32x32x16_bf16 v[96:111], a[52:55], v[68:71], v[96:111]
    v_mfma_f32_32x32x16_bf16 v[96:111], a[56:59], v[72:75], v[96:111]
    v_mfma_f32_32x32x16_bf16 v[96:111], a[60:63], v[76:79], v[96:111]
L_OPtail_75:
    v_mfma_f32_32x32x16_bf16 v[112:127], a[108:111], v[60:63], v[112:127]
    s_add_u32 s14, s14, 1
    s_add_u32 s24, s14, 1
    s_mov_b32 s26, 0
    v_mfma_f32_32x32x16_bf16 v[112:127], a[112:115], v[64:67], v[112:127]
    s_nop 1
    v_mov_b32 v12, v12
    s_nop 1
    v_mov_b32 v12, v12
    v_mov_b32 v12, v12
    ds_write_b128 v8, v[96:99] offset:0
    v_mfma_f32_32x32x16_bf16 v[112:127], a[116:119], v[68:71], v[112:127]
    ds_write_b128 v8, v[100:103] offset:32
    v_mfma_f32_32x32x16_bf16 v[112:127], a[120:123], v[72:75], v[112:127]
    ds_write_b128 v8, v[104:107] offset:64
    v_mfma_f32_32x32x16_bf16 v[112:127], a[124:127], v[76:79], v[112:127]
    ds_write_b128 v8, v[108:111] offset:96
    s_nop 1
    v_mov_b32 v12, v12
    s_nop 1
    v_mov_b32 v12, v12
    s_nop 1
    v_mov_b32 v12, v12
    s_nop 0
    v_mov_b32 v12, v12
    ds_write_b128 v8, v[112:115] offset:128
    ds_write_b128 v8, v[116:119] offset:160
    ds_write_b128 v8, v[120:123] offset:192
    ds_write_b128 v8, v[124:127] offset:224
    v_cmp_gt_u32 vcc, s24, v11
    s_cbranch_vccnz L_OPtail2_76
    s_mov_b32 s26, 1
    s_mov_b32 s17, s22
    s_add_u32 s22, s22, 262144
    buffer_load_dwordx4 v[16:19], v5, s[4:7], s17 offen offset:0 sc1
    buffer_load_dwordx4 v[20:23], v5, s[4:7], s17 offen offset:1024 sc1
    buffer_load_dwordx4 v[24:27], v5, s[4:7], s17 offen offset:2048 sc1
    buffer_load_dwordx4 v[28:31], v5, s[4:7], s17 offen offset:3072 sc1
    s_add_u32 s17, s17, 4096
    buffer_load_dwordx4 v[32:35], v5, s[4:7], s17 offen offset:0 sc1
    buffer_load_dwordx4 v[36:39], v5, s[4:7], s17 offen offset:1024 sc1
    buffer_load_dwordx4 v[40:43], v5, s[4:7], s17 offen offset:2048 sc1
    buffer_load_dwordx4 v[44:47], v5, s[4:7], s17 offen offset:3072 sc1
    s_add_u32 s17, s17, 4096
    buffer_load_dwordx4 v[48:51], v5, s[4:7], s17 offen offset:0 sc1
    buffer_load_dwordx4 v[52:55], v5, s[4:7], s17 offen offset:1024 sc1
    buffer_load_dwordx4 v[56:59], v5, s[4:7], s17 offen offset:2048 sc1
    buffer_load_dwordx4 v[60:63], v5, s[4:7], s17 offen offset:3072 sc1
    s_add_u32 s17, s17, 4096
    buffer_load_dwordx4 v[64:67], v5, s[4:7], s17 offen offset:0 sc1
    buffer_load_dwordx4 v[68:71], v5, s[4:7], s17 offen offset:1024 sc1
    buffer_load_dwordx4 v[72:75], v5, s[4:7], s17 offen offset:2048 sc1
    buffer_load_dwordx4 v[76:79], v5, s[4:7], s17 offen offset:3072 sc1
    s_add_u32 s17, s17, 4096
L_OPtail2_76:
    buffer_load_dword v11, v6, s[4:7], 0 offen sc1
    v_mov_b32 v12, v12
    s_nop 2
    v_mov_b32 v12, v12
    s_nop 2
    v_mov_b32 v12, v12
    s_nop 2
    s_waitcnt lgkmcnt(0)
    s_barrier
    ds_read_b128 v[128:131], v9 offset:0
    v_mov_b32 v12, v12
    ds_read_b128 v[132:135], v9 offset:8704
    v_mov_b32 v12, v12
    ds_read_b128 v[136:139], v9 offset:17408
    v_mov_b32 v12, v12
    ds_read_b128 v[140:143], v9 offset:26112
    v_mov_b32 v12, v12
    ds_read_b128 v[144:147], v9 offset:1088
    v_mov_b32 v12, v12
    ds_read_b128 v[148:151], v9 offset:9792
    v_mov_b32 v12, v12
    ds_read_b128 v[152:155], v9 offset:18496
    v_mov_b32 v12, v12
    ds_read_b128 v[156:159], v9 offset:27200
    v_mov_b32 v12, v12
    s_add_u32 s16, s23, 9216
    s_waitcnt lgkmcnt(4)
    v_pk_add_f32 v[128:129], v[128:129], v[132:133]
    v_pk_add_f32 v[136:137], v[136:137], v[140:141]
    v_pk_add_f32 v[130:131], v[130:131], v[134:135]
    v_pk_add_f32 v[138:139], v[138:139], v[142:143]
    v_pk_add_f32 v[128:129], v[128:129], v[136:137]
    v_pk_add_f32 v[130:131], v[130:131], v[138:139]
    buffer_store_dwordx4 v[128:131], v10, s[4:7], s23 offen sc1
    s_waitcnt lgkmcnt(0)
    v_pk_add_f32 v[144:145], v[144:145], v[148:149]
    v_pk_add_f32 v[152:153], v[152:153], v[156:157]
    v_pk_add_f32 v[146:147], v[146:147], v[150:151]
    v_pk_add_f32 v[154:155], v[154:155], v[158:159]
    v_pk_add_f32 v[144:145], v[144:145], v[152:153]
    v_pk_add_f32 v[146:147], v[146:147], v[154:155]
    buffer_store_dwordx4 v[144:147], v10, s[4:7], s16 offen sc1
    s_add_u32 s23, s23, 294912
    s_cmp_eq_u32 s26, 1
    s_cbranch_scc1 L_OPu_73
    s_waitcnt vmcnt(2)
    v_cmp_gt_u32 vcc, s24, v11
    s_cbranch_vccz L_OPlate2_72
    s_min_u32 s24, s24, 64
    s_mov_b32 s45, 131072
    buffer_load_dword v7, v6, s[4:7], 0 offen sc1
    s_waitcnt vmcnt(0)
    s_barrier
    s_cmp_lg_u32 s13, 0
    s_cbranch_scc1 L_pnf_82
    v_mov_b32 v2, s14
    s_mov_b64 exec, 1
    buffer_store_dword v2, off, s[4:7], s25 offset:0 sc1
    s_mov_b64 exec, -1
L_pnf_82:
    v_cmp_gt_u32 vcc, s24, v7
    s_cbranch_vccz L_wfok_81
L_wf_80:
    buffer_load_dword v7, v6, s[4:7], 0 offen sc1
    s_sub_u32 s45, s45, 1
    s_cbranch_scc1 ABORT
    s_waitcnt vmcnt(0)
    v_cmp_gt_u32 vcc, s24, v7
    s_cbranch_vccnz L_wf_80
L_wfok_81:
    s_cmp_lt_u32 s14, 64
    s_cbranch_scc1 L_OPlate_71
    s_endpgm
ROLE_DN:
    v_mbcnt_lo_u32_b32 v1, -1, 0
    v_mbcnt_hi_u32_b32 v1, -1, v1
    v_mbcnt_lo_u32_b32 v2, -1, 0
    v_mbcnt_hi_u32_b32 v2, -1, v2
    v_and_b32 v2, 31, v2
    v_lshlrev_b32 v2, 2, v2
    s_mov_b32 s45, 131072
L_ver_83:
    buffer_load_dword v3, v2, s[84:87], 0 offen sc1
    s_sub_u32 s45, s45, 1
    s_cbranch_scc1 ABORT
    s_waitcnt vmcnt(0)
L_verchk_85:
    v_readlane_b32 s66, v3, 0
    v_readlane_b32 s67, v3, 4
    v_readlane_b32 s68, v3, 8
    v_readlane_b32 s69, v3, 12
    v_readlane_b32 s70, v3, 16
    v_readlane_b32 s71, v3, 20
    v_readlane_b32 s72, v3, 24
    v_readlane_b32 s73, v3, 28
    v_readlane_b32 s74, v3, 1
    s_add_u32 s75, s66, s67
    s_add_u32 s75, s75, s68
    s_add_u32 s75, s75, s69
    s_add_u32 s75, s75, s70
    s_add_u32 s75, s75, s71
    s_add_u32 s75, s75, s72
    s_add_u32 s75, s75, s73
    s_add_u32 s75, s75, s74
    s_cmp_ge_u32 s75, 267
    s_cbranch_scc1 L_ver_83_d
    s_sleep 16
    s_branch L_ver_83
L_ver_83_d:
    s_cmp_eq_u32 s93, 1
    s_cbranch_scc1 L_verok_84
    s_or_b32 s75, s66, s67
    s_or_b32 s75, s75, s68
    s_or_b32 s75, s75, s69
    s_or_b32 s75, s75, s70
    s_or_b32 s75, s75, s71
    s_or_b32 s75, s75, s72
    s_or_b32 s75, s75, s73
    s_cmp_lg_u32 s75, 32
    s_cbranch_scc1 REROLE
L_verok_84:
    s_mov_b32 s45, 131072
L_ls_86:
    s_sleep 32
    buffer_load_dword v3, off, s[4:7], 0 offset:0 sc1
    s_sub_u32 s45, s45, 1
    s_cbranch_scc1 ABORT
    s_waitcnt vmcnt(0)
    v_cmp_gt_u32 vcc, 3, v3
    s_cbranch_vccnz L_ls_86
    s_load_dwordx2 s[8:9], s[0:1], 80
    s_mov_b32 s10, 5308416
    s_mov_b32 s11, 0x20000
    s_waitcnt lgkmcnt(0)
    s_mul_i32 s20, s12, 7282
    s_lshr_b32 s20, s20, 16
    s_mul_i32 s16, s20, 9
    s_sub_u32 s21, s12, s16
    s_mul_i32 s16, s20, 1327104
    s_lshl_b32 s19, s21, 7
    s_add_u32 s16, s16, s19
    v_lshrrev_b32 v2, 3, v1
    v_mul_u32_u24 v2, 1152, v2
    v_and_b32 v3, 7, v1
    v_lshl_add_u32 v2, v3, 4, v2
    s_mul_i32 s17, s13, 9216
    s_add_u32 s17, s17, s16
    s_lshl_b32 s18, s13, 10
    s_add_u32 m0, s18, 0
    s_nop 0
    buffer_load_dwordx4 v2, s[8:11], s17 offen lds
    s_add_u32 s17, s17, 36864
    s_add_u32 m0, m0, 4096
    s_nop 0
    buffer_load_dwordx4 v2, s[8:11], s17 offen lds
    s_add_u32 s17, s17, 36864
    s_add_u32 m0, m0, 4096
    s_nop 0
    buffer_load_dwordx4 v2, s[8:11], s17 offen lds
    s_add_u32 s17, s17, 36864
    s_add_u32 m0, m0, 4096
    s_nop 0
    buffer_load_dwordx4 v2, s[8:11], s17 offen lds
    s_add_u32 s17, s17, 36864
    s_add_u32 m0, m0, 4096
    s_nop 0
    buffer_load_dwordx4 v2, s[8:11], s17 offen lds
    s_add_u32 s17, s17, 36864
    s_add_u32 m0, m0, 4096
    s_nop 0
    buffer_load_dwordx4 v2, s[8:11], s17 offen lds
    s_add_u32 s17, s17, 36864
    s_add_u32 m0, m0, 4096
    s_nop 0
    buffer_load_dwordx4 v2, s[8:11], s17 offen lds
    s_add_u32 s17, s17, 36864
    s_add_u32 m0, m0, 4096
    s_nop 0
    buffer_load_dwordx4 v2, s[8:11], s17 offen lds
    s_add_u32 s17, s17, 36864
    s_add_u32 m0, m0, 4096
    s_nop 0
    buffer_load_dwordx4 v2, s[8:11], s17 offen lds
    s_add_u32 s17, s17, 36864
    s_add_u32 m0, m0, 4096
    s_nop 0
    buffer_load_dwordx4 v2, s[8:11], s17 offen lds
    s_add_u32 s17, s17, 36864
    s_add_u32 m0, m0, 4096
    s_nop 0
    buffer_load_dwordx4 v2, s[8:11], s17 offen lds
    s_add_u32 s17, s17, 36864
    s_add_u32 m0, m0, 4096
    s_nop 0
    buffer_load_dwordx4 v2, s[8:11], s17 offen lds
    s_add_u32 s17, s17, 36864
    s_add_u32 m0, m0, 4096
    s_nop 0
    buffer_load_dwordx4 v2, s[8:11], s17 offen lds
    s_add_u32 s17, s17, 36864
    s_add_u32 m0, m0, 4096
    s_nop 0
    buffer_load_dwordx4 v2, s[8:11], s17 offen lds
    s_add_u32 s17, s17, 36864
    s_add_u32 m0, m0, 4096
    s_nop 0
    buffer_load_dwordx4 v2, s[8:11], s17 offen lds
    s_add_u32 s17, s17, 36864
    s_add_u32 m0, m0, 4096
    s_nop 0
    buffer_load_dwordx4 v2, s[8:11], s17 offen lds
    s_add_u32 s17, s17, 36864
    s_add_u32 m0, m0, 4096
    s_nop 0
    buffer_load_dwordx4 v2, s[8:11], s17 offen lds
    s_add_u32 s17, s17, 36864
    s_add_u32 m0, m0, 4096
    s_nop 0
    buffer_load_dwordx4 v2, s[8:11], s17 offen lds
    s_add_u32 s17, s17, 36864
    s_add_u32 m0, m0, 4096
    s_nop 0
    buffer_load_dwordx4 v2, s[8:11], s17 offen lds
    s_add_u32 s17, s17, 36864
    s_add_u32 m0, m0, 4096
    s_nop 0
    buffer_load_dwordx4 v2, s[8:11], s17 offen lds
    s_add_u32 s17, s17, 36864
    s_add_u32 m0, m0, 4096
    s_nop 0
    buffer_load_dwordx4 v2, s[8:11], s17 offen lds
    s_add_u32 s17, s17, 36864
    s_add_u32 m0, m0, 4096
    s_nop 0
    buffer_load_dwordx4 v2, s[8:11], s17 offen lds
    s_add_u32 s17, s17, 36864
    s_add_u32 m0, m0, 4096
    s_nop 0
    buffer_load_dwordx4 v2, s[8:11], s17 offen lds
    s_add_u32 s17, s17, 36864
    s_add_u32 m0, m0, 4096
    s_nop 0
    buffer_load_dwordx4 v2, s[8:11], s17 offen lds
    s_add_u32 s17, s17, 36864
    s_add_u32 m0, m0, 4096
    s_nop 0
    buffer_load_dwordx4 v2, s[8:11], s17 offen lds
    s_add_u32 s17, s17, 36864
    s_add_u32 m0, m0, 4096
    s_nop 0
    buffer_load_dwordx4 v2, s[8:11], s17 offen lds
    s_add_u32 s17, s17, 36864
    s_add_u32 m0, m0, 4096
    s_nop 0
    buffer_load_dwordx4 v2, s[8:11], s17 offen lds
    s_add_u32 s17, s17, 36864
    s_add_u32 m0, m0, 4096
    s_nop 0
    buffer_load_dwordx4 v2, s[8:11], s17 offen lds
    s_add_u32 s17, s17, 36864
    s_add_u32 m0, m0, 4096
    s_nop 0
    buffer_load_dwordx4 v2, s[8:11], s17 offen lds
    s_add_u32 s17, s17, 36864
    s_add_u32 m0, m0, 4096
    s_nop 0
    buffer_load_dwordx4 v2, s[8:11], s17 offen lds
    s_add_u32 s17, s17, 36864
    s_add_u32 m0, m0, 4096
    s_nop 0
    buffer_load_dwordx4 v2, s[8:11], s17 offen lds
    s_add_u32 s17, s17, 36864
    s_add_u32 m0, m0, 4096
    s_nop 0
    buffer_load_dwordx4 v2, s[8:11], s17 offen lds
    s_add_u32 s17, s17, 36864
    s_add_u32 m0, m0, 4096
    s_nop 0
    buffer_load_dwordx4 v2, s[8:11], s17 offen lds
    s_add_u32 s17, s17, 36864
    s_add_u32 m0, m0, 4096
    s_nop 0
    buffer_load_dwordx4 v2, s[8:11], s17 offen lds
    s_add_u32 s17, s17, 36864
    s_add_u32 m0, m0, 4096
    s_nop 0
    buffer_load_dwordx4 v2, s[8:11], s17 offen lds
    s_add_u32 s17, s17, 36864
    s_add_u32 m0, m0, 4096
    s_nop 0
    buffer_load_dwordx4 v2, s[8:11], s17 offen lds
    v_lshrrev_b32 v4, 5, v1
    v_bfe_u32 v2, v1, 2, 2
    v_lshl_add_u32 v4, v4, 3, v2
    v_mul_u32_u24 v4, 128, v4
    v_bfe_u32 v2, v1, 4, 1
    v_mul_u32_u24 v2, 32, v2
    v_add_u32 v4, v4, v2
    v_and_b32 v2, 3, v1
    v_lshl_add_u32 v4, v2, 3, v4
    s_mul_i32 s16, s13, 36864
    v_add_u32 v4, s16, v4
    v_add_u32 v5, 64, v4
    s_waitcnt vmcnt(0)
    s_barrier
    ds_read_b64_tr_b16 a[0:1], v4 offset:0
    ds_read_b64_tr_b16 a[2:3], v4 offset:512
    ds_read_b64_tr_b16 a[4:5], v4 offset:2048
    ds_read_b64_tr_b16 a[6:7], v4 offset:2560
    ds_read_b64_tr_b16 a[8:9], v4 offset:4096
    ds_read_b64_tr_b16 a[10:11], v4 offset:4608
    ds_read_b64_tr_b16 a[12:13], v4 offset:6144
    ds_read_b64_tr_b16 a[14:15], v4 offset:6656
    ds_read_b64_tr_b16 a[16:17], v4 offset:8192
    ds_read_b64_tr_b16 a[18:19], v4 offset:8704
    ds_read_b64_tr_b16 a[20:21], v4 offset:10240
    ds_read_b64_tr_b16 a[22:23], v4 offset:10752
    ds_read_b64_tr_b16 a[24:25], v4 offset:12288
    ds_read_b64_tr_b16 a[26:27], v4 offset:12800
    ds_read_b64_tr_b16 a[28:29], v4 offset:14336
    ds_read_b64_tr_b16 a[30:31], v4 offset:14848
    ds_read_b64_tr_b16 a[32:33], v4 offset:16384
    ds_read_b64_tr_b16 a[34:35], v4 offset:16896
    ds_read_b64_tr_b16 a[36:37], v4 offset:18432
    ds_read_b64_tr_b16 a[38:39], v4 offset:18944
    ds_read_b64_tr_b16 a[40:41], v4 offset:20480
    ds_read_b64_tr_b16 a[42:43], v4 offset:20992
    ds_read_b64_tr_b16 a[44:45], v4 offset:22528
    ds_read_b64_tr_b16 a[46:47], v4 offset:23040
    ds_read_b64_tr_b16 a[48:49], v4 offset:24576
    ds_read_b64_tr_b16 a[50:51], v4 offset:25088
    ds_read_b64_tr_b16 a[52:53], v4 offset:26624
    ds_read_b64_tr_b16 a[54:55], v4 offset:27136
    ds_read_b64_tr_b16 a[56:57], v4 offset:28672
    ds_read_b64_tr_b16 a[58:59], v4 offset:29184
    ds_read_b64_tr_b16 a[60:61], v4 offset:30720
    ds_read_b64_tr_b16 a[62:63], v4 offset:31232
    ds_read_b64_tr_b16 a[64:65], v4 offset:32768
    ds_read_b64_tr_b16 a[66:67], v4 offset:33280
    ds_read_b64_tr_b16 a[68:69], v4 offset:34816
    ds_read_b64_tr_b16 a[70:71], v4 offset:35328
    ds_read_b64_tr_b16 a[72:73], v5 offset:0
    ds_read_b64_tr_b16 a[74:75], v5 offset:512
    ds_read_b64_tr_b16 a[76:77], v5 offset:2048
    ds_read_b64_tr_b16 a[78:79], v5 offset:2560
    ds_read_b64_tr_b16 a[80:81], v5 offset:4096
    ds_read_b64_tr_b16 a[82:83], v5 offset:4608
    ds_read_b64_tr_b16 a[84:85], v5 offset:6144
    ds_read_b64_tr_b16 a[86:87], v5 offset:6656
    ds_read_b64_tr_b16 a[88:89], v5 offset:8192
    ds_read_b64_tr_b16 a[90:91], v5 offset:8704
    ds_read_b64_tr_b16 a[92:93], v5 offset:10240
    ds_read_b64_tr_b16 a[94:95], v5 offset:10752
    ds_read_b64_tr_b16 a[96:97], v5 offset:12288
    ds_read_b64_tr_b16 a[98:99], v5 offset:12800
    ds_read_b64_tr_b16 a[100:101], v5 offset:14336
    ds_read_b64_tr_b16 a[102:103], v5 offset:14848
    ds_read_b64_tr_b16 a[104:105], v5 offset:16384
    ds_read_b64_tr_b16 a[106:107], v5 offset:16896
    ds_read_b64_tr_b16 a[108:109], v5 offset:18432
    ds_read_b64_tr_b16 a[110:111], v5 offset:18944
    ds_read_b64_tr_b16 a[112:113], v5 offset:20480
    ds_read_b64_tr_b16 a[114:115], v5 offset:20992
    ds_read_b64_tr_b16 a[116:117], v5 offset:22528
    ds_read_b64_tr_b16 a[118:119], v5 offset:23040
    ds_read_b64_tr_b16 a[120:121], v5 offset:24576
    ds_read_b64_tr_b16 a[122:123], v5 offset:25088
    ds_read_b64_tr_b16 a[124:125], v5 offset:26624
    ds_read_b64_tr_b16 a[126:127], v5 offset:27136
    ds_read_b64_tr_b16 a[128:129], v5 offset:28672
    ds_read_b64_tr_b16 a[130:131], v5 offset:29184
    ds_read_b64_tr_b16 a[132:133], v5 offset:30720
    ds_read_b64_tr_b16 a[134:135], v5 offset:31232
    ds_read_b64_tr_b16 a[136:137], v5 offset:32768
    ds_read_b64_tr_b16 a[138:139], v5 offset:33280
    ds_read_b64_tr_b16 a[140:141], v5 offset:34816
    ds_read_b64_tr_b16 a[142:143], v5 offset:35328
    v_lshlrev_b32 v5, 4, v1
    s_lshl_b32 s16, s20, 2
    s_add_u32 s16, s16, s13
    s_mul_i32 s22, s16, 18432
    s_add_u32 s22, s22, 83886080
    s_mul_i32 s16, s16, 2304
    s_add_u32 s16, s16, 25600
    v_min_u32 v6, 17, v1
    v_lshl_add_u32 v6, v6, 7, s16
    v_and_b32 v2, 31, v1
    v_mul_u32_u24 v8, 272, v2
    v_lshrrev_b32 v2, 5, v1
    v_lshl_add_u32 v8, v2, 4, v8
    s_mul_i32 s16, s13, 8704
    v_add_u32 v8, s16, v8
    v_lshrrev_b32 v2, 4, v1
    s_lshl_b32 s16, s13, 3
    v_add_u32 v2, s16, v2
    v_and_b32 v3, 15, v1
    v_mul_u32_u24 v9, 272, v2
    v_lshl_add_u32 v9, v3, 4, v9
    v_mul_u32_u24 v10, 2304, v2
    v_lshl_add_u32 v10, v3, 4, v10
    s_mul_i32 s23, s20, 73728
    s_lshl_b32 s16, s21, 8
    s_add_u32 s23, s23, s16
    s_add_u32 s23, s23, 125829120
    s_lshl_b32 s25, s12, 7
    s_add_u32 s25, s25, 20992
    s_mov_b32 s14, 0
    s_mov_b32 s24, 1
    s_waitcnt lgkmcnt(0)
    v_mbcnt_lo_u32_b32 v2, -1, 0
    v_mbcnt_hi_u32_b32 v2, -1, v2
    v_and_b32 v2, 31, v2
    v_lshlrev_b32 v2, 2, v2
    s_mov_b32 s45, 131072
L_ver_87:
    buffer_load_dword v3, v2, s[84:87], 0 offen sc1
    s_sub_u32 s45, s45, 1
    s_cbranch_scc1 ABORT
    s_waitcnt vmcnt(0)
L_verchk_89:
    v_readlane_b32 s66, v3, 0
    v_readlane_b32 s67, v3, 4
    v_readlane_b32 s68, v3, 8
    v_readlane_b32 s69, v3, 12
    v_readlane_b32 s70, v3, 16
    v_readlane_b32 s71, v3, 20
    v_readlane_b32 s72, v3, 24
    v_readlane_b32 s73, v3, 28
    v_readlane_b32 s74, v3, 1
    s_add_u32 s75, s66, s67
    s_add_u32 s75, s75, s68
    s_add_u32 s75, s75, s69
    s_add_u32 s75, s75, s70
    s_add_u32 s75, s75, s71
    s_add_u32 s75, s75, s72
    s_add_u32 s75, s75, s73
    s_add_u32 s75, s75, s74
    s_cmp_ge_u32 s75, 267
    s_cbranch_scc1 L_ver_87_d
    s_sleep 16
    s_branch L_ver_87
L_ver_87_d:
    s_cmp_eq_u32 s93, 1
    s_cbranch_scc1 L_verok_88
    s_or_b32 s75, s66, s67
    s_or_b32 s75, s75, s68
    s_or_b32 s75, s75, s69
    s_or_b32 s75, s75, s70
    s_or_b32 s75, s75, s71
    s_or_b32 s75, s75, s72
    s_or_b32 s75, s75, s73
    s_cmp_lg_u32 s75, 32
    s_cbranch_scc1 REROLE
L_verok_88:
    s_barrier
    s_mov_b32 s45, 131072
L_wf_90:
    buffer_load_dword v7, v6, s[4:7], 0 offen sc1
    s_sub_u32 s45, s45, 1
    s_cbranch_scc1 ABORT
    s_waitcnt vmcnt(0)
    v_cmp_gt_u32 vcc, s24, v7
    s_cbranch_vccnz L_wf_90
L_wfok_91:
    v_mov_b32 v11, 0
L_DNlate_92:
    s_mov_b32 s17, s22
    s_add_u32 s22, s22, 294912
    buffer_load_dwordx4 v[16:19], v5, s[4:7], s17 offen offset:0 sc1
    buffer_load_dwordx4 v[20:23], v5, s[4:7], s17 offen offset:1024 sc1
    buffer_load_dwordx4 v[24:27], v5, s[4:7], s17 offen offset:2048 sc1
    buffer_load_dwordx4 v[28:31], v5, s[4:7], s17 offen offset:3072 sc1
    s_add_u32 s17, s17, 4096
    buffer_load_dwordx4 v[32:35], v5, s[4:7], s17 offen offset:0 sc1
    buffer_load_dwordx4 v[36:39], v5, s[4:7], s17 offen offset:1024 sc1
    buffer_load_dwordx4 v[40:43], v5, s[4:7], s17 offen offset:2048 sc1
    buffer_load_dwordx4 v[44:47], v5, s[4:7], s17 offen offset:3072 sc1
    s_add_u32 s17, s17, 4096
    buffer_load_dwordx4 v[48:51], v5, s[4:7], s17 offen offset:0 sc1
    buffer_load_dwordx4 v[52:55], v5, s[4:7], s17 offen offset:1024 sc1
    s_waitcnt vmcnt(9)
    v_mfma_f32_32x32x16_bf16 v[96:111], a[0:3], v[16:19], 0
    v_mfma_f32_32x32x16_bf16 v[112:127], a[72:75], v[16:19], 0
    buffer_load_dwordx4 v[56:59], v5, s[4:7], s17 offen offset:2048 sc1
    s_waitcnt vmcnt(9)
    v_mfma_f32_32x32x16_bf16 v[96:111], a[4:7], v[20:23], v[96:111]
    v_mfma_f32_32x32x16_bf16 v[112:127], a[76:79], v[20:23], v[112:127]
    buffer_load_dwordx4 v[60:63], v5, s[4:7], s17 offen offset:3072 sc1
    s_add_u32 s17, s17, 4096
    s_waitcnt vmcnt(9)
    v_mfma_f32_32x32x16_bf16 v[96:111], a[8:11], v[24:27], v[96:111]
    v_mfma_f32_32x32x16_bf16 v[112:127], a[80:83], v[24:27], v[112:127]
    buffer_load_dwordx4 v[64:67], v5, s[4:7], s17 offen offset:0 sc1
    s_waitcnt vmcnt(9)
    v_mfma_f32_32x32x16_bf16 v[96:111], a[12:15], v[28:31], v[96:111]
    v_mfma_f32_32x32x16_bf16 v[112:127], a[84:87], v[28:31], v[112:127]
    buffer_load_dwordx4 v[68:71], v5, s[4:7], s17 offen offset:1024 sc1
    s_waitcnt vmcnt(9)
    v_mfma_f32_32x32x16_bf16 v[96:111], a[16:19], v[32:35], v[96:111]
    v_mfma_f32_32x32x16_bf16 v[112:127], a[88:91], v[32:35], v[112:127]
    buffer_load_dwordx4 v[72:75], v5, s[4:7], s17 offen offset:2048 sc1
    s_waitcnt vmcnt(9)
    v_mfma_f32_32x32x16_bf16 v[96:111], a[20:23], v[36:39], v[96:111]
    v_mfma_f32_32x32x16_bf16 v[112:127], a[92:95], v[36:39], v[112:127]
    buffer_load_dwordx4 v[76:79], v5, s[4:7], s17 offen offset:3072 sc1
    s_add_u32 s17, s17, 4096
    s_waitcnt vmcnt(9)
    v_mfma_f32_32x32x16_bf16 v[96:111], a[24:27], v[40:43], v[96:111]
    v_mfma_f32_32x32x16_bf16 v[112:127], a[96:99], v[40:43], v[112:127]
    buffer_load_dwordx4 v[80:83], v5, s[4:7], s17 offen offset:0 sc1
    s_waitcnt vmcnt(9)
    v_mfma_f32_32x32x16_bf16 v[96:111], a[28:31], v[44:47], v[96:111]
    v_mfma_f32_32x32x16_bf16 v[112:127], a[100:103], v[44:47], v[112:127]
    buffer_load_dwordx4 v[84:87], v5, s[4:7], s17 offen offset:1024 sc1
    s_waitcnt vmcnt(9)
    v_mfma_f32_32x32x16_bf16 v[96:111], a[32:35], v[48:51], v[96:111]
    v_mfma_f32_32x32x16_bf16 v[112:127], a[104:107], v[48:51], v[112:127]
    buffer_load_dword v11, v6, s[4:7], 0 offen sc1
    s_waitcnt vmcnt(9)
    v_mfma_f32_32x32x16_bf16 v[96:111], a[36:39], v[52:55], v[96:111]
    v_mfma_f32_32x32x16_bf16 v[112:127], a[108:111], v[52:55], v[112:127]
    s_waitcnt vmcnt(8)
    v_mfma_f32_32x32x16_bf16 v[96:111], a[40:43], v[56:59], v[96:111]
    v_mfma_f32_32x32x16_bf16 v[112:127], a[112:115], v[56:59], v[112:127]
    s_waitcnt vmcnt(7)
    v_mfma_f32_32x32x16_bf16 v[96:111], a[44:47], v[60:63], v[96:111]
    v_mfma_f32_32x32x16_bf16 v[112:127], a[116:119], v[60:63], v[112:127]
    s_waitcnt vmcnt(6)
    v_mfma_f32_32x32x16_bf16 v[96:111], a[48:51], v[64:67], v[96:111]
    v_mfma_f32_32x32x16_bf16 v[112:127], a[120:123], v[64:67], v[112:127]
    s_waitcnt vmcnt(5)
    v_mfma_f32_32x32x16_bf16 v[96:111], a[52:55], v[68:71], v[96:111]
    s_waitcnt vmcnt(4)
    v_mfma_f32_32x32x16_bf16 v[96:111], a[56:59], v[72:75], v[96:111]
    s_waitcnt vmcnt(3)
    v_mfma_f32_32x32x16_bf16 v[96:111], a[60:63], v[76:79], v[96:111]
    s_waitcnt vmcnt(2)
    v_mfma_f32_32x32x16_bf16 v[96:111], a[64:67], v[80:83], v[96:111]
    s_waitcnt vmcnt(1)
    v_mfma_f32_32x32x16_bf16 v[96:111], a[68:71], v[84:87], v[96:111]
    s_branch L_DNtail_96
L_DNlate2_93:
    s_mov_b32 s17, s22
    s_add_u32 s22, s22, 294912
    buffer_load_dwordx4 v[16:19], v5, s[4:7], s17 offen offset:0 sc1
    buffer_load_dwordx4 v[20:23], v5, s[4:7], s17 offen offset:1024 sc1
    buffer_load_dwordx4 v[24:27], v5, s[4:7], s17 offen offset:2048 sc1
    buffer_load_dwordx4 v[28:31], v5, s[4:7], s17 offen offset:3072 sc1
    s_add_u32 s17, s17, 4096
    buffer_load_dwordx4 v[32:35], v5, s[4:7], s17 offen offset:0 sc1
    buffer_load_dwordx4 v[36:39], v5, s[4:7], s17 offen offset:1024 sc1
    buffer_load_dwordx4 v[40:43], v5, s[4:7], s17 offen offset:2048 sc1
    buffer_load_dwordx4 v[44:47], v5, s[4:7], s17 offen offset:3072 sc1
    s_add_u32 s17, s17, 4096
    buffer_load_dwordx4 v[48:51], v5, s[4:7], s17 offen offset:0 sc1
    buffer_load_dwordx4 v[52:55], v5, s[4:7], s17 offen offset:1024 sc1
    s_waitcnt vmcnt(9)
    s_barrier
    s_cmp_lg_u32 s13, 0
    s_cbranch_scc1 L_pnf_98
    v_mov_b32 v2, s14
    s_mov_b64 exec, 1
    buffer_store_dword v2, off, s[4:7], s25 offset:0 sc1
    s_mov_b64 exec, -1
L_pnf_98:
    v_mfma_f32_32x32x16_bf16 v[96:111], a[0:3], v[16:19], 0
    v_mfma_f32_32x32x16_bf16 v[112:127], a[72:75], v[16:19], 0
    buffer_load_dwordx4 v[56:59], v5, s[4:7], s17 offen offset:2048 sc1
    s_waitcnt vmcnt(9)
    v_mfma_f32_32x32x16_bf16 v[96:111], a[4:7], v[20:23], v[96:111]
    v_mfma_f32_32x32x16_bf16 v[112:127], a[76:79], v[20:23], v[112:127]
    buffer_load_dwordx4 v[60:63], v5, s[4:7], s17 offen offset:3072 sc1
    s_add_u32 s17, s17, 4096
    s_waitcnt vmcnt(9)
    v_mfma_f32_32x32x16_bf16 v[96:111], a[8:11], v[24:27], v[96:111]
    v_mfma_f32_32x32x16_bf16 v[112:127], a[80:83], v[24:27], v[112:127]
    buffer_load_dwordx4 v[64:67], v5, s[4:7], s17 offen offset:0 sc1
    s_waitcnt vmcnt(9)
    v_mfma_f32_32x32x16_bf16 v[96:111], a[12:15], v[28:31], v[96:111]
    v_mfma_f32_32x32x16_bf16 v[112:127], a[84:87], v[28:31], v[112:127]
    buffer_load_dwordx4 v[68:71], v5, s[4:7], s17 offen offset:1024 sc1
    s_waitcnt vmcnt(9)
    v_mfma_f32_32x32x16_bf16 v[96:111], a[16:19], v[32:35], v[96:111]
    v_mfma_f32_32x32x16_bf16 v[112:127], a[88:91], v[32:35], v[112:127]
    buffer_load_dwordx4 v[72:75], v5, s[4:7], s17 offen offset:2048 sc1
    s_waitcnt vmcnt(9)
    v_mfma_f32_32x32x16_bf16 v[96:111], a[20:23], v[36:39], v[96:111]
    v_mfma_f32_32x32x16_bf16 v[112:127], a[92:95], v[36:39], v[112:127]
    buffer_load_dwordx4 v[76:79], v5, s[4:7], s17 offen offset:3072 sc1
    s_add_u32 s17, s17, 4096
    s_waitcnt vmcnt(9)
    v_mfma_f32_32x32x16_bf16 v[96:111], a[24:27], v[40:43], v[96:111]
    v_mfma_f32_32x32x16_bf16 v[112:127], a[96:99], v[40:43], v[112:127]
    buffer_load_dwordx4 v[80:83], v5, s[4:7], s17 offen offset:0 sc1
    s_waitcnt vmcnt(9)
    v_mfma_f32_32x32x16_bf16 v[96:111], a[28:31], v[44:47], v[96:111]
    v_mfma_f32_32x32x16_bf16 v[112:127], a[100:103], v[44:47], v[112:127]
    buffer_load_dwordx4 v[84:87], v5, s[4:7], s17 offen offset:1024 sc1
    s_waitcnt vmcnt(9)
    v_mfma_f32_32x32x16_bf16 v[96:111], a[32:35], v[48:51], v[96:111]
    v_mfma_f32_32x32x16_bf16 v[112:127], a[104:107], v[48:51], v[112:127]
    buffer_load_dword v11, v6, s[4:7], 0 offen sc1
    s_waitcnt vmcnt(9)
    v_mfma_f32_32x32x16_bf16 v[96:111], a[36:39], v[52:55], v[96:111]
    v_mfma_f32_32x32x16_bf16 v[112:127], a[108:111], v[52:55], v[112:127]
    s_waitcnt vmcnt(8)
    v_mfma_f32_32x32x16_bf16 v[96:111], a[40:43], v[56:59], v[96:111]
    v_mfma_f32_32x32x16_bf16 v[112:127], a[112:115], v[56:59], v[112:127]
    s_waitcnt vmcnt(7)
    v_mfma_f32_32x32x16_bf16 v[96:111], a[44:47], v[60:63], v[96:111]
    v_mfma_f32_32x32x16_bf16 v[112:127], a[116:119], v[60:63], v[112:127]
    s_waitcnt vmcnt(6)
    v_mfma_f32_32x32x16_bf16 v[96:111], a[48:51], v[64:67], v[96:111]
    v_mfma_f32_32x32x16_bf16 v[112:127], a[120:123], v[64:67], v[112:127]
    s_waitcnt vmcnt(5)
    v_mfma_f32_32x32x16_bf16 v[96:111], a[52:55], v[68:71], v[96:111]
    s_waitcnt vmcnt(4)
    v_mfma_f32_32x32x16_bf16 v[96:111], a[56:59], v[72:75], v[96:111]
    s_waitcnt vmcnt(3)
    v_mfma_f32_32x32x16_bf16 v[96:111], a[60:63], v[76:79], v[96:111]
    s_waitcnt vmcnt(2)
    v_mfma_f32_32x32x16_bf16 v[96:111], a[64:67], v[80:83], v[96:111]
    s_waitcnt vmcnt(1)
    v_mfma_f32_32x32x16_bf16 v[96:111], a[68:71], v[84:87], v[96:111]
    s_branch L_DNtail_96
L_DNu_94:
    s_add_u32 s16, s24, 1
    s_waitcnt vmcnt(2)
    v_cmp_gt_u32 vcc, s16, v11
    s_cbranch_vccnz L_DNp0_95
    s_nop 1
    v_mov_b32 v12, v12
    s_nop 0
    v_mov_b32 v12, v12
    v_mfma_f32_32x32x16_bf16 v[96:111], a[0:3], v[16:19], 0
    v_mfma_f32_32x32x16_bf16 v[112:127], a[72:75], v[16:19], 0
    s_mov_b32 s17, s22
    s_add_u32 s22, s22, 294912
    buffer_load_dwordx4 v[16:19], v5, s[4:7], s17 offen offset:0 sc1
    v_mfma_f32_32x32x16_bf16 v[96:111], a[4:7], v[20:23], v[96:111]
    v_mfma_f32_32x32x16_bf16 v[112:127], a[76:79], v[20:23], v[112:127]
    buffer_load_dwordx4 v[20:23], v5, s[4:7], s17 offen offset:1024 sc1
    v_mfma_f32_32x32x16_bf16 v[96:111], a[8:11], v[24:27], v[96:111]
    v_mfma_f32_32x32x16_bf16 v[112:127], a[80:83], v[24:27], v[112:127]
    buffer_load_dwordx4 v[24:27], v5, s[4:7], s17 offen offset:2048 sc1
    v_mfma_f32_32x32x16_bf16 v[96:111], a[12:15], v[28:31], v[96:111]
    v_mfma_f32_32x32x16_bf16 v[112:127], a[84:87], v[28:31], v[112:127]
    buffer_load_dwordx4 v[28:31], v5, s[4:7], s17 offen offset:3072 sc1
    s_add_u32 s17, s17, 4096
    v_mfma_f32_32x32x16_bf16 v[96:111], a[16:19], v[32:35], v[96:111]
    v_mfma_f32_32x32x16_bf16 v[112:127], a[88:91], v[32:35], v[112:127]
    buffer_load_dwordx4 v[32:35], v5, s[4:7], s17 offen offset:0 sc1
    v_mfma_f32_32x32x16_bf16 v[96:111], a[20:23], v[36:39], v[96:111]
    v_mfma_f32_32x32x16_bf16 v[112:127], a[92:95], v[36:39], v[112:127]
    buffer_load_dwordx4 v[36:39], v5, s[4:7], s17 offen offset:1024 sc1
    v_mfma_f32_32x32x16_bf16 v[96:111], a[24:27], v[40:43], v[96:111]
    v_mfma_f32_32x32x16_bf16 v[112:127], a[96:99], v[40:43], v[112:127]
    buffer_load_dwordx4 v[40:43], v5, s[4:7], s17 offen offset:2048 sc1
    v_mfma_f32_32x32x16_bf16 v[96:111], a[28:31], v[44:47], v[96:111]
    v_mfma_f32_32x32x16_bf16 v[112:127], a[100:103], v[44:47], v[112:127]
    buffer_load_dwordx4 v[44:47], v5, s[4:7], s17 offen offset:3072 sc1
    s_add_u32 s17, s17, 4096
    v_mfma_f32_32x32x16_bf16 v[96:111], a[32:35], v[48:51], v[96:111]
    v_mfma_f32_32x32x16_bf16 v[112:127], a[104:107], v[48:51], v[112:127]
    buffer_load_dwordx4 v[48:51], v5, s[4:7], s17 offen offset:0 sc1
    s_waitcnt vmcnt(9)
    s_barrier
    s_cmp_lg_u32 s13, 0
    s_cbranch_scc1 L_pnf_99
    v_mov_b32 v2, s14
    s_mov_b64 exec, 1
    buffer_store_dword v2, off, s[4:7], s25 offset:0 sc1
    s_mov_b64 exec, -1
L_pnf_99:
    v_mfma_f32_32x32x16_bf16 v[96:111], a[36:39], v[52:55], v[96:111]
    v_mfma_f32_32x32x16_bf16 v[112:127], a[108:111], v[52:55], v[112:127]
    buffer_load_dwordx4 v[52:55], v5, s[4:7], s17 offen offset:1024 sc1
    v_mfma_f32_32x32x16_bf16 v[96:111], a[40:43], v[56:59], v[96:111]
    v_mfma_f32_32x32x16_bf16 v[112:127], a[112:115], v[56:59], v[112:127]
    buffer_load_dwordx4 v[56:59], v5, s[4:7], s17 offen offset:2048 sc1
    v_mfma_f32_32x32x16_bf16 v[96:111], a[44:47], v[60:63], v[96:111]
    v_mfma_f32_32x32x16_bf16 v[112:127], a[116:119], v[60:63], v[112:127]
    buffer_load_dwordx4 v[60:63], v5, s[4:7], s17 offen offset:3072 sc1
    s_add_u32 s17, s17, 4096
    v_mfma_f32_32x32x16_bf16 v[96:111], a[48:51], v[64:67], v[96:111]
    v_mfma_f32_32x32x16_bf16 v[112:127], a[120:123], v[64:67], v[112:127]
    buffer_load_dwordx4 v[64:67], v5, s[4:7], s17 offen offset:0 sc1
    v_mfma_f32_32x32x16_bf16 v[96:111], a[52:55], v[68:71], v[96:111]
    v_mfma_f32_32x32x16_bf16 v[96:111], a[56:59], v[72:75], v[96:111]
    v_mfma_f32_32x32x16_bf16 v[96:111], a[60:63], v[76:79], v[96:111]
    v_mfma_f32_32x32x16_bf16 v[96:111], a[64:67], v[80:83], v[96:111]
    v_mfma_f32_32x32x16_bf16 v[96:111], a[68:71], v[84:87], v[96:111]
    v_mfma_f32_32x32x16_bf16 v[112:127], a[124:127], v[68:71], v[112:127]
    buffer_load_dwordx4 v[68:71], v5, s[4:7], s17 offen offset:1024 sc1
    s_add_u32 s14, s14, 1
    s_add_u32 s24, s14, 1
    s_mov_b32 s26, 1
    v_mfma_f32_32x32x16_bf16 v[112:127], a[128:131], v[72:75], v[112:127]
    buffer_load_dwordx4 v[72:75], v5, s[4:7], s17 offen offset:2048 sc1
    s_nop 1
    v_mov_b32 v12, v12
    s_nop 0
    v_mov_b32 v12, v12
    ds_write_b128 v8, v[96:99] offset:0
    v_mfma_f32_32x32x16_bf16 v[112:127], a[132:135], v[76:79], v[112:127]
    buffer_load_dwordx4 v[76:79], v5, s[4:7], s17 offen offset:3072 sc1
    s_add_u32 s17, s17, 4096
    ds_write_b128 v8, v[100:103] offset:32
    v_mfma_f32_32x32x16_bf16 v[112:127], a[136:139], v[80:83], v[112:127]
    buffer_load_dwordx4 v[80:83], v5, s[4:7], s17 offen offset:0 sc1
    ds_write_b128 v8, v[104:107] offset:64
    v_mfma_f32_32x32x16_bf16 v[112:127], a[140:143], v[84:87], v[112:127]
    buffer_load_dwordx4 v[84:87], v5, s[4:7], s17 offen offset:1024 sc1
    ds_write_b128 v8, v[108:111] offset:96
    s_nop 1
    v_mov_b32 v12, v12
    s_nop 1
    v_mov_b32 v12, v12
    s_nop 1
    v_mov_b32 v12, v12
    v_mov_b32 v12, v12
    ds_write_b128 v8, v[112:115] offset:128
    ds_write_b128 v8, v[116:119] offset:160
    ds_write_b128 v8, v[120:123] offset:192
    ds_write_b128 v8, v[124:127] offset:224
    s_branch L_DNtail2_97
L_DNp0_95:
    v_mfma_f32_32x32x16_bf16 v[96:111], a[0:3], v[16:19], 0
    v_mfma_f32_32x32x16_bf16 v[112:127], a[72:75], v[16:19], 0
    v_mfma_f32_32x32x16_bf16 v[96:111], a[4:7], v[20:23], v[96:111]
    v_mfma_f32_32x32x16_bf16 v[112:127], a[76:79], v[20:23], v[112:127]
    v_mfma_f32_32x32x16_bf16 v[96:111], a[8:11], v[24:27], v[96:111]
    v_mfma_f32_32x32x16_bf16 v[112:127], a[80:83], v[24:27], v[112:127]
    v_mfma_f32_32x32x16_bf16 v[96:111], a[12:15], v[28:31], v[96:111]
    v_mfma_f32_32x32x16_bf16 v[112:127], a[84:87], v[28:31], v[112:127]
    v_mfma_f32_32x32x16_bf16 v[96:111], a[16:19], v[32:35], v[96:111]
    v_mfma_f32_32x32x16_bf16 v[112:127], a[88:91], v[32:35], v[112:127]
    v_mfma_f32_32x32x16_bf16 v[96:111], a[20:23], v[36:39], v[96:111]
    v_mfma_f32_32x32x16_bf16 v[112:127], a[92:95], v[36:39], v[112:127]
    v_mfma_f32_32x32x16_bf16 v[96:111], a[24:27], v[40:43], v[96:111]
    v_mfma_f32_32x32x16_bf16 v[112:127], a[96:99], v[40:43], v[112:127]
    v_mfma_f32_32x32x16_bf16 v[96:111], a[28:31], v[44:47], v[96:111]
    v_mfma_f32_32x32x16_bf16 v[112:127], a[100:103], v[44:47], v[112:127]
    v_mfma_f32_32x32x16_bf16 v[96:111], a[32:35], v[48:51], v[96:111]
    v_mfma_f32_32x32x16_bf16 v[112:127], a[104:107], v[48:51], v[112:127]
    s_waitcnt vmcnt(0)
    buffer_load_dword v11, v6, s[4:7], 0 offen sc1
    s_barrier
    s_cmp_lg_u32 s13, 0
    s_cbranch_scc1 L_pnf_100
    v_mov_b32 v2, s14
    s_mov_b64 exec, 1
    buffer_store_dword v2, off, s[4:7], s25 offset:0 sc1
    s_mov_b64 exec, -1
L_pnf_100:
    v_mfma_f32_32x32x16_bf16 v[96:111], a[36:39], v[52:55], v[96:111]
    v_mfma_f32_32x32x16_bf16 v[112:127], a[108:111], v[52:55], v[112:127]
    v_mfma_f32_32x32x16_bf16 v[96:111], a[40:43], v[56:59], v[96:111]
    v_mfma_f32_32x32x16_bf16 v[112:127], a[112:115], v[56:59], v[112:127]
    v_mfma_f32_32x32x16_bf16 v[96:111], a[44:47], v[60:63], v[96:111]
    v_mfma_f32_32x32x16_bf16 v[112:127], a[116:119], v[60:63], v[112:127]
    v_mfma_f32_32x32x16_bf16 v[96:111], a[48:51], v[64:67], v[96:111]
    v_mfma_f32_32x32x16_bf16 v[112:127], a[120:123], v[64:67], v[112:127]
    v_mfma_f32_32x32x16_bf16 v[96:111], a[52:55], v[68:71], v[96:111]
    v_mfma_f32_32x32x16_bf16 v[96:111], a[56:59], v[72:75], v[96:111]
    v_mfma_f32_32x32x16_bf16 v[96:111], a[60:63], v[76:79], v[96:111]
    v_mfma_f32_32x32x16_bf16 v[96:111], a[64:67], v[80:83], v[96:111]
    v_mfma_f32_32x32x16_bf16 v[96:111], a[68:71], v[84:87], v[96:111]
L_DNtail_96:
    v_mfma_f32_32x32x16_bf16 v[112:127], a[124:127], v[68:71], v[112:127]
    s_add_u32 s14, s14, 1
    s_add_u32 s24, s14, 1
    s_mov_b32 s26, 0
    v_mfma_f32_32x32x16_bf16 v[112:127], a[128:131], v[72:75], v[112:127]
    s_nop 1
    v_mov_b32 v12, v12
    s_nop 1
    v_mov_b32 v12, v12
    v_mov_b32 v12, v12
    ds_write_b128 v8, v[96:99] offset:0
    v_mfma_f32_32x32x16_bf16 v[112:127], a[132:135], v[76:79], v[112:127]
    ds_write_b128 v8, v[100:103] offset:32
    v_mfma_f32_32x32x16_bf16 v[112:127], a[136:139], v[80:83], v[112:127]
    ds_write_b128 v8, v[104:107] offset:64
    v_mfma_f32_32x32x16_bf16 v[112:127], a[140:143], v[84:87], v[112:127]
    ds_write_b128 v8, v[108:111] offset:96
    s_nop 1
    v_mov_b32 v12, v12
    s_nop 1
    v_mov_b32 v12, v12
    s_nop 1
    v_mov_b32 v12, v12
    s_nop 0
    v_mov_b32 v12, v12
    ds_write_b128 v8, v[112:115] offset:128
    ds_write_b128 v8, v[116:119] offset:160
    ds_write_b128 v8, v[120:123] offset:192
    ds_write_b128 v8, v[124:127] offset:224
    v_cmp_gt_u32 vcc, s24, v11
    s_cbranch_vccnz L_DNtail2_97
    s_mov_b32 s26, 1
    s_mov_b32 s17, s22
    s_add_u32 s22, s22, 294912
    buffer_load_dwordx4 v[16:19], v5, s[4:7], s17 offen offset:0 sc1
    buffer_load_dwordx4 v[20:23], v5, s[4:7], s17 offen offset:1024 sc1
    buffer_load_dwordx4 v[24:27], v5, s[4:7], s17 offen offset:2048 sc1
    buffer_load_dwordx4 v[28:31], v5, s[4:7], s17 offen offset:3072 sc1
    s_add_u32 s17, s17, 4096
    buffer_load_dwordx4 v[32:35], v5, s[4:7], s17 offen offset:0 sc1
    buffer_load_dwordx4 v[36:39], v5, s[4:7], s17 offen offset:1024 sc1
    buffer_load_dwordx4 v[40:43], v5, s[4:7], s17 offen offset:2048 sc1
    buffer_load_dwordx4 v[44:47], v5, s[4:7], s17 offen offset:3072 sc1
    s_add_u32 s17, s17, 4096
    buffer_load_dwordx4 v[48:51], v5, s[4:7], s17 offen offset:0 sc1
    buffer_load_dwordx4 v[52:55], v5, s[4:7], s17 offen offset:1024 sc1
    buffer_load_dwordx4 v[56:59], v5, s[4:7], s17 offen offset:2048 sc1
    buffer_load_dwordx4 v[60:63], v5, s[4:7], s17 offen offset:3072 sc1
    s_add_u32 s17, s17, 4096
    buffer_load_dwordx4 v[64:67], v5, s[4:7], s17 offen offset:0 sc1
    buffer_load_dwordx4 v[68:71], v5, s[4:7], s17 offen offset:1024 sc1
    buffer_load_dwordx4 v[72:75], v5, s[4:7], s17 offen offset:2048 sc1
    buffer_load_dwordx4 v[76:79], v5, s[4:7], s17 offen offset:3072 sc1
    s_add_u32 s17, s17, 4096
    buffer_load_dwordx4 v[80:83], v5, s[4:7], s17 offen offset:0 sc1
    buffer_load_dwordx4 v[84:87], v5, s[4:7], s17 offen offset:1024 sc1
L_DNtail2_97:
    buffer_load_dword v11, v6, s[4:7], 0 offen sc1
    v_mov_b32 v12, v12
    s_nop 2
    v_mov_b32 v12, v12
    s_nop 2
    v_mov_b32 v12, v12
    s_nop 2
    s_waitcnt lgkmcnt(0)
    s_barrier
    ds_read_b128 v[128:131], v9 offset:0
    v_mov_b32 v12, v12
    ds_read_b128 v[132:135], v9 offset:8704
    v_mov_b32 v12, v12
    ds_read_b128 v[136:139], v9 offset:17408
    v_mov_b32 v12, v12
    ds_read_b128 v[140:143], v9 offset:26112
    v_mov_b32 v12, v12
    ds_read_b128 v[144:147], v9 offset:1088
    v_mov_b32 v12, v12
    ds_read_b128 v[148:151], v9 offset:9792
    v_mov_b32 v12, v12
    ds_read_b128 v[152:155], v9 offset:18496
    v_mov_b32 v12, v12
    ds_read_b128 v[156:159], v9 offset:27200
    v_mov_b32 v12, v12
    s_add_u32 s16, s23, 9216
    s_waitcnt lgkmcnt(4)
    v_pk_add_f32 v[128:129], v[128:129], v[132:133]
    v_pk_add_f32 v[136:137], v[136:137], v[140:141]
    v_pk_add_f32 v[130:131], v[130:131], v[134:135]
    v_pk_add_f32 v[138:139], v[138:139], v[142:143]
    v_pk_add_f32 v[128:129], v[128:129], v[136:137]
    v_pk_add_f32 v[130:131], v[130:131], v[138:139]
    buffer_store_dwordx4 v[128:131], v10, s[4:7], s23 offen sc1
    s_waitcnt lgkmcnt(0)
    v_pk_add_f32 v[144:145], v[144:145], v[148:149]
    v_pk_add_f32 v[152:153], v[152:153], v[156:157]
    v_pk_add_f32 v[146:147], v[146:147], v[150:151]
    v_pk_add_f32 v[154:155], v[154:155], v[158:159]
    v_pk_add_f32 v[144:145], v[144:145], v[152:153]
    v_pk_add_f32 v[146:147], v[146:147], v[154:155]
    buffer_store_dwordx4 v[144:147], v10, s[4:7], s16 offen sc1
    s_add_u32 s23, s23, 294912
    s_cmp_eq_u32 s26, 1
    s_cbranch_scc1 L_DNu_94
    s_waitcnt vmcnt(2)
    v_cmp_gt_u32 vcc, s24, v11
    s_cbranch_vccz L_DNlate2_93
    s_min_u32 s24, s24, 64
    s_mov_b32 s45, 131072
    buffer_load_dword v7, v6, s[4:7], 0 offen sc1
    s_waitcnt vmcnt(0)
    s_barrier
    s_cmp_lg_u32 s13, 0
    s_cbranch_scc1 L_pnf_103
    v_mov_b32 v2, s14
    s_mov_b64 exec, 1
    buffer_store_dword v2, off, s[4:7], s25 offset:0 sc1
    s_mov_b64 exec, -1
L_pnf_103:
    v_cmp_gt_u32 vcc, s24, v7
    s_cbranch_vccz L_wfok_102
L_wf_101:
    buffer_load_dword v7, v6, s[4:7], 0 offen sc1
    s_sub_u32 s45, s45, 1
    s_cbranch_scc1 ABORT
    s_waitcnt vmcnt(0)
    v_cmp_gt_u32 vcc, s24, v7
    s_cbranch_vccnz L_wf_101
L_wfok_102:
    s_cmp_lt_u32 s14, 64
    s_cbranch_scc1 L_DNlate_92
    s_endpgm
ROLE_GU:
    v_mbcnt_lo_u32_b32 v1, -1, 0
    v_mbcnt_hi_u32_b32 v1, -1, v1
    v_mbcnt_lo_u32_b32 v2, -1, 0
    v_mbcnt_hi_u32_b32 v2, -1, v2
    v_and_b32 v2, 31, v2
    v_lshlrev_b32 v2, 2, v2
    s_mov_b32 s45, 131072
L_ver_104:
    buffer_load_dword v3, v2, s[84:87], 0 offen sc1
    s_sub_u32 s45, s45, 1
    s_cbranch_scc1 ABORT
    s_waitcnt vmcnt(0)
L_verchk_106:
    v_readlane_b32 s66, v3, 0
    v_readlane_b32 s67, v3, 4
    v_readlane_b32 s68, v3, 8
    v_readlane_b32 s69, v3, 12
    v_readlane_b32 s70, v3, 16
    v_readlane_b32 s71, v3, 20
    v_readlane_b32 s72, v3, 24
    v_readlane_b32 s73, v3, 28
    v_readlane_b32 s74, v3, 1
    s_add_u32 s75, s66, s67
    s_add_u32 s75, s75, s68
    s_add_u32 s75, s75, s69
    s_add_u32 s75, s75, s70
    s_add_u32 s75, s75, s71
    s_add_u32 s75, s75, s72
    s_add_u32 s75, s75, s73
    s_add_u32 s75, s75, s74
    s_cmp_ge_u32 s75, 267
    s_cbranch_scc1 L_ver_104_d
    s_sleep 16
    s_branch L_ver_104
L_ver_104_d:
    s_cmp_eq_u32 s93, 1
    s_cbranch_scc1 L_verok_105
    s_or_b32 s75, s66, s67
    s_or_b32 s75, s75, s68
    s_or_b32 s75, s75, s69
    s_or_b32 s75, s75, s70
    s_or_b32 s75, s75, s71
    s_or_b32 s75, s75, s72
    s_or_b32 s75, s75, s73
    s_cmp_lg_u32 s75, 32
    s_cbranch_scc1 REROLE
L_verok_105:
    s_mov_b32 s45, 131072
L_ls_107:
    s_sleep 32
    buffer_load_dword v3, off, s[4:7], 0 offset:0 sc1
    s_sub_u32 s45, s45, 1
    s_cbranch_scc1 ABORT
    s_waitcnt vmcnt(0)
    v_cmp_gt_u32 vcc, 3, v3
    s_cbranch_vccnz L_ls_107
    s_load_dwordx2 s[8:9], s[0:1], 64
    s_mov_b32 s10, 5308416
    s_mov_b32 s11, 0x20000
    s_waitcnt lgkmcnt(0)
    s_lshl_b32 s16, s12, 7
    v_lshrrev_b32 v2, 3, v1
    v_mul_u32_u24 v2, 9216, v2
    v_and_b32 v3, 7, v1
    v_lshl_add_u32 v2, v3, 4, v2
    s_mul_i32 s17, s13, 73728
    s_add_u32 s17, s17, s16
    s_lshl_b32 s18, s13, 10
    s_add_u32 m0, s18, 0
    s_nop 0
    buffer_load_dwordx4 v2, s[8:11], s17 offen lds
    s_add_u32 s17, s17, 294912
    s_add_u32 m0, m0, 4096
    s_nop 0
    buffer_load_dwordx4 v2, s[8:11], s17 offen lds
    s_add_u32 s17, s17, 294912
    s_add_u32 m0, m0, 4096
    s_nop 0
    buffer_load_dwordx4 v2, s[8:11], s17 offen lds
    s_add_u32 s17, s17, 294912
    s_add_u32 m0, m0, 4096
    s_nop 0
    buffer_load_dwordx4 v2, s[8:11], s17 offen lds
    s_add_u32 s17, s17, 294912
    s_add_u32 m0, m0, 4096
    s_nop 0
    buffer_load_dwordx4 v2, s[8:11], s17 offen lds
    s_add_u32 s17, s17, 294912
    s_add_u32 m0, m0, 4096
    s_nop 0
    buffer_load_dwordx4 v2, s[8:11], s17 offen lds
    s_add_u32 s17, s17, 294912
    s_add_u32 m0, m0, 4096
    s_nop 0
    buffer_load_dwordx4 v2, s[8:11], s17 offen lds
    s_add_u32 s17, s17, 294912
    s_add_u32 m0, m0, 4096
    s_nop 0
    buffer_load_dwordx4 v2, s[8:11], s17 offen lds
    s_add_u32 s17, s17, 294912
    s_add_u32 m0, m0, 4096
    s_nop 0
    buffer_load_dwordx4 v2, s[8:11], s17 offen lds
    s_add_u32 s17, s17, 294912
    s_add_u32 m0, m0, 4096
    s_nop 0
    buffer_load_dwordx4 v2, s[8:11], s17 offen lds
    s_add_u32 s17, s17, 294912
    s_add_u32 m0, m0, 4096
    s_nop 0
    buffer_load_dwordx4 v2, s[8:11], s17 offen lds
    s_add_u32 s17, s17, 294912
    s_add_u32 m0, m0, 4096
    s_nop 0
    buffer_load_dwordx4 v2, s[8:11], s17 offen lds
    s_add_u32 s17, s17, 294912
    s_add_u32 m0, m0, 4096
    s_nop 0
    buffer_load_dwordx4 v2, s[8:11], s17 offen lds
    s_add_u32 s17, s17, 294912
    s_add_u32 m0, m0, 4096
    s_nop 0
    buffer_load_dwordx4 v2, s[8:11], s17 offen lds
    s_add_u32 s17, s17, 294912
    s_add_u32 m0, m0, 4096
    s_nop 0
    buffer_load_dwordx4 v2, s[8:11], s17 offen lds
    s_add_u32 s17, s17, 294912
    s_add_u32 m0, m0, 4096
    s_nop 0
    buffer_load_dwordx4 v2, s[8:11], s17 offen lds
    s_add_u32 s17, s17, 294912
    s_add_u32 m0, m0, 4096
    s_nop 0
    buffer_load_dwordx4 v2, s[8:11], s17 offen lds
    s_add_u32 s17, s17, 294912
    s_add_u32 m0, m0, 4096
    s_nop 0
    buffer_load_dwordx4 v2, s[8:11], s17 offen lds
    s_waitcnt vmcnt(0)
    s_load_dwordx2 s[8:9], s[0:1], 72
    s_mov_b32 s10, 5308416
    s_mov_b32 s11, 0x20000
    s_waitcnt lgkmcnt(0)
    s_lshl_b32 s16, s12, 7
    v_lshrrev_b32 v2, 3, v1
    v_mul_u32_u24 v2, 9216, v2
    v_and_b32 v3, 7, v1
    v_lshl_add_u32 v2, v3, 4, v2
    s_mul_i32 s17, s13, 73728
    s_add_u32 s17, s17, s16
    s_lshl_b32 s18, s13, 10
    s_add_u32 m0, s18, 73728
    s_nop 0
    buffer_load_dwordx4 v2, s[8:11], s17 offen lds
    s_add_u32 s17, s17, 294912
    s_add_u32 m0, m0, 4096
    s_nop 0
    buffer_load_dwordx4 v2, s[8:11], s17 offen lds
    s_add_u32 s17, s17, 294912
    s_add_u32 m0, m0, 4096
    s_nop 0
    buffer_load_dwordx4 v2, s[8:11], s17 offen lds
    s_add_u32 s17, s17, 294912
    s_add_u32 m0, m0, 4096
    s_nop 0
    buffer_load_dwordx4 v2, s[8:11], s17 offen lds
    s_add_u32 s17, s17, 294912
    s_add_u32 m0, m0, 4096
    s_nop 0
    buffer_load_dwordx4 v2, s[8:11], s17 offen lds
    s_add_u32 s17, s17, 294912
    s_add_u32 m0, m0, 4096
    s_nop 0
    buffer_load_dwordx4 v2, s[8:11], s17 offen lds
    s_add_u32 s17, s17, 294912
    s_add_u32 m0, m0, 4096
    s_nop 0
    buffer_load_dwordx4 v2, s[8:11], s17 offen lds
    s_add_u32 s17, s17, 294912
    s_add_u32 m0, m0, 4096
    s_nop 0
    buffer_load_dwordx4 v2, s[8:11], s17 offen lds
    s_add_u32 s17, s17, 294912
    s_add_u32 m0, m0, 4096
    s_nop 0
    buffer_load_dwordx4 v2, s[8:11], s17 offen lds
    s_add_u32 s17, s17, 294912
    s_add_u32 m0, m0, 4096
    s_nop 0
    buffer_load_dwordx4 v2, s[8:11], s17 offen lds
    s_add_u32 s17, s17, 294912
    s_add_u32 m0, m0, 4096
    s_nop 0
    buffer_load_dwordx4 v2, s[8:11], s17 offen lds
    s_add_u32 s17, s17, 294912
    s_add_u32 m0, m0, 4096
    s_nop 0
    buffer_load_dwordx4 v2, s[8:11], s17 offen lds
    s_add_u32 s17, s17, 294912
    s_add_u32 m0, m0, 4096
    s_nop 0
    buffer_load_dwordx4 v2, s[8:11], s17 offen lds
    s_add_u32 s17, s17, 294912
    s_add_u32 m0, m0, 4096
    s_nop 0
    buffer_load_dwordx4 v2, s[8:11], s17 offen lds
    s_add_u32 s17, s17, 294912
    s_add_u32 m0, m0, 4096
    s_nop 0
    buffer_load_dwordx4 v2, s[8:11], s17 offen lds
    s_add_u32 s17, s17, 294912
    s_add_u32 m0, m0, 4096
    s_nop 0
    buffer_load_dwordx4 v2, s[8:11], s17 offen lds
    s_add_u32 s17, s17, 294912
    s_add_u32 m0, m0, 4096
    s_nop 0
    buffer_load_dwordx4 v2, s[8:11], s17 offen lds
    s_add_u32 s17, s17, 294912
    s_add_u32 m0, m0, 4096
    s_nop 0
    buffer_load_dwordx4 v2, s[8:11], s17 offen lds
    v_lshrrev_b32 v4, 5, v1
    v_bfe_u32 v2, v1, 2, 2
    v_lshl_add_u32 v4, v4, 3, v2
    v_mul_u32_u24 v4, 128, v4
    v_bfe_u32 v2, v1, 4, 1
    v_mul_u32_u24 v2, 73728, v2
    v_add_u32 v4, v4, v2
    v_and_b32 v2, 1, v1
    v_lshl_add_u32 v4, v2, 4, v4
    v_bfe_u32 v2, v1, 1, 1
    v_lshl_add_u32 v4, v2, 3, v4
    s_lshl_b32 s16, s13, 5
    v_add_u32 v4, s16, v4
    s_waitcnt vmcnt(0)
    s_barrier
    ds_read_b64_tr_b16 a[0:1], v4 offset:0
    ds_read_b64_tr_b16 a[2:3], v4 offset:512
    ds_read_b64_tr_b16 a[4:5], v4 offset:2048
    ds_read_b64_tr_b16 a[6:7], v4 offset:2560
    ds_read_b64_tr_b16 a[8:9], v4 offset:4096
    ds_read_b64_tr_b16 a[10:11], v4 offset:4608
    ds_read_b64_tr_b16 a[12:13], v4 offset:6144
    ds_read_b64_tr_b16 a[14:15], v4 offset:6656
    ds_read_b64_tr_b16 a[16:17], v4 offset:8192
    ds_read_b64_tr_b16 a[18:19], v4 offset:8704
    ds_read_b64_tr_b16 a[20:21], v4 offset:10240
    ds_read_b64_tr_b16 a[22:23], v4 offset:10752
    ds_read_b64_tr_b16 a[24:25], v4 offset:12288
    ds_read_b64_tr_b16 a[26:27], v4 offset:12800
    ds_read_b64_tr_b16 a[28:29], v4 offset:14336
    ds_read_b64_tr_b16 a[30:31], v4 offset:14848
    ds_read_b64_tr_b16 a[32:33], v4 offset:16384
    ds_read_b64_tr_b16 a[34:35], v4 offset:16896
    ds_read_b64_tr_b16 a[36:37], v4 offset:18432
    ds_read_b64_tr_b16 a[38:39], v4 offset:18944
    ds_read_b64_tr_b16 a[40:41], v4 offset:20480
    ds_read_b64_tr_b16 a[42:43], v4 offset:20992
    ds_read_b64_tr_b16 a[44:45], v4 offset:22528
    ds_read_b64_tr_b16 a[46:47], v4 offset:23040
    ds_read_b64_tr_b16 a[48:49], v4 offset:24576
    ds_read_b64_tr_b16 a[50:51], v4 offset:25088
    ds_read_b64_tr_b16 a[52:53], v4 offset:26624
    ds_read_b64_tr_b16 a[54:55], v4 offset:27136
    ds_read_b64_tr_b16 a[56:57], v4 offset:28672
    ds_read_b64_tr_b16 a[58:59], v4 offset:29184
    ds_read_b64_tr_b16 a[60:61], v4 offset:30720
    ds_read_b64_tr_b16 a[62:63], v4 offset:31232
    ds_read_b64_tr_b16 a[64:65], v4 offset:32768
    ds_read_b64_tr_b16 a[66:67], v4 offset:33280
    ds_read_b64_tr_b16 a[68:69], v4 offset:34816
    ds_read_b64_tr_b16 a[70:71], v4 offset:35328
    ds_read_b64_tr_b16 a[72:73], v4 offset:36864
    ds_read_b64_tr_b16 a[74:75], v4 offset:37376
    ds_read_b64_tr_b16 a[76:77], v4 offset:38912
    ds_read_b64_tr_b16 a[78:79], v4 offset:39424
    ds_read_b64_tr_b16 a[80:81], v4 offset:40960
    ds_read_b64_tr_b16 a[82:83], v4 offset:41472
    ds_read_b64_tr_b16 a[84:85], v4 offset:43008
    ds_read_b64_tr_b16 a[86:87], v4 offset:43520
    ds_read_b64_tr_b16 a[88:89], v4 offset:45056
    ds_read_b64_tr_b16 a[90:91], v4 offset:45568
    ds_read_b64_tr_b16 a[92:93], v4 offset:47104
    ds_read_b64_tr_b16 a[94:95], v4 offset:47616
    ds_read_b64_tr_b16 a[96:97], v4 offset:49152
    ds_read_b64_tr_b16 a[98:99], v4 offset:49664
    ds_read_b64_tr_b16 a[100:101], v4 offset:51200
    ds_read_b64_tr_b16 a[102:103], v4 offset:51712
    ds_read_b64_tr_b16 a[104:105], v4 offset:53248
    ds_read_b64_tr_b16 a[106:107], v4 offset:53760
    ds_read_b64_tr_b16 a[108:109], v4 offset:55296
    ds_read_b64_tr_b16 a[110:111], v4 offset:55808
    ds_read_b64_tr_b16 a[112:113], v4 offset:57344
    ds_read_b64_tr_b16 a[114:115], v4 offset:57856
    ds_read_b64_tr_b16 a[116:117], v4 offset:59392
    ds_read_b64_tr_b16 a[118:119], v4 offset:59904
    ds_read_b64_tr_b16 a[120:121], v4 offset:61440
    ds_read_b64_tr_b16 a[122:123], v4 offset:61952
    ds_read_b64_tr_b16 a[124:125], v4 offset:63488
    ds_read_b64_tr_b16 a[126:127], v4 offset:64000
    v_add_u32 v4, 65536, v4
    ds_read_b64_tr_b16 a[128:129], v4 offset:0
    ds_read_b64_tr_b16 a[130:131], v4 offset:512
    ds_read_b64_tr_b16 a[132:133], v4 offset:2048
    ds_read_b64_tr_b16 a[134:135], v4 offset:2560
    ds_read_b64_tr_b16 a[136:137], v4 offset:4096
    ds_read_b64_tr_b16 a[138:139], v4 offset:4608
    ds_read_b64_tr_b16 a[140:141], v4 offset:6144
    ds_read_b64_tr_b16 a[142:143], v4 offset:6656
    v_lshrrev_b32 v2, 3, v1
    s_lshl_b32 s16, s13, 3
    v_add_u32 v2, s16, v2
    v_mul_u32_u24 v4, 1152, v2
    v_bfe_u32 v2, v2, 1, 3
    v_and_b32 v3, 7, v1
    v_xor_b32 v2, v2, v3
    v_lshl_add_u32 v4, v2, 4, v4
    v_bfe_u32 v2, v1, 3, 2
    v_mul_u32_u24 v5, 9216, v2
    v_lshl_add_u32 v5, v3, 7, v5
    v_bfe_u32 v2, v1, 1, 3
    v_lshrrev_b32 v3, 5, v1
    v_xor_b32 v2, v2, v3
    v_lshl_add_u32 v5, v2, 4, v5
    v_xor_b32 v6, 32, v5
    v_xor_b32 v7, 64, v5
    v_xor_b32 v8, 96, v5
    v_lshlrev_b32 v9, 4, v1
    v_and_b32 v10, 7, v1
    v_lshlrev_b32 v10, 7, v10
    s_lshl_b32 s16, s13, 10
    s_add_u32 s16, s16, 16896
    v_add_u32 v10, s16, v10
    s_mov_b32 s20, 7340032
    s_mov_b32 s21, 0
    s_lshl_b32 s16, s12, 2
    s_add_u32 s16, s16, s13
    s_lshl_b32 s22, s16, 10
    s_add_u32 s22, s22, 83886080
    s_lshl_b32 s24, s16, 7
    s_add_u32 s24, s24, 25600
    s_mov_b32 s26, 0xc0135761
    s_mov_b32 s28, 0xbdd2d3e8
    s_mov_b32 s29, 0
    v_mov_b32 v64, s26
    s_mov_b32 s14, 0
    s_mov_b32 s23, 1
    s_waitcnt lgkmcnt(0)
    v_mbcnt_lo_u32_b32 v2, -1, 0
    v_mbcnt_hi_u32_b32 v2, -1, v2
    v_and_b32 v2, 31, v2
    v_lshlrev_b32 v2, 2, v2
    s_mov_b32 s45, 131072
L_ver_108:
    buffer_load_dword v3, v2, s[84:87], 0 offen sc1
    s_sub_u32 s45, s45, 1
    s_cbranch_scc1 ABORT
    s_waitcnt vmcnt(0)
L_verchk_110:
    v_readlane_b32 s66, v3, 0
    v_readlane_b32 s67, v3, 4
    v_readlane_b32 s68, v3, 8
    v_readlane_b32 s69, v3, 12
    v_readlane_b32 s70, v3, 16
    v_readlane_b32 s71, v3, 20
    v_readlane_b32 s72, v3, 24
    v_readlane_b32 s73, v3, 28
    v_readlane_b32 s74, v3, 1
    s_add_u32 s75, s66, s67
    s_add_u32 s75, s75, s68
    s_add_u32 s75, s75, s69
    s_add_u32 s75, s75, s70
    s_add_u32 s75, s75, s71
    s_add_u32 s75, s75, s72
    s_add_u32 s75, s75, s73
    s_add_u32 s75, s75, s74
    s_cmp_ge_u32 s75, 267
    s_cbranch_scc1 L_ver_108_d
    s_sleep 16
    s_branch L_ver_108
L_ver_108_d:
    s_cmp_eq_u32 s93, 1
    s_cbranch_scc1 L_verok_109
    s_or_b32 s75, s66, s67
    s_or_b32 s75, s75, s68
    s_or_b32 s75, s75, s69
    s_or_b32 s75, s75, s70
    s_or_b32 s75, s75, s71
    s_or_b32 s75, s75, s72
    s_or_b32 s75, s75, s73
    s_cmp_lg_u32 s75, 32
    s_cbranch_scc1 REROLE
L_verok_109:
    s_barrier
    s_mov_b32 s45, 131072
L_wf_111:
    buffer_load_dword v11, v10, s[4:7], 0 offen sc1
    s_sub_u32 s45, s45, 1
    s_cbranch_scc1 ABORT
    s_waitcnt vmcnt(0)
    v_cmp_gt_u32 vcc, s23, v11
    s_cbranch_vccnz L_wf_111
L_wfok_112:
    s_mov_b32 s25, 0
    v_mov_b32 v12, 0
L_gulate_113:
    s_mul_i32 s16, s13, 9216
    s_add_u32 m0, s16, s21
    s_nop 0
    buffer_load_dwordx4 v4, s[4:7], s20 offen offset:0 sc1 lds
    s_add_u32 m0, m0, 896
    s_nop 0
    buffer_load_dwordx4 v4, s[4:7], s20 offen offset:128 sc1 lds
    s_add_u32 m0, m0, 896
    s_nop 0
    buffer_load_dwordx4 v4, s[4:7], s20 offen offset:256 sc1 lds
    s_add_u32 m0, m0, 896
    s_nop 0
    buffer_load_dwordx4 v4, s[4:7], s20 offen offset:384 sc1 lds
    s_add_u32 m0, m0, 896
    s_nop 0
    buffer_load_dwordx4 v4, s[4:7], s20 offen offset:512 sc1 lds
    s_add_u32 m0, m0, 896
    s_nop 0
    buffer_load_dwordx4 v4, s[4:7], s20 offen offset:640 sc1 lds
    s_add_u32 m0, m0, 896
    s_nop 0
    buffer_load_dwordx4 v4, s[4:7], s20 offen offset:768 sc1 lds
    s_add_u32 m0, m0, 896
    s_nop 0
    buffer_load_dwordx4 v4, s[4:7], s20 offen offset:896 sc1 lds
    s_add_u32 m0, m0, 896
    s_nop 0
    buffer_load_dwordx4 v4, s[4:7], s20 offen offset:1024 sc1 lds
L_guearly_114:
    s_waitcnt vmcnt(6)
    s_barrier
    ds_read_b128 v[16:19], v5 offset:0
    ds_read_b128 v[20:23], v6 offset:0
    ds_read_b128 v[24:27], v7 offset:0
    ds_read_b128 v[28:31], v8 offset:0
    s_waitcnt lgkmcnt(3)
    v_mfma_f32_32x32x16_bf16 v[32:47], a[0:3], v[16:19], 0
    ds_read_b128 v[16:19], v5 offset:1024
    s_waitcnt lgkmcnt(3)
    v_mfma_f32_32x32x16_bf16 v[32:47], a[4:7], v[20:23], v[32:47]
    ds_read_b128 v[20:23], v6 offset:1024
    s_waitcnt lgkmcnt(3)
    v_mfma_f32_32x32x16_bf16 v[32:47], a[8:11], v[24:27], v[32:47]
    ds_read_b128 v[24:27], v7 offset:1024
    s_waitcnt lgkmcnt(3)
    v_mfma_f32_32x32x16_bf16 v[32:47], a[12:15], v[28:31], v[32:47]
    ds_read_b128 v[28:31], v8 offset:1024
    s_waitcnt lgkmcnt(3)
    v_mfma_f32_32x32x16_bf16 v[32:47], a[16:19], v[16:19], v[32:47]
    ds_read_b128 v[16:19], v5 offset:2048
    s_waitcnt lgkmcnt(3)
    v_mfma_f32_32x32x16_bf16 v[32:47], a[20:23], v[20:23], v[32:47]
    ds_read_b128 v[20:23], v6 offset:2048
    s_waitcnt lgkmcnt(3)
    v_mfma_f32_32x32x16_bf16 v[32:47], a[24:27], v[24:27], v[32:47]
    ds_read_b128 v[24:27], v7 offset:2048
    s_waitcnt lgkmcnt(3)
    v_mfma_f32_32x32x16_bf16 v[32:47], a[28:31], v[28:31], v[32:47]
    ds_read_b128 v[28:31], v8 offset:2048
    s_waitcnt lgkmcnt(3)
    v_mfma_f32_32x32x16_bf16 v[32:47], a[32:35], v[16:19], v[32:47]
    s_waitcnt vmcnt(3)
    s_barrier
    ds_read_b128 v[16:19], v5 offset:3072
    s_waitcnt lgkmcnt(3)
    v_mfma_f32_32x32x16_bf16 v[32:47], a[36:39], v[20:23], v[32:47]
    ds_read_b128 v[20:23], v6 offset:3072
    s_waitcnt lgkmcnt(3)
    v_mfma_f32_32x32x16_bf16 v[32:47], a[40:43], v[24:27], v[32:47]
    ds_read_b128 v[24:27], v7 offset:3072
    s_waitcnt lgkmcnt(3)
    v_mfma_f32_32x32x16_bf16 v[32:47], a[44:47], v[28:31], v[32:47]
    ds_read_b128 v[28:31], v8 offset:3072
    s_waitcnt lgkmcnt(3)
    v_mfma_f32_32x32x16_bf16 v[32:47], a[48:51], v[16:19], v[32:47]
    ds_read_b128 v[16:19], v5 offset:4096
    s_waitcnt lgkmcnt(3)
    v_mfma_f32_32x32x16_bf16 v[32:47], a[52:55], v[20:23], v[32:47]
    ds_read_b128 v[20:23], v6 offset:4096
    s_waitcnt lgkmcnt(3)
    v_mfma_f32_32x32x16_bf16 v[32:47], a[56:59], v[24:27], v[32:47]
    ds_read_b128 v[24:27], v7 offset:4096
    s_waitcnt lgkmcnt(3)
    v_mfma_f32_32x32x16_bf16 v[32:47], a[60:63], v[28:31], v[32:47]
    ds_read_b128 v[28:31], v8 offset:4096
    s_waitcnt lgkmcnt(3)
    v_mfma_f32_32x32x16_bf16 v[32:47], a[64:67], v[16:19], v[32:47]
    ds_read_b128 v[16:19], v5 offset:5120
    s_waitcnt lgkmcnt(3)
    v_mfma_f32_32x32x16_bf16 v[32:47], a[68:71], v[20:23], v[32:47]
    ds_read_b128 v[20:23], v6 offset:5120
    s_waitcnt lgkmcnt(3)
    v_mfma_f32_32x32x16_bf16 v[32:47], a[72:75], v[24:27], v[32:47]
    ds_read_b128 v[24:27], v7 offset:5120
    s_waitcnt lgkmcnt(3)
    v_mfma_f32_32x32x16_bf16 v[32:47], a[76:79], v[28:31], v[32:47]
    ds_read_b128 v[28:31], v8 offset:5120
    s_waitcnt lgkmcnt(3)
    v_mfma_f32_32x32x16_bf16 v[32:47], a[80:83], v[16:19], v[32:47]
    s_waitcnt vmcnt(0)
    s_barrier
    ds_read_b128 v[16:19], v5 offset:6144
    s_waitcnt lgkmcnt(3)
    v_mfma_f32_32x32x16_bf16 v[32:47], a[84:87], v[20:23], v[32:47]
    buffer_load_dword v12, v10, s[4:7], 0 offen sc1
    s_cmp_eq_u32 s25, 0
    s_cbranch_scc1 L_gupd_115
    v_mov_b32 v2, s14
    s_mov_b64 exec, 1
    buffer_store_dword v2, off, s[4:7], s24 offset:0 sc1
    s_mov_b64 exec, -1
L_gupd_115:
    ds_read_b128 v[20:23], v6 offset:6144
    s_waitcnt lgkmcnt(3)
    v_mfma_f32_32x32x16_bf16 v[32:47], a[88:91], v[24:27], v[32:47]
    ds_read_b128 v[24:27], v7 offset:6144
    s_waitcnt lgkmcnt(3)
    v_mfma_f32_32x32x16_bf16 v[32:47], a[92:95], v[28:31], v[32:47]
    ds_read_b128 v[28:31], v8 offset:6144
    s_waitcnt lgkmcnt(3)
    v_mfma_f32_32x32x16_bf16 v[32:47], a[96:99], v[16:19], v[32:47]
    ds_read_b128 v[16:19], v5 offset:7168
    s_waitcnt lgkmcnt(3)
    v_mfma_f32_32x32x16_bf16 v[32:47], a[100:103], v[20:23], v[32:47]
    ds_read_b128 v[20:23], v6 offset:7168
    s_waitcnt lgkmcnt(3)
    v_mfma_f32_32x32x16_bf16 v[32:47], a[104:107], v[24:27], v[32:47]
    ds_read_b128 v[24:27], v7 offset:7168
    s_waitcnt lgkmcnt(3)
    v_mfma_f32_32x32x16_bf16 v[32:47], a[108:111], v[28:31], v[32:47]
    ds_read_b128 v[28:31], v8 offset:7168
    s_waitcnt lgkmcnt(3)
    v_mfma_f32_32x32x16_bf16 v[32:47], a[112:115], v[16:19], v[32:47]
    ds_read_b128 v[16:19], v5 offset:8192
    s_waitcnt lgkmcnt(3)
    v_mfma_f32_32x32x16_bf16 v[32:47], a[116:119], v[20:23], v[32:47]
    ds_read_b128 v[20:23], v6 offset:8192
    s_waitcnt lgkmcnt(3)
    v_mfma_f32_32x32x16_bf16 v[32:47], a[120:123], v[24:27], v[32:47]
    ds_read_b128 v[24:27], v7 offset:8192
    s_waitcnt lgkmcnt(3)
    v_mfma_f32_32x32x16_bf16 v[32:47], a[124:127], v[28:31], v[32:47]
    ds_read_b128 v[28:31], v8 offset:8192
    s_waitcnt lgkmcnt(3)
    v_mfma_f32_32x32x16_bf16 v[32:47], a[128:131], v[16:19], v[32:47]
    s_waitcnt lgkmcnt(2)
    v_mfma_f32_32x32x16_bf16 v[32:47], a[132:135], v[20:23], v[32:47]
    s_waitcnt lgkmcnt(1)
    v_mfma_f32_32x32x16_bf16 v[32:47], a[136:139], v[24:27], v[32:47]
    s_waitcnt lgkmcnt(0)
    v_mfma_f32_32x32x16_bf16 v[32:47], a[140:143], v[28:31], v[32:47]
    s_xor_b32 s21, s21, 36864
    s_lshl_b32 s16, s21, 1
    s_sub_u32 s16, s16, 36864
    s_add_u32 s20, s20, 36864
    s_add_u32 s14, s14, 1
    s_add_u32 s23, s14, 1
    v_add_u32 v5, s16, v5
    v_add_u32 v6, s16, v6
    v_add_u32 v7, s16, v7
    v_add_u32 v8, s16, v8
    s_mov_b32 s25, 0
    v_cmp_gt_u32 vcc, s23, v12
    s_cbranch_vccnz L_gune0_117
    s_mov_b32 s25, 1
    s_mul_i32 s16, s13, 9216
    s_add_u32 m0, s16, s21
    s_nop 0
    buffer_load_dwordx4 v4, s[4:7], s20 offen offset:0 sc1 lds
    s_add_u32 m0, m0, 896
    s_nop 0
    buffer_load_dwordx4 v4, s[4:7], s20 offen offset:128 sc1 lds
    s_add_u32 m0, m0, 896
    s_nop 0
    buffer_load_dwordx4 v4, s[4:7], s20 offen offset:256 sc1 lds
    s_add_u32 m0, m0, 896
    s_nop 0
    buffer_load_dwordx4 v4, s[4:7], s20 offen offset:384 sc1 lds
    s_add_u32 m0, m0, 896
    s_nop 0
    buffer_load_dwordx4 v4, s[4:7], s20 offen offset:512 sc1 lds
    s_add_u32 m0, m0, 896
    s_nop 0
    buffer_load_dwordx4 v4, s[4:7], s20 offen offset:640 sc1 lds
    s_add_u32 m0, m0, 896
    s_nop 0
    buffer_load_dwordx4 v4, s[4:7], s20 offen offset:768 sc1 lds
    s_add_u32 m0, m0, 896
    s_nop 0
    buffer_load_dwordx4 v4, s[4:7], s20 offen offset:896 sc1 lds
    s_add_u32 m0, m0, 896
    s_nop 0
    buffer_load_dwordx4 v4, s[4:7], s20 offen offset:1024 sc1 lds
L_gune0_117:
    buffer_load_dword v12, v10, s[4:7], 0 offen sc1
    v_mov_b32 v13, v13
    s_nop 2
    v_mov_b32 v13, v13
    s_nop 2
    v_pk_mul_f32 v[48:49], v[32:33], v[32:33]
    v_pk_mul_f32 v[50:51], v[34:35], v[34:35]
    v_pk_mul_f32 v[52:53], v[36:37], v[36:37]
    v_pk_mul_f32 v[54:55], v[38:39], v[38:39]
    v_pk_fma_f32 v[48:49], v[48:49], s[28:29], v[64:65] op_sel_hi:[1,0,0]
    v_pk_fma_f32 v[50:51], v[50:51], s[28:29], v[64:65] op_sel_hi:[1,0,0]
    v_pk_fma_f32 v[52:53], v[52:53], s[28:29], v[64:65] op_sel_hi:[1,0,0]
    v_pk_fma_f32 v[54:55], v[54:55], s[28:29], v[64:65] op_sel_hi:[1,0,0]
    v_pk_mul_f32 v[48:49], v[48:49], v[32:33]
    v_pk_mul_f32 v[50:51], v[50:51], v[34:35]
    v_pk_mul_f32 v[52:53], v[52:53], v[36:37]
    v_pk_mul_f32 v[54:55], v[54:55], v[38:39]
    v_exp_f32 v48, v48
    v_exp_f32 v49, v49
    v_exp_f32 v50, v50
    v_exp_f32 v51, v51
    v_exp_f32 v52, v52
    v_exp_f32 v53, v53
    v_exp_f32 v54, v54
    v_exp_f32 v55, v55
    v_pk_mul_f32 v[32:33], v[32:33], v[40:41]
    v_pk_mul_f32 v[34:35], v[34:35], v[42:43]
    v_pk_mul_f32 v[36:37], v[36:37], v[44:45]
    v_pk_mul_f32 v[38:39], v[38:39], v[46:47]
    v_pk_add_f32 v[48:49], v[48:49], 1.0 op_sel_hi:[1,0]
    v_pk_add_f32 v[50:51], v[50:51], 1.0 op_sel_hi:[1,0]
    v_pk_add_f32 v[52:53], v[52:53], 1.0 op_sel_hi:[1,0]
    v_pk_add_f32 v[54:55], v[54:55], 1.0 op_sel_hi:[1,0]
    v_rcp_f32 v48, v48
    v_rcp_f32 v49, v49
    v_rcp_f32 v50, v50
    v_rcp_f32 v51, v51
    v_rcp_f32 v52, v52
    v_rcp_f32 v53, v53
    v_rcp_f32 v54, v54
    v_rcp_f32 v55, v55
    v_pk_mul_f32 v[32:33], v[32:33], v[48:49]
    v_pk_mul_f32 v[34:35], v[34:35], v[50:51]
    v_pk_mul_f32 v[36:37], v[36:37], v[52:53]
    v_pk_mul_f32 v[38:39], v[38:39], v[54:55]
    v_cvt_pk_bf16_f32 v56, v32, v33
    v_cvt_pk_bf16_f32 v57, v34, v35
    v_cvt_pk_bf16_f32 v58, v36, v37
    v_cvt_pk_bf16_f32 v59, v38, v39
    buffer_store_dwordx4 v[56:59], v9, s[4:7], s22 offen sc1
    s_add_u32 s22, s22, 294912
    s_cmp_eq_u32 s25, 0
    s_cbranch_scc1 L_gune_116
    s_waitcnt vmcnt(2)
    s_branch L_guearly_114
L_gune_116:
    s_waitcnt vmcnt(1)
    v_cmp_gt_u32 vcc, s23, v12
    s_cbranch_vccnz L_gune2_118
    s_mul_i32 s16, s13, 9216
    s_add_u32 m0, s16, s21
    s_nop 0
    buffer_load_dwordx4 v4, s[4:7], s20 offen offset:0 sc1 lds
    s_add_u32 m0, m0, 896
    s_nop 0
    buffer_load_dwordx4 v4, s[4:7], s20 offen offset:128 sc1 lds
    s_add_u32 m0, m0, 896
    s_nop 0
    buffer_load_dwordx4 v4, s[4:7], s20 offen offset:256 sc1 lds
    s_add_u32 m0, m0, 896
    s_nop 0
    buffer_load_dwordx4 v4, s[4:7], s20 offen offset:384 sc1 lds
    s_add_u32 m0, m0, 896
    s_nop 0
    buffer_load_dwordx4 v4, s[4:7], s20 offen offset:512 sc1 lds
    s_add_u32 m0, m0, 896
    s_nop 0
    buffer_load_dwordx4 v4, s[4:7], s20 offen offset:640 sc1 lds
    s_add_u32 m0, m0, 896
    s_nop 0
    buffer_load_dwordx4 v4, s[4:7], s20 offen offset:768 sc1 lds
    s_add_u32 m0, m0, 896
    s_nop 0
    buffer_load_dwordx4 v4, s[4:7], s20 offen offset:896 sc1 lds
    s_add_u32 m0, m0, 896
    s_nop 0
    buffer_load_dwordx4 v4, s[4:7], s20 offen offset:1024 sc1 lds
    s_waitcnt vmcnt(9)
    v_mov_b32 v2, s14
    s_mov_b64 exec, 1
    buffer_store_dword v2, off, s[4:7], s24 offset:0 sc1
    s_mov_b64 exec, -1
    s_waitcnt vmcnt(1)
    s_branch L_guearly_114
L_gune2_118:
    s_min_u32 s23, s23, 64
    s_mov_b32 s45, 131072
    buffer_load_dword v11, v10, s[4:7], 0 offen sc1
    s_waitcnt vmcnt(0)
    v_mov_b32 v2, s14
    s_mov_b64 exec, 1
    buffer_store_dword v2, off, s[4:7], s24 offset:0 sc1
    s_mov_b64 exec, -1
    v_cmp_gt_u32 vcc, s23, v11
    s_cbranch_vccz L_wfok_120
L_wf_119:
    buffer_load_dword v11, v10, s[4:7], 0 offen sc1
    s_sub_u32 s45, s45, 1
    s_cbranch_scc1 ABORT
    s_waitcnt vmcnt(0)
    v_cmp_gt_u32 vcc, s23, v11
    s_cbranch_vccnz L_wf_119
L_wfok_120:
    s_cmp_lt_u32 s14, 64
    s_cbranch_scc1 L_gulate_113
    s_endpgm
ROLE_LN:
    v_mbcnt_lo_u32_b32 v1, -1, 0
    v_mbcnt_hi_u32_b32 v1, -1, v1
    v_mbcnt_lo_u32_b32 v2, -1, 0
    v_mbcnt_hi_u32_b32 v2, -1, v2
    v_and_b32 v2, 31, v2
    v_lshlrev_b32 v2, 2, v2
    s_mov_b32 s45, 131072
L_ver_121:
    s_sleep 64
    buffer_load_dword v3, v2, s[84:87], 0 offen sc1
    s_sub_u32 s45, s45, 1
    s_cbranch_scc1 ABORT
    s_waitcnt vmcnt(0)
L_verchk_123:
    v_readlane_b32 s66, v3, 0
    v_readlane_b32 s67, v3, 4
    v_readlane_b32 s68, v3, 8
    v_readlane_b32 s69, v3, 12
    v_readlane_b32 s70, v3, 16
    v_readlane_b32 s71, v3, 20
    v_readlane_b32 s72, v3, 24
    v_readlane_b32 s73, v3, 28
    v_readlane_b32 s74, v3, 1
    s_add_u32 s75, s66, s67
    s_add_u32 s75, s75, s68
    s_add_u32 s75, s75, s69
    s_add_u32 s75, s75, s70
    s_add_u32 s75, s75, s71
    s_add_u32 s75, s75, s72
    s_add_u32 s75, s75, s73
    s_add_u32 s75, s75, s74
    s_cmp_ge_u32 s75, 267
    s_cbranch_scc1 L_ver_121_d
    s_sleep 16
    s_branch L_ver_121
L_ver_121_d:
    s_cmp_eq_u32 s93, 1
    s_cbranch_scc1 L_verok_122
    s_or_b32 s75, s66, s67
    s_or_b32 s75, s75, s68
    s_or_b32 s75, s75, s69
    s_or_b32 s75, s75, s70
    s_or_b32 s75, s75, s71
    s_or_b32 s75, s75, s72
    s_or_b32 s75, s75, s73
    s_cmp_lg_u32 s75, 32
    s_cbranch_scc1 REROLE
L_verok_122:
    s_load_dwordx2 s[8:9], s[0:1], 0
    s_mov_b32 s10, 2359296
    s_mov_b32 s11, 0x20000
    s_waitcnt lgkmcnt(0)
    v_mov_b32 v7, 0x40000000
    v_lshlrev_b32 v4, 3, v1
    v_cmp_gt_u32 vcc, 48, v1
    s_nop 1
    v_cndmask_b32 v4, v7, v4, vcc
    v_lshlrev_b32 v5, 4, v1
    v_cndmask_b32 v5, v7, v5, vcc
    v_cndmask_b32 v8, 0, 1.0, vcc
    v_mul_f32 v8, 0xbae38e39, v8
    v_min_u32 v6, 35, v1
    v_lshlrev_b32 v6, 7, v6
    v_add_u32 v6, 12288, v6
    s_lshl_b32 s16, s12, 2
    s_add_u32 s16, s16, s13
    s_lshl_b32 s23, s16, 7
    s_add_u32 s23, s23, 16896
    s_mul_i32 s20, s16, 1152
    s_mul_i32 s21, s16, 2304
    s_add_u32 s21, s21, 104857600
    s_mov_b32 s14, 0
    s_mov_b32 s22, 1
    buffer_load_dwordx2 v[10:11], v4, s[8:11], s20 offen offset:0
    buffer_load_dwordx2 v[12:13], v4, s[8:11], s20 offen offset:384
    buffer_load_dwordx2 v[14:15], v4, s[8:11], s20 offen offset:768
    s_mov_b32 s45, 131072
L_wf_124:
    buffer_load_dword v7, v6, s[4:7], 0 offen sc1
    s_sub_u32 s45, s45, 1
    s_cbranch_scc1 ABORT
    s_waitcnt vmcnt(0)
    v_cmp_gt_u32 vcc, s22, v7
    s_cbranch_vccnz L_wf_124
L_wfok_125:
L_LNloop_126:
    s_add_u32 s24, s20, 4718592
    buffer_load_dwordx4 v[20:23], v5, s[4:7], s21 offen offset:0 sc1
    buffer_load_dwordx4 v[24:27], v5, s[4:7], s21 offen offset:768 sc1
    buffer_load_dwordx4 v[28:31], v5, s[4:7], s21 offen offset:1536 sc1
    s_add_u32 s21, s21, 73728
    buffer_load_dwordx4 v[40:43], v5, s[4:7], s21 offen offset:0 sc1
    buffer_load_dwordx4 v[44:47], v5, s[4:7], s21 offen offset:768 sc1
    buffer_load_dwordx4 v[48:51], v5, s[4:7], s21 offen offset:1536 sc1
    s_add_u32 s21, s21, 73728
    buffer_load_dwordx4 v[52:55], v5, s[4:7], s21 offen offset:0 sc1
    buffer_load_dwordx4 v[56:59], v5, s[4:7], s21 offen offset:768 sc1
    buffer_load_dwordx4 v[60:63], v5, s[4:7], s21 offen offset:1536 sc1
    s_add_u32 s21, s21, 73728
    buffer_load_dwordx4 v[64:67], v5, s[4:7], s21 offen offset:0 sc1
    buffer_load_dwordx4 v[68:71], v5, s[4:7], s21 offen offset:768 sc1
    buffer_load_dwordx4 v[72:75], v5, s[4:7], s21 offen offset:1536 sc1
    s_add_u32 s21, s21, 73728
    s_waitcnt vmcnt(12)
    v_lshlrev_b32 v80, 16, v10
    v_and_b32 v81, 0xffff0000, v10
    v_lshlrev_b32 v82, 16, v11
    v_and_b32 v83, 0xffff0000, v11
    v_lshlrev_b32 v84, 16, v12
    v_and_b32 v85, 0xffff0000, v12
    v_lshlrev_b32 v86, 16, v13
    v_and_b32 v87, 0xffff0000, v13
    v_lshlrev_b32 v88, 16, v14
    v_and_b32 v89, 0xffff0000, v14
    v_lshlrev_b32 v90, 16, v15
    v_and_b32 v91, 0xffff0000, v15
    s_waitcnt vmcnt(9)
    v_pk_add_f32 v[20:21], v[20:21], v[80:81]
    v_pk_add_f32 v[22:23], v[22:23], v[82:83]
    v_pk_add_f32 v[24:25], v[24:25], v[84:85]
    v_pk_add_f32 v[26:27], v[26:27], v[86:87]
    v_pk_add_f32 v[28:29], v[28:29], v[88:89]
    v_pk_add_f32 v[30:31], v[30:31], v[90:91]
    s_waitcnt vmcnt(6)
    v_pk_add_f32 v[20:21], v[20:21], v[40:41]
    v_pk_add_f32 v[22:23], v[22:23], v[42:43]
    v_pk_add_f32 v[24:25], v[24:25], v[44:45]
    v_pk_add_f32 v[26:27], v[26:27], v[46:47]
    v_pk_add_f32 v[28:29], v[28:29], v[48:49]
    v_pk_add_f32 v[30:31], v[30:31], v[50:51]
    s_waitcnt vmcnt(3)
    v_pk_add_f32 v[20:21], v[20:21], v[52:53]
    v_pk_add_f32 v[22:23], v[22:23], v[54:55]
    v_pk_add_f32 v[24:25], v[24:25], v[56:57]
    v_pk_add_f32 v[26:27], v[26:27], v[58:59]
    v_pk_add_f32 v[28:29], v[28:29], v[60:61]
    v_pk_add_f32 v[30:31], v[30:31], v[62:63]
    s_waitcnt vmcnt(0)
    v_pk_add_f32 v[20:21], v[20:21], v[64:65]
    v_pk_add_f32 v[22:23], v[22:23], v[66:67]
    v_pk_add_f32 v[24:25], v[24:25], v[68:69]
    v_pk_add_f32 v[26:27], v[26:27], v[70:71]
    v_pk_add_f32 v[28:29], v[28:29], v[72:73]
    v_pk_add_f32 v[30:31], v[30:31], v[74:75]
    v_cvt_pk_bf16_f32 v80, v20, v21
    v_cvt_pk_bf16_f32 v81, v22, v23
    v_cvt_pk_bf16_f32 v82, v24, v25
    v_cvt_pk_bf16_f32 v83, v26, v27
    v_cvt_pk_bf16_f32 v84, v28, v29
    v_cvt_pk_bf16_f32 v85, v30, v31
    v_pk_add_f32 v[32:33], v[20:21], v[22:23]
    v_pk_add_f32 v[32:33], v[32:33], v[24:25]
    v_pk_add_f32 v[32:33], v[32:33], v[26:27]
    v_pk_add_f32 v[32:33], v[32:33], v[28:29]
    v_pk_add_f32 v[32:33], v[32:33], v[30:31]
    v_add_f32 v32, v32, v33
    s_nop 1
    v_add_f32_dpp v32, v32, v32 row_ror:8 row_mask:0xf bank_mask:0xf
    s_nop 1
    v_add_f32_dpp v32, v32, v32 row_ror:4 row_mask:0xf bank_mask:0xf
    s_nop 1
    v_add_f32_dpp v32, v32, v32 row_ror:2 row_mask:0xf bank_mask:0xf
    s_nop 1
    v_add_f32_dpp v32, v32, v32 row_ror:1 row_mask:0xf bank_mask:0xf
    v_mov_b32 v33, v32
    s_nop 1
    v_permlane16_swap_b32 v32, v33
    v_add_f32 v32, v32, v33
    v_mov_b32 v33, v32
    s_nop 1
    v_permlane32_swap_b32 v32, v33
    v_add_f32 v32, v32, v33
    v_mul_f32 v32, v8, v32
    v_pk_add_f32 v[20:21], v[20:21], v[32:33] op_sel_hi:[1,0]
    v_pk_add_f32 v[22:23], v[22:23], v[32:33] op_sel_hi:[1,0]
    v_pk_add_f32 v[24:25], v[24:25], v[32:33] op_sel_hi:[1,0]
    v_pk_add_f32 v[26:27], v[26:27], v[32:33] op_sel_hi:[1,0]
    v_pk_add_f32 v[28:29], v[28:29], v[32:33] op_sel_hi:[1,0]
    v_pk_add_f32 v[30:31], v[30:31], v[32:33] op_sel_hi:[1,0]
    v_pk_mul_f32 v[34:35], v[20:21], v[20:21]
    v_pk_fma_f32 v[34:35], v[22:23], v[22:23], v[34:35]
    v_pk_fma_f32 v[34:35], v[24:25], v[24:25], v[34:35]
    v_pk_fma_f32 v[34:35], v[26:27], v[26:27], v[34:35]
    v_pk_fma_f32 v[34:35], v[28:29], v[28:29], v[34:35]
    v_pk_fma_f32 v[34:35], v[30:31], v[30:31], v[34:35]
    v_add_f32 v32, v34, v35
    s_nop 1
    v_add_f32_dpp v32, v32, v32 row_ror:8 row_mask:0xf bank_mask:0xf
    s_nop 1
    v_add_f32_dpp v32, v32, v32 row_ror:4 row_mask:0xf bank_mask:0xf
    s_nop 1
    v_add_f32_dpp v32, v32, v32 row_ror:2 row_mask:0xf bank_mask:0xf
    s_nop 1
    v_add_f32_dpp v32, v32, v32 row_ror:1 row_mask:0xf bank_mask:0xf
    v_mov_b32 v33, v32
    s_nop 1
    v_permlane16_swap_b32 v32, v33
    v_add_f32 v32, v32, v33
    v_mov_b32 v33, v32
    s_nop 1
    v_permlane32_swap_b32 v32, v33
    v_add_f32 v32, v32, v33
    v_mov_b32 v33, 0x3727c5ac
    v_fmac_f32 v33, 0x3ae38e39, v32
    v_rsq_f32 v32, v33
    s_add_u32 s16, s20, 7340032
    v_pk_mul_f32 v[20:21], v[20:21], v[32:33] op_sel_hi:[1,0]
    v_pk_mul_f32 v[22:23], v[22:23], v[32:33] op_sel_hi:[1,0]
    v_pk_mul_f32 v[24:25], v[24:25], v[32:33] op_sel_hi:[1,0]
    v_pk_mul_f32 v[26:27], v[26:27], v[32:33] op_sel_hi:[1,0]
    v_pk_mul_f32 v[28:29], v[28:29], v[32:33] op_sel_hi:[1,0]
    v_pk_mul_f32 v[30:31], v[30:31], v[32:33] op_sel_hi:[1,0]
    v_cvt_pk_bf16_f32 v86, v20, v21
    v_cvt_pk_bf16_f32 v87, v22, v23
    v_cvt_pk_bf16_f32 v88, v24, v25
    v_cvt_pk_bf16_f32 v89, v26, v27
    v_cvt_pk_bf16_f32 v90, v28, v29
    v_cvt_pk_bf16_f32 v91, v30, v31
    buffer_store_dwordx2 v[86:87], v4, s[4:7], s16 offen offset:0 sc1
    buffer_store_dwordx2 v[88:89], v4, s[4:7], s16 offen offset:384 sc1
    buffer_store_dwordx2 v[90:91], v4, s[4:7], s16 offen offset:768 sc1
    buffer_store_dwordx2 v[80:81], v4, s[4:7], s24 offen offset:0 sc1
    buffer_store_dwordx2 v[82:83], v4, s[4:7], s24 offen offset:384 sc1
    buffer_store_dwordx2 v[84:85], v4, s[4:7], s24 offen offset:768 sc1
    s_add_u32 s20, s20, 36864
    s_add_u32 s14, s14, 1
    s_add_u32 s22, s14, 1
    s_min_u32 s22, s22, 64
    s_mov_b32 s45, 131072
    buffer_load_dword v7, v6, s[4:7], 0 offen sc1
    s_waitcnt vmcnt(0)
    v_mov_b32 v32, s14
    s_mov_b64 exec, 1
    buffer_store_dword v32, off, s[4:7], s23 offset:0 sc1
    s_mov_b64 exec, -1
    buffer_load_dwordx2 v[10:11], v4, s[8:11], s20 offen offset:0
    buffer_load_dwordx2 v[12:13], v4, s[8:11], s20 offen offset:384
    buffer_load_dwordx2 v[14:15], v4, s[8:11], s20 offen offset:768
    v_cmp_gt_u32 vcc, s22, v7
    s_cbranch_vccz L_wfok_128
L_wf_127:
    buffer_load_dword v7, v6, s[4:7], 0 offen sc1
    s_sub_u32 s45, s45, 1
    s_cbranch_scc1 ABORT
    s_waitcnt vmcnt(0)
    v_cmp_gt_u32 vcc, s22, v7
    s_cbranch_vccnz L_wf_127
L_wfok_128:
    s_cmp_lt_u32 s14, 64
    s_cbranch_scc1 L_LNloop_126
    s_endpgm
ROLE_FIN:
    v_mbcnt_lo_u32_b32 v1, -1, 0
    v_mbcnt_hi_u32_b32 v1, -1, v1
    v_mbcnt_lo_u32_b32 v2, -1, 0
    v_mbcnt_hi_u32_b32 v2, -1, v2
    v_and_b32 v2, 31, v2
    v_lshlrev_b32 v2, 2, v2
    s_mov_b32 s45, 131072
L_ver_129:
    s_sleep 64
    buffer_load_dword v3, v2, s[84:87], 0 offen sc1
    s_sub_u32 s45, s45, 1
    s_cbranch_scc1 ABORT
    s_waitcnt vmcnt(0)
L_verchk_131:
    v_readlane_b32 s66, v3, 0
    v_readlane_b32 s67, v3, 4
    v_readlane_b32 s68, v3, 8
    v_readlane_b32 s69, v3, 12
    v_readlane_b32 s70, v3, 16
    v_readlane_b32 s71, v3, 20
    v_readlane_b32 s72, v3, 24
    v_readlane_b32 s73, v3, 28
    v_readlane_b32 s74, v3, 1
    s_add_u32 s75, s66, s67
    s_add_u32 s75, s75, s68
    s_add_u32 s75, s75, s69
    s_add_u32 s75, s75, s70
    s_add_u32 s75, s75, s71
    s_add_u32 s75, s75, s72
    s_add_u32 s75, s75, s73
    s_add_u32 s75, s75, s74
    s_cmp_ge_u32 s75, 267
    s_cbranch_scc1 L_ver_129_d
    s_sleep 16
    s_branch L_ver_129
L_ver_129_d:
    s_cmp_eq_u32 s93, 1
    s_cbranch_scc1 L_verok_130
    s_or_b32 s75, s66, s67
    s_or_b32 s75, s75, s68
    s_or_b32 s75, s75, s69
    s_or_b32 s75, s75, s70
    s_or_b32 s75, s75, s71
    s_or_b32 s75, s75, s72
    s_or_b32 s75, s75, s73
    s_cmp_lg_u32 s75, 32
    s_cbranch_scc1 REROLE
L_verok_130:
    s_load_dwordx2 s[8:9], s[0:1], 88
    s_mov_b32 s10, 2359296
    s_mov_b32 s11, 0x20000
    s_waitcnt lgkmcnt(0)
    v_mov_b32 v7, 0x40000000
    v_lshlrev_b32 v4, 3, v1
    v_cmp_gt_u32 vcc, 48, v1
    s_nop 1
    v_cndmask_b32 v4, v7, v4, vcc
    v_lshlrev_b32 v5, 4, v1
    v_cndmask_b32 v5, v7, v5, vcc
    v_cndmask_b32 v8, 0, 1.0, vcc
    v_mul_f32 v8, 0xbae38e39, v8
    v_min_u32 v6, 35, v1
    v_lshlrev_b32 v6, 7, v6
    v_add_u32 v6, 20992, v6
    s_lshl_b32 s16, s12, 2
    s_add_u32 s16, s16, s13
    s_lshl_b32 s23, s16, 7
    s_add_u32 s23, s23, 16896
    s_mul_i32 s20, s16, 1152
    s_mul_i32 s21, s16, 2304
    s_add_u32 s21, s21, 125829120
    s_mov_b32 s14, 0
    s_mov_b32 s22, 1
    s_mov_b32 s45, 131072
L_wf_132:
    buffer_load_dword v7, v6, s[4:7], 0 offen sc1
    s_sub_u32 s45, s45, 1
    s_cbranch_scc1 ABORT
    s_waitcnt vmcnt(0)
    v_cmp_gt_u32 vcc, s22, v7
    s_cbranch_vccnz L_wf_132
L_wfok_133:
L_FINloop_134:
    s_add_u32 s24, s20, 4718592
    buffer_load_dwordx2 v[10:11], v4, s[4:7], s24 offen offset:0 sc1
    buffer_load_dwordx2 v[12:13], v4, s[4:7], s24 offen offset:384 sc1
    buffer_load_dwordx2 v[14:15], v4, s[4:7], s24 offen offset:768 sc1
    buffer_load_dwordx4 v[20:23], v5, s[4:7], s21 offen offset:0 sc1
    buffer_load_dwordx4 v[24:27], v5, s[4:7], s21 offen offset:768 sc1
    buffer_load_dwordx4 v[28:31], v5, s[4:7], s21 offen offset:1536 sc1
    s_add_u32 s21, s21, 73728
    buffer_load_dwordx4 v[40:43], v5, s[4:7], s21 offen offset:0 sc1
    buffer_load_dwordx4 v[44:47], v5, s[4:7], s21 offen offset:768 sc1
    buffer_load_dwordx4 v[48:51], v5, s[4:7], s21 offen offset:1536 sc1
    s_add_u32 s21, s21, 73728
    buffer_load_dwordx4 v[52:55], v5, s[4:7], s21 offen offset:0 sc1
    buffer_load_dwordx4 v[56:59], v5, s[4:7], s21 offen offset:768 sc1
    buffer_load_dwordx4 v[60:63], v5, s[4:7], s21 offen offset:1536 sc1
    s_add_u32 s21, s21, 73728
    buffer_load_dwordx4 v[64:67], v5, s[4:7], s21 offen offset:0 sc1
    buffer_load_dwordx4 v[68:71], v5, s[4:7], s21 offen offset:768 sc1
    buffer_load_dwordx4 v[72:75], v5, s[4:7], s21 offen offset:1536 sc1
    s_add_u32 s21, s21, 73728
    s_waitcnt vmcnt(12)
    v_lshlrev_b32 v80, 16, v10
    v_and_b32 v81, 0xffff0000, v10
    v_lshlrev_b32 v82, 16, v11
    v_and_b32 v83, 0xffff0000, v11
    v_lshlrev_b32 v84, 16, v12
    v_and_b32 v85, 0xffff0000, v12
    v_lshlrev_b32 v86, 16, v13
    v_and_b32 v87, 0xffff0000, v13
    v_lshlrev_b32 v88, 16, v14
    v_and_b32 v89, 0xffff0000, v14
    v_lshlrev_b32 v90, 16, v15
    v_and_b32 v91, 0xffff0000, v15
    s_waitcnt vmcnt(9)
    v_pk_add_f32 v[20:21], v[20:21], v[80:81]
    v_pk_add_f32 v[22:23], v[22:23], v[82:83]
    v_pk_add_f32 v[24:25], v[24:25], v[84:85]
    v_pk_add_f32 v[26:27], v[26:27], v[86:87]
    v_pk_add_f32 v[28:29], v[28:29], v[88:89]
    v_pk_add_f32 v[30:31], v[30:31], v[90:91]
    s_waitcnt vmcnt(6)
    v_pk_add_f32 v[20:21], v[20:21], v[40:41]
    v_pk_add_f32 v[22:23], v[22:23], v[42:43]
    v_pk_add_f32 v[24:25], v[24:25], v[44:45]
    v_pk_add_f32 v[26:27], v[26:27], v[46:47]
    v_pk_add_f32 v[28:29], v[28:29], v[48:49]
    v_pk_add_f32 v[30:31], v[30:31], v[50:51]
    s_waitcnt vmcnt(3)
    v_pk_add_f32 v[20:21], v[20:21], v[52:53]
    v_pk_add_f32 v[22:23], v[22:23], v[54:55]
    v_pk_add_f32 v[24:25], v[24:25], v[56:57]
    v_pk_add_f32 v[26:27], v[26:27], v[58:59]
    v_pk_add_f32 v[28:29], v[28:29], v[60:61]
    v_pk_add_f32 v[30:31], v[30:31], v[62:63]
    s_waitcnt vmcnt(0)
    v_pk_add_f32 v[20:21], v[20:21], v[64:65]
    v_pk_add_f32 v[22:23], v[22:23], v[66:67]
    v_pk_add_f32 v[24:25], v[24:25], v[68:69]
    v_pk_add_f32 v[26:27], v[26:27], v[70:71]
    v_pk_add_f32 v[28:29], v[28:29], v[72:73]
    v_pk_add_f32 v[30:31], v[30:31], v[74:75]
    v_cvt_pk_bf16_f32 v80, v20, v21
    v_cvt_pk_bf16_f32 v81, v22, v23
    v_cvt_pk_bf16_f32 v82, v24, v25
    v_cvt_pk_bf16_f32 v83, v26, v27
    v_cvt_pk_bf16_f32 v84, v28, v29
    v_cvt_pk_bf16_f32 v85, v30, v31
    buffer_store_dwordx2 v[80:81], v4, s[8:11], s20 offen offset:0
    buffer_store_dwordx2 v[82:83], v4, s[8:11], s20 offen offset:384
    buffer_store_dwordx2 v[84:85], v4, s[8:11], s20 offen offset:768
    s_add_u32 s20, s20, 36864
    s_add_u32 s14, s14, 1
    s_add_u32 s22, s14, 1
    s_min_u32 s22, s22, 64
    s_cmp_eq_u32 s14, 64
    s_cbranch_scc1 END
    s_mov_b32 s45, 131072
    buffer_load_dword v7, v6, s[4:7], 0 offen sc1
    s_waitcnt vmcnt(0)
    v_cmp_gt_u32 vcc, s22, v7
    s_cbranch_vccz L_wfok_136
L_wf_135:
    buffer_load_dword v7, v6, s[4:7], 0 offen sc1
    s_sub_u32 s45, s45, 1
    s_cbranch_scc1 ABORT
    s_waitcnt vmcnt(0)
    v_cmp_gt_u32 vcc, s22, v7
    s_cbranch_vccnz L_wf_135
L_wfok_136:
    s_cmp_lt_u32 s14, 64
    s_cbranch_scc1 L_FINloop_134
    s_endpgm
.p2align 6
.type ROLETAB,@object
ROLETAB:
.long 0xc8000002, 0xc8070102, 0xc80e0202, 0xc8150302, 0xc81c0402, 0xc8ff0502, 0xc8ff0602, 0xc8ff0702
.long 0xc8ff0802, 0x1b2f1b03, 0x1c301c03, 0x1d311d03, 0x1e321e03, 0x1f331f03, 0x20342003, 0x21352103
.long 0x22362203, 0x23372303, 0xc8ff0600, 0xc8ff0d00, 0xc8ff1400, 0xc8ff1b00, 0xc8ff0201, 0xc8ff0901
.long 0xc8ff1001, 0xc8ff1701, 0xc8ff1e01, 0x596d0504, 0xc8740c04, 0xc87b1304, 0xc87e1a04, 0xc87f2104
.long 0xc8010902, 0xc8080a02, 0xc80f0b02, 0xc8160c02, 0xc81d0d02, 0xc8ff0e02, 0xc8ff0f02, 0xc8ff1002
.long 0xc8ff1102, 0xc8ff0000, 0xc8ff0700, 0xc8ff0e00, 0xc8ff1500, 0xc8ff1c00, 0xc8ff0301, 0xc8ff0a01
.long 0xc8ff1101, 0xc8ff1801, 0xc8ff1f01, 0x293d0604, 0x2f430d04, 0x35491404, 0x3b4f1b04, 0x41552204
.long 0x475b2804, 0x4d612e04, 0x53673404, 0x5a6e3a04, 0xc8754004, 0xc87c4604, 0xc8ff0405, 0xc8ff0206
.long 0xc8021202, 0xc8091302, 0xc8101402, 0xc8171502, 0xc81e1602, 0xc8ff1702, 0xc8ff1802, 0xc8ff1902
.long 0xc8ff1a02, 0xc8ff0100, 0xc8ff0800, 0xc8ff0f00, 0xc8ff1600, 0xc8ff1d00, 0xc8ff0401, 0xc8ff0b01
.long 0xc8ff1201, 0xc8ff1901, 0x24380004, 0x2a3e0704, 0x30440e04, 0x364a1504, 0x3c501c04, 0x42562304
.long 0x485c2904, 0x4e622f04, 0x54683504, 0x5b6f3b04, 0xc8764104, 0xc87d4704, 0xc8ff0505, 0xc8ff0306
.long 0xc8031b02, 0xc80a1c02, 0xc8111d02, 0xc8181e02, 0xc81f1f02, 0xc8ff2002, 0xc8ff2102, 0xc8ff2202
.long 0xc8ff2302, 0xc8ff0200, 0xc8ff0900, 0xc8ff1000, 0xc8ff1700, 0xc8ff1e00, 0xc8ff0501, 0xc8ff0c01
.long 0xc8ff1301, 0xc8ff1a01, 0x25390104, 0x2b3f0804, 0x31450f04, 0x374b1604, 0x3d511d04, 0x43572404
.long 0x495d2a04, 0x4f633004, 0x55693604, 0x5c703c04, 0xc8774204, 0xc8ff0005, 0xc8ff0605, 0xc8ff0406
.long 0x40003, 0x30b0103, 0x6120203, 0x9190303, 0xc200403, 0xf230503, 0x12260603, 0x15290703
.long 0x182c0803, 0xc8ff0300, 0xc8ff0a00, 0xc8ff1100, 0xc8ff1800, 0xc8ff1f00, 0xc8ff0601, 0xc8ff0d01
.long 0xc8ff1401, 0xc8ff1b01, 0x263a0204, 0x2c400904, 0x32461004, 0x384c1704, 0x3e521e04, 0x44582504
.long 0x4a5e2b04, 0x50643104, 0x566a3704, 0x5d713d04, 0xc8784304, 0xc8ff0105, 0xc8ff0705, 0xc8ff0506
.long 0x1050903, 0x40c0a03, 0x7130b03, 0xa1a0c03, 0xd210d03, 0x10240e03, 0x13270f03, 0x162a1003
.long 0x192d1103, 0xc8ff0400, 0xc8ff0b00, 0xc8ff1200, 0xc8ff1900, 0xc8ff0001, 0xc8ff0701, 0xc8ff0e01
.long 0xc8ff1501, 0xc8ff1c01, 0x273b0304, 0x2d410a04, 0x33471104, 0x394d1804, 0x3f531f04, 0x45592604
.long 0x4b5f2c04, 0x51653204, 0x576b3804, 0x5e723e04, 0xc8794404, 0xc8ff0205, 0xc8ff0006, 0xc8ff0606
.long 0x2061203, 0x50d1303, 0x8141403, 0xb1b1503, 0xe221603, 0x11251703, 0x14281803, 0x172b1903
.long 0x1a2e1a03, 0xc8ff0500, 0xc8ff0c00, 0xc8ff1300, 0xc8ff1a00, 0xc8ff0101, 0xc8ff0801, 0xc8ff0f01
.long 0xc8ff1601, 0xc8ff1d01, 0x283c0404, 0x2e420b04, 0x34481204, 0x3a4e1904, 0x40542004, 0x465a2704
.long 0x4c602d04, 0x52663304, 0x586c3904, 0x5f733f04, 0xc87a4504, 0xc8ff0305, 0xc8ff0106, 0xc8ff0706
.size ROLETAB, 896
.section .rodata,"a"
.p2align 6
.amdhsa_kernel sequential_preLN__memory_aug_recurrent_mem_tr__geglu_ffn__prompt_kernel
  .amdhsa_next_free_vgpr 512
  .amdhsa_next_free_sgpr 102
  .amdhsa_accum_offset 256
  .amdhsa_group_segment_fixed_size 0
  .amdhsa_float_denorm_mode_32 3
  .amdhsa_kernarg_size 112
  .amdhsa_user_sgpr_count 2
  .amdhsa_user_sgpr_kernarg_segment_ptr 1
  .amdhsa_system_sgpr_workgroup_id_x 1
.end_amdhsa_kernel
```
